```python
import torch

def _softmax(x, axis=-1):
    return torch.softmax(x, dim=axis)
def _gelu(x):
    return torch.nn.functional.gelu(x, approximate="tanh")
def _silu(x):
    return torch.nn.functional.silu(x)
def _sigmoid(x):
    return torch.sigmoid(x)
def _layernorm(x, axis=-1, eps=1e-5):
    m = x.mean(dim=axis, keepdim=True)
    v = x.var(dim=axis, keepdim=True, unbiased=False)
    return (x - m) / torch.sqrt(v + eps)
def _scatter_add(tgt, idx, src, axis=0):
    return tgt.clone().index_add_(axis, idx, src)
def _segment_sum(src, seg, n):
    out = torch.zeros((n,) + src.shape[1:], dtype=src.dtype)
    return out.index_add_(0, seg, src)
def _pad(x, pw):
    flat = tuple(v for pair in reversed(pw) for v in pair)
    return torch.nn.functional.pad(x, flat)

kernel_name = 'gated_mix__sliding_local_dilated__glu_gated_glu__prompt'

def setup_inputs():

    _w = (lambda a: (lambda t: t.to(torch.bfloat16) if t.is_floating_point() else t)(torch.as_tensor(a)))
    def _A_setup():
        B, S, D = 1, 2048, 448
        return {
            "x": _w((lambda *s: torch.randn(*s, dtype=torch.bfloat16) * 0.05)(B, S, D)),
            "wqkv": _w((lambda *s: torch.randn(*s, dtype=torch.bfloat16) * 0.8)(D, 3 * D)),
            "wo": _w((lambda *s: torch.randn(*s, dtype=torch.bfloat16) * 0.05)(D, D)),
        }
    _A_in = _A_setup()

    def _B_setup():
        B, S, D, F = 1, 2048, 448, 1792
        return {
            "x": _w((lambda *s: torch.randn(*s, dtype=torch.bfloat16) * 0.05)(B, S, D)),
            "w_gate": _w((lambda *s: torch.randn(*s, dtype=torch.bfloat16) * 1.6)(D, F)),
            "w_up": _w((lambda *s: torch.randn(*s, dtype=torch.bfloat16) * 0.1)(D, F)),
            "w_down": _w((lambda *s: torch.randn(*s, dtype=torch.bfloat16) * 0.1)(F, D)),
        }
    _B_in = _B_setup()

    return {
        "A_x": _A_in["x"],
        "A_wqkv": _A_in["wqkv"],
        "A_wo": _A_in["wo"],
        "B_x": _B_in["x"],
        "B_w_gate": _B_in["w_gate"],
        "B_w_up": _B_in["w_up"],
        "B_w_down": _B_in["w_down"],
        "gate_w": _w((lambda *s: torch.randn(*s, dtype=torch.bfloat16) * 0.05)(448) * 16.0),
    }

def reference(A_x, A_wqkv, A_wo, B_x, B_w_gate, B_w_up, B_w_down, gate_w):
    def _A_ref(x, wqkv, wo):
        B, S, D = x.shape
        H = 16; Dh = D // H
        W, dil = 8, 2
        qkv = (lambda x, *d: x.permute(*d))((x @ wqkv).reshape(B, S, 3, H, Dh), 2, 0, 3, 1, 4)
        q, k, v = qkv[0], qkv[1], qkv[2]
        scale = Dh ** -0.5
        pos = torch.arange(S)
        off = torch.arange(W) * dil
        idx = pos[:, None] - off[None, :]
        mask = idx >= 0
        idx_c = torch.where(mask, idx, 0).reshape(-1)
        kg = k[:, :, idx_c, :].reshape(B, H, S, W, Dh)
        vg = v[:, :, idx_c, :].reshape(B, H, S, W, Dh)
        logits = torch.einsum("bhsd,bhswd->bhsw", q, kg) * scale
        logits = torch.where(mask[None, None, :, :], logits, -1e9)
        attn = _softmax(logits, axis=-1)
        o = torch.einsum("bhsw,bhswd->bhsd", attn, vg)
        return (lambda x, *d: x.permute(*d))(o, 0, 2, 1, 3).reshape(B, S, D) @ wo

    def _B_ref(x, w_gate, w_up, w_down):
        g = torch.einsum("bsd,df->bsf", x, w_gate)
        u = torch.einsum("bsd,df->bsf", x, w_up)
        h = _sigmoid(g) * u
        return torch.einsum("bsf,fd->bsd", h, w_down)

    x = A_x
    g = _sigmoid((x * gate_w).sum(-1, keepdims=True))
    a = _A_ref(x, A_wqkv, A_wo)
    b = _B_ref(x, B_w_gate, B_w_up, B_w_down)
    return g * a + (1 - g) * b
```

```asm
; @launch grid=(256,1,1) block=(256,1,1) lds=163840
.amdgcn_target "amdgcn-amd-amdhsa--gfx950"
.text
.globl gated_mix__sliding_local_dilated__glu_gated_glu__prompt_kernel
.p2align 8
.type gated_mix__sliding_local_dilated__glu_gated_glu__prompt_kernel,@function
gated_mix__sliding_local_dilated__glu_gated_glu__prompt_kernel:
    s_cmp_ge_u32 s2, 256
    s_cbranch_scc1 gated_mix__sliding_local_dilated__glu_gated_glu__prompt_kernel_done
    s_load_dwordx16 s[16:31], s[0:1], 0
    s_load_dwordx2 s[36:37], s[0:1], 80
    s_load_dwordx2 s[90:91], s[0:1], 72
    s_mov_b32 s96, s2
    v_lshrrev_b32 v4, 6, v0
    v_and_b32 v1, 63, v0
    v_and_b32 v2, 31, v0
    v_readfirstlane_b32 s3, v4
    v_bfe_u32 v3, v0, 5, 1
    s_and_b32 s7, s2, 7
    s_lshr_b32 s8, s2, 3
    s_sub_u32 s5, s8, 4
    s_cmp_ge_u32 s8, 0
    s_cselect_b32 s5, s5, s8
    s_max_i32 s5, s5, 0
    s_mul_i32 s6, s5, 37
    s_lshr_b32 s6, s6, 8
    s_lshl_b32 s9, s7, 2
    s_add_u32 s9, s9, s6
    s_lshl_b32 s9, s9, 1
    s_mul_i32 s10, s9, 94
    s_lshr_b32 s10, s10, 10
    s_mul_i32 s10, s10, 11
    s_sub_u32 s9, s9, s10
    s_mul_i32 s9, s9, 86
    s_lshr_b32 s9, s9, 7
    s_min_u32 s97, s9, 6
    s_mul_i32 s6, s6, 7
    s_sub_u32 s5, s5, s6
    s_and_b32 s94, s5, 0
    s_lshl_b32 s5, s5, 7
    s_mul_i32 s32, s3, 401408
    s_add_u32 s32, s32, s5
    s_lshl_b32 s4, s3, 10
    s_or_b32 s5, s2, s3
    s_cmp_lg_u32 s5, 0
    s_cbranch_scc1 gated_mix__sliding_local_dilated__glu_gated_glu__prompt_kernel_nn
    s_load_dwordx2 s[44:45], s[0:1], 72
    s_memrealtime s[48:49]
    s_waitcnt lgkmcnt(0)
    s_mov_b32 s46, 256
    s_mov_b32 s47, 0x00020000
    s_andn2_b32 s48, s48, 3
    s_or_b32 s49, s49, 0x40000000
    v_mov_b32 v4, s48
    v_mov_b32 v5, s49
    v_mov_b32 v6, 0
    buffer_store_dwordx2 v[4:5], v6, s[44:47], 0 offen sc1
    s_nop 1
gated_mix__sliding_local_dilated__glu_gated_glu__prompt_kernel_nn:
    s_cmp_lt_u32 s8, 11
    s_cbranch_scc1 gated_mix__sliding_local_dilated__glu_gated_glu__prompt_kernel_att
    s_sub_u32 s8, s8, 11
    s_nop 1
    s_mul_i32 s5, s8, 43
    s_lshr_b32 s5, s5, 7
    s_mul_i32 s6, s5, 3
    s_sub_u32 s8, s8, s6
    s_and_b32 s6, s7, 1
    s_mul_i32 s6, s6, 3
    s_add_u32 s8, s8, s6
    s_lshr_b32 s7, s7, 1
    s_lshl_b32 s33, s7, 3
    s_add_u32 s33, s33, s8
    s_lshl_b32 s33, s33, 3
    s_add_u32 s33, s33, s5
    s_lshl_b32 s33, s33, 2
    s_add_u32 s33, s33, s3
    s_lshl_b32 s33, s33, 3
    s_mul_i32 s2, s5, 3
    s_add_u32 s2, s2, 1
    s_lshr_b32 s2, s2, 1
    s_mul_i32 s7, s7, 7
    s_add_u32 s7, s7, s5
    s_mul_i32 s9, s3, 28672
    s_lshl_b32 s6, s7, 7
    s_add_u32 s9, s9, s6
    s_mul_i32 s11, s8, 11
    s_add_u32 s12, s2, 0
    s_sub_u32 s13, s12, 11
    s_cmp_ge_u32 s12, 11
    s_cselect_b32 s12, s13, s12
    s_add_u32 s12, s12, s11
    s_mul_i32 s72, s12, 147456
    s_lshr_b32 s13, s12, 1
    s_lshl_b32 s13, s13, 6
    s_and_b32 s12, s12, 1
    s_add_u32 s12, s12, s13
    s_mul_i32 s60, s12, 896
    s_add_u32 s12, s2, 1
    s_sub_u32 s13, s12, 11
    s_cmp_ge_u32 s12, 11
    s_cselect_b32 s12, s13, s12
    s_add_u32 s12, s12, s11
    s_mul_i32 s73, s12, 147456
    s_lshr_b32 s13, s12, 1
    s_lshl_b32 s13, s13, 6
    s_and_b32 s12, s12, 1
    s_add_u32 s12, s12, s13
    s_mul_i32 s61, s12, 896
    s_add_u32 s12, s2, 2
    s_sub_u32 s13, s12, 11
    s_cmp_ge_u32 s12, 11
    s_cselect_b32 s12, s13, s12
    s_add_u32 s12, s12, s11
    s_mul_i32 s74, s12, 147456
    s_lshr_b32 s13, s12, 1
    s_lshl_b32 s13, s13, 6
    s_and_b32 s12, s12, 1
    s_add_u32 s12, s12, s13
    s_mul_i32 s62, s12, 896
    s_add_u32 s12, s2, 3
    s_sub_u32 s13, s12, 11
    s_cmp_ge_u32 s12, 11
    s_cselect_b32 s12, s13, s12
    s_add_u32 s12, s12, s11
    s_mul_i32 s75, s12, 147456
    s_lshr_b32 s13, s12, 1
    s_lshl_b32 s13, s13, 6
    s_and_b32 s12, s12, 1
    s_add_u32 s12, s12, s13
    s_mul_i32 s63, s12, 896
    s_add_u32 s12, s2, 4
    s_sub_u32 s13, s12, 11
    s_cmp_ge_u32 s12, 11
    s_cselect_b32 s12, s13, s12
    s_add_u32 s12, s12, s11
    s_mul_i32 s76, s12, 147456
    s_lshr_b32 s13, s12, 1
    s_lshl_b32 s13, s13, 6
    s_and_b32 s12, s12, 1
    s_add_u32 s12, s12, s13
    s_mul_i32 s64, s12, 896
    s_add_u32 s12, s2, 5
    s_sub_u32 s13, s12, 11
    s_cmp_ge_u32 s12, 11
    s_cselect_b32 s12, s13, s12
    s_add_u32 s12, s12, s11
    s_mul_i32 s77, s12, 147456
    s_lshr_b32 s13, s12, 1
    s_lshl_b32 s13, s13, 6
    s_and_b32 s12, s12, 1
    s_add_u32 s12, s12, s13
    s_mul_i32 s65, s12, 896
    v_lshrrev_b32 v4, 3, v1
    s_lshl_b32 s5, s3, 3
    v_add_u32 v4, s5, v4
    v_bfe_u32 v5, v4, 1, 3
    v_and_b32 v6, 7, v1
    v_xor_b32 v5, v5, v6
    v_mul_u32_u24 v4, 1792, v4
    v_lshl_add_u32 v8, v5, 4, v4
    v_lshrrev_b32 v4, 3, v1
    v_bfe_u32 v5, v1, 4, 1
    v_bfe_u32 v6, v1, 1, 2
    v_xor_b32 v5, v5, v6
    v_mul_u32_u24 v4, 3584, v4
    v_and_b32 v6, 1, v1
    v_lshl_add_u32 v4, v6, 4, v4
    v_lshl_add_u32 v9, v5, 5, v4
    v_xor_b32 v5, 2, v5
    v_lshl_add_u32 v10, v5, 5, v4
    s_waitcnt lgkmcnt(0)
    s_mov_b32 s40, s16
    s_mov_b32 s41, s17
    s_mov_b32 s42, 1835008
    s_mov_b32 s43, 0x00020000
    s_mov_b32 s44, s24
    s_mov_b32 s45, s25
    s_mov_b32 s46, 1605632
    s_mov_b32 s47, 0x00020000
    s_mov_b32 s48, s26
    s_mov_b32 s49, s27
    s_mov_b32 s50, 1605632
    s_mov_b32 s51, 0x00020000
    s_add_u32 m0, s4, 0
    s_add_u32 s35, s9, 0
    buffer_load_dwordx4 v9, s[44:47], s35 offen lds
    s_add_u32 m0, s4, 4096
    s_add_u32 s35, s9, 0
    buffer_load_dwordx4 v10, s[48:51], s35 offen lds
    s_add_u32 m0, s4, 16384
    s_add_u32 s35, s60, 0
    buffer_load_dwordx4 v8, s[40:43], s35 offen lds
    s_add_u32 m0, s4, 20480
    s_add_u32 s35, s61, 0
    buffer_load_dwordx4 v8, s[40:43], s35 offen lds
    s_add_u32 m0, s4, 24576
    s_add_u32 s35, s62, 0
    buffer_load_dwordx4 v8, s[40:43], s35 offen lds
    s_add_u32 m0, s4, 28672
    s_add_u32 s35, s63, 0
    buffer_load_dwordx4 v8, s[40:43], s35 offen lds
    s_add_u32 m0, s4, 32768
    s_add_u32 s35, s64, 0
    buffer_load_dwordx4 v8, s[40:43], s35 offen lds
    s_add_u32 m0, s4, 36864
    s_add_u32 s35, s65, 0
    buffer_load_dwordx4 v8, s[40:43], s35 offen lds
    s_add_u32 m0, s4, 8192
    s_add_u32 s35, s9, 114688
    buffer_load_dwordx4 v9, s[44:47], s35 offen lds
    s_add_u32 m0, s4, 12288
    s_add_u32 s35, s9, 114688
    buffer_load_dwordx4 v10, s[48:51], s35 offen lds
    s_add_u32 m0, s4, 40960
    s_add_u32 s35, s9, 229376
    buffer_load_dwordx4 v9, s[44:47], s35 offen lds
    s_add_u32 m0, s4, 45056
    s_add_u32 s35, s9, 229376
    buffer_load_dwordx4 v10, s[48:51], s35 offen lds
    s_add_u32 m0, s4, 57344
    s_add_u32 s35, s60, 128
    buffer_load_dwordx4 v8, s[40:43], s35 offen lds
    s_add_u32 m0, s4, 61440
    s_add_u32 s35, s61, 128
    buffer_load_dwordx4 v8, s[40:43], s35 offen lds
    s_add_u32 m0, s4, 65536
    s_add_u32 s35, s62, 128
    buffer_load_dwordx4 v8, s[40:43], s35 offen lds
    s_add_u32 m0, s4, 69632
    s_add_u32 s35, s63, 128
    buffer_load_dwordx4 v8, s[40:43], s35 offen lds
    s_add_u32 m0, s4, 73728
    s_add_u32 s35, s64, 128
    buffer_load_dwordx4 v8, s[40:43], s35 offen lds
    s_add_u32 m0, s4, 77824
    s_add_u32 s35, s65, 128
    buffer_load_dwordx4 v8, s[40:43], s35 offen lds
    s_add_u32 m0, s4, 49152
    s_add_u32 s35, s9, 344064
    buffer_load_dwordx4 v9, s[44:47], s35 offen lds
    s_add_u32 m0, s4, 53248
    s_add_u32 s35, s9, 344064
    buffer_load_dwordx4 v10, s[48:51], s35 offen lds
    s_mov_b32 s84, s18
    s_mov_b32 s85, s19
    s_mov_b32 s86, 1204224
    s_mov_b32 s87, 0x00020000
    s_lshr_b32 s12, s96, 3
    s_sub_u32 s12, s12, 11
    s_lshl_b32 s12, s12, 2
    s_add_u32 s12, s12, s3
    s_bfe_u32 s13, s96, 0x20001
    s_mul_i32 s88, s13, 896
    s_mul_i32 s89, s13, 224
    s_andn2_b32 s89, s89, 127
    s_and_b32 s83, s96, 1
    s_mul_i32 s83, s83, 802816
    s_mul_i32 s6, s12, 48
    v_min_u32 v4, 47, v1
    v_add_u32 v4, s6, v4
    v_mul_u32_u24 v5, 7282, v4
    v_lshrrev_b32 v5, 16, v5
    v_mul_u32_u24 v6, 9, v5
    v_sub_u32 v4, v4, v6
    v_mul_u32_u24 v5, 2688, v5
    v_mul_u32_u24 v6, 11, v4
    v_lshrrev_b32 v6, 5, v6
    v_lshl_add_u32 v5, v6, 9, v5
    v_lshl_add_u32 v216, v4, 7, v5
    v_add_u32 v216, 0, v216
    buffer_load_dword v27, v216, s[84:87], s89 offen
    s_mov_b32 s52, s36
    s_mov_b32 s53, s37
    s_mov_b32 s54, 9437184
    s_mov_b32 s55, 0x00020000
    s_mov_b32 s20, s28
    s_mov_b32 s21, s29
    s_mov_b32 s22, 1605632
    s_mov_b32 s23, 0x00020000
    s_add_u32 s24, s36, 9445376
    s_addc_u32 s25, s37, 0
    s_mov_b32 s26, 16384
    s_mov_b32 s27, 0x00020000
    s_mov_b32 s16, s90
    s_mov_b32 s17, s91
    s_mov_b32 s18, 256
    s_mov_b32 s19, 0x00020000
    s_add_u32 s12, s2, 6
    s_sub_u32 s13, s12, 11
    s_cmp_ge_u32 s12, 11
    s_cselect_b32 s12, s13, s12
    s_add_u32 s12, s12, s11
    s_mul_i32 s78, s12, 147456
    s_lshr_b32 s13, s12, 1
    s_lshl_b32 s13, s13, 6
    s_and_b32 s12, s12, 1
    s_add_u32 s12, s12, s13
    s_mul_i32 s66, s12, 896
    s_add_u32 s12, s2, 7
    s_sub_u32 s13, s12, 11
    s_cmp_ge_u32 s12, 11
    s_cselect_b32 s12, s13, s12
    s_add_u32 s12, s12, s11
    s_mul_i32 s79, s12, 147456
    s_lshr_b32 s13, s12, 1
    s_lshl_b32 s13, s13, 6
    s_and_b32 s12, s12, 1
    s_add_u32 s12, s12, s13
    s_mul_i32 s67, s12, 896
    s_add_u32 s12, s2, 8
    s_sub_u32 s13, s12, 11
    s_cmp_ge_u32 s12, 11
    s_cselect_b32 s12, s13, s12
    s_add_u32 s12, s12, s11
    s_mul_i32 s80, s12, 147456
    s_lshr_b32 s13, s12, 1
    s_lshl_b32 s13, s13, 6
    s_and_b32 s12, s12, 1
    s_add_u32 s12, s12, s13
    s_mul_i32 s68, s12, 896
    s_add_u32 s12, s2, 9
    s_sub_u32 s13, s12, 11
    s_cmp_ge_u32 s12, 11
    s_cselect_b32 s12, s13, s12
    s_add_u32 s12, s12, s11
    s_mul_i32 s81, s12, 147456
    s_lshr_b32 s13, s12, 1
    s_lshl_b32 s13, s13, 6
    s_and_b32 s12, s12, 1
    s_add_u32 s12, s12, s13
    s_mul_i32 s69, s12, 896
    s_add_u32 s12, s2, 10
    s_sub_u32 s13, s12, 11
    s_cmp_ge_u32 s12, 11
    s_cselect_b32 s12, s13, s12
    s_add_u32 s12, s12, s11
    s_mul_i32 s82, s12, 147456
    s_lshr_b32 s13, s12, 1
    s_lshl_b32 s13, s13, 6
    s_and_b32 s12, s12, 1
    s_add_u32 s12, s12, s13
    s_mul_i32 s70, s12, 896
    s_lshl_b32 s12, s7, 2
    s_add_u32 s12, s12, s3
    s_add_u32 s12, s12, 32
    s_lshl_b32 s10, s12, 10
    v_lshlrev_b32 v11, 4, v1
    v_bfe_u32 v4, v2, 1, 3
    v_xor_b32 v4, v4, v3
    v_lshlrev_b32 v5, 7, v2
    v_xor_b32 v12, 0, v4
    v_lshl_add_u32 v12, v12, 4, v5
    v_xor_b32 v13, 2, v4
    v_lshl_add_u32 v13, v13, 4, v5
    v_xor_b32 v14, 4, v4
    v_lshl_add_u32 v14, v14, 4, v5
    v_xor_b32 v15, 6, v4
    v_lshl_add_u32 v15, v15, 4, v5
    v_add_u32 v16, 65536, v12
    v_add_u32 v17, 65536, v13
    v_add_u32 v18, 65536, v14
    v_add_u32 v19, 65536, v15
    v_add_u32 v20, 131072, v12
    v_add_u32 v21, 131072, v13
    v_add_u32 v22, 131072, v14
    v_add_u32 v23, 131072, v15
    v_bfe_u32 v4, v1, 4, 1
    v_bfe_u32 v5, v1, 3, 1
    v_lshl_add_u32 v5, v4, 1, v5
    v_xor_b32 v5, s3, v5
    v_lshlrev_b32 v5, 5, v5
    v_lshl_add_u32 v5, v4, 12, v5
    v_bfe_u32 v4, v1, 2, 2
    v_lshl_add_u32 v4, v3, 3, v4
    v_lshl_add_u32 v5, v4, 7, v5
    v_and_b32 v4, 3, v1
    v_lshl_add_u32 v24, v4, 3, v5
    v_add_u32 v25, 65536, v24
    v_add_u32 v26, 131072, v24
    s_mov_b32 s14, 0xbfb8aa3b
    s_mov_b32 s15, 0xbfb8aa3b
    s_lshl_b32 s34, s3, 13
    s_add_u32 s34, s34, 98304
    s_cmp_eq_u32 s3, 3
    s_cselect_b32 s34, 151552, s34
    v_lshrrev_b32 v4, 3, v1
    v_bfe_u32 v5, v1, 4, 1
    v_lshlrev_b32 v5, 2, v5
    v_and_b32 v6, 7, v1
    v_xor_b32 v5, v5, v6
    v_mul_u32_u24 v4, 896, v4
    v_lshl_add_u32 v29, v5, 4, v4
    v_bfe_u32 v4, v1, 4, 1
    v_lshlrev_b32 v4, 5, v4
    v_and_b32 v5, 3, v1
    v_lshl_add_u32 v4, v5, 3, v4
    v_bfe_u32 v5, v1, 3, 1
    v_lshl_add_u32 v4, v5, 6, v4
    v_bfe_u32 v5, v1, 2, 2
    v_lshl_add_u32 v5, v3, 2, v5
    v_lshl_add_u32 v4, v5, 7, v4
    v_add_u32 v30, s34, v4
    v_xor_b32 v31, 64, v30
    v_mov_b32 v210, s33
    v_mov_b32 v4, 0x7fffff00
    v_cmp_eq_u32 vcc, 0, v1
    s_nop 1
    v_cndmask_b32 v210, v4, v210, vcc
    v_mov_b32 v28, 0
    s_waitcnt vmcnt(11)
    s_barrier
    ds_read_b64_tr_b16 a[0:1], v24 offset:0
    ds_read_b64_tr_b16 a[2:3], v24 offset:512
    ds_read_b128 v[160:163], v12 offset:16384
    ds_read_b128 v[164:167], v12 offset:20480
    ds_read_b128 v[168:171], v12 offset:24576
    ds_read_b128 v[172:175], v12 offset:28672
    ds_read_b128 v[176:179], v12 offset:32768
    ds_read_b128 v[180:183], v12 offset:36864
    ds_read_b64_tr_b16 a[4:5], v24 offset:2048
    ds_read_b64_tr_b16 a[6:7], v24 offset:2560
    ds_read_b128 v[184:187], v13 offset:16384
    ds_read_b128 v[188:191], v13 offset:20480
    s_waitcnt lgkmcnt(9)
    v_mfma_f32_32x32x16_bf16 v[32:47], a[0:3], v[160:163], 0
    ds_read_b128 v[192:195], v13 offset:24576
    ds_read_b128 v[196:199], v13 offset:28672
    s_add_u32 m0, s4, 81920
    s_add_u32 s35, s9, 458752
    s_waitcnt lgkmcnt(10)
    v_mfma_f32_32x32x16_bf16 v[48:63], a[0:3], v[164:167], 0
    ds_read_b128 v[200:203], v13 offset:32768
    buffer_load_dwordx4 v9, s[44:47], s35 offen lds
    s_add_u32 m0, s4, 86016
    s_add_u32 s35, s9, 458752
    s_waitcnt lgkmcnt(10)
    v_mfma_f32_32x32x16_bf16 v[64:79], a[0:3], v[168:171], 0
    ds_read_b128 v[204:207], v13 offset:36864
    s_waitcnt lgkmcnt(5)
    v_mfma_f32_32x32x16_bf16 v[80:95], a[0:3], v[172:175], 0
    ds_read_b64_tr_b16 a[8:9], v24 offset:8192
    ds_read_b64_tr_b16 a[10:11], v24 offset:8704
    ds_read_b128 v[160:163], v14 offset:16384
    buffer_load_dwordx4 v10, s[48:51], s35 offen lds
    v_mfma_f32_32x32x16_bf16 v[96:111], a[0:3], v[176:179], 0
    ds_read_b128 v[164:167], v14 offset:20480
    s_add_u32 m0, s4, 98304
    s_add_u32 s35, s60, 256
    v_mfma_f32_32x32x16_bf16 v[112:127], a[0:3], v[180:183], 0
    ds_read_b128 v[168:171], v14 offset:24576
    buffer_load_dwordx4 v8, s[40:43], s35 offen lds
    s_add_u32 m0, s4, 102400
    s_add_u32 s35, s61, 256
    v_mfma_f32_32x32x16_bf16 v[32:47], a[4:7], v[184:187], v[32:47]
    ds_read_b128 v[172:175], v14 offset:28672
    s_waitcnt lgkmcnt(7)
    v_mfma_f32_32x32x16_bf16 v[48:63], a[4:7], v[188:191], v[48:63]
    ds_read_b128 v[176:179], v14 offset:32768
    buffer_load_dwordx4 v8, s[40:43], s35 offen lds
    s_add_u32 m0, s4, 106496
    s_add_u32 s35, s62, 256
    v_mfma_f32_32x32x16_bf16 v[64:79], a[4:7], v[192:195], v[64:79]
    ds_read_b128 v[180:183], v14 offset:36864
    v_mfma_f32_32x32x16_bf16 v[80:95], a[4:7], v[196:199], v[80:95]
    ds_read_b64_tr_b16 a[12:13], v24 offset:10240
    ds_read_b64_tr_b16 a[14:15], v24 offset:10752
    ds_read_b128 v[184:187], v15 offset:16384
    buffer_load_dwordx4 v8, s[40:43], s35 offen lds
    v_mfma_f32_32x32x16_bf16 v[96:111], a[4:7], v[200:203], v[96:111]
    ds_read_b128 v[188:191], v15 offset:20480
    s_add_u32 m0, s4, 110592
    s_add_u32 s35, s63, 256
    s_waitcnt lgkmcnt(7)
    v_mfma_f32_32x32x16_bf16 v[112:127], a[4:7], v[204:207], v[112:127]
    ds_read_b128 v[192:195], v15 offset:24576
    buffer_load_dwordx4 v8, s[40:43], s35 offen lds
    s_add_u32 m0, s4, 114688
    s_add_u32 s35, s64, 256
    v_mfma_f32_32x32x16_bf16 v[32:47], a[8:11], v[160:163], v[32:47]
    ds_read_b128 v[196:199], v15 offset:28672
    v_mfma_f32_32x32x16_bf16 v[48:63], a[8:11], v[164:167], v[48:63]
    ds_read_b128 v[200:203], v15 offset:32768
    buffer_load_dwordx4 v8, s[40:43], s35 offen lds
    s_add_u32 m0, s4, 118784
    s_add_u32 s35, s65, 256
    v_mfma_f32_32x32x16_bf16 v[64:79], a[8:11], v[168:171], v[64:79]
    ds_read_b128 v[204:207], v15 offset:36864
    s_waitcnt lgkmcnt(5)
    v_mfma_f32_32x32x16_bf16 v[80:95], a[8:11], v[172:175], v[80:95]
    buffer_load_dwordx4 v8, s[40:43], s35 offen lds
    s_add_u32 m0, s4, 90112
    s_add_u32 s35, s9, 573440
    v_mfma_f32_32x32x16_bf16 v[96:111], a[8:11], v[176:179], v[96:111]
    v_mfma_f32_32x32x16_bf16 v[112:127], a[8:11], v[180:183], v[112:127]
    s_waitcnt vmcnt(9) lgkmcnt(0)
    s_barrier
    ds_read_b64_tr_b16 a[16:17], v24 offset:40960
    ds_read_b64_tr_b16 a[18:19], v24 offset:41472
    ds_read_b128 v[160:163], v12 offset:57344
    buffer_load_dwordx4 v9, s[44:47], s35 offen lds
    v_mfma_f32_32x32x16_bf16 v[32:47], a[12:15], v[184:187], v[32:47]
    ds_read_b128 v[164:167], v12 offset:61440
    ds_read_b128 v[168:171], v16 offset:0
    ds_read_b128 v[172:175], v16 offset:4096
    s_add_u32 m0, s4, 94208
    s_add_u32 s35, s9, 573440
    v_mfma_f32_32x32x16_bf16 v[48:63], a[12:15], v[188:191], v[48:63]
    ds_read_b128 v[176:179], v16 offset:8192
    buffer_load_dwordx4 v10, s[48:51], s35 offen lds
    s_add_u32 m0, s4, 122880
    s_add_u32 s35, s9, 688128
    v_mfma_f32_32x32x16_bf16 v[64:79], a[12:15], v[192:195], v[64:79]
    ds_read_b128 v[180:183], v16 offset:12288
    v_mfma_f32_32x32x16_bf16 v[80:95], a[12:15], v[196:199], v[80:95]
    ds_read_b64_tr_b16 a[20:21], v24 offset:43008
    ds_read_b64_tr_b16 a[22:23], v24 offset:43520
    ds_read_b128 v[184:187], v13 offset:57344
    buffer_load_dwordx4 v9, s[44:47], s35 offen lds
    v_mfma_f32_32x32x16_bf16 v[96:111], a[12:15], v[200:203], v[96:111]
    ds_read_b128 v[188:191], v13 offset:61440
    s_add_u32 m0, s4, 126976
    s_add_u32 s35, s9, 688128
    v_mfma_f32_32x32x16_bf16 v[112:127], a[12:15], v[204:207], v[112:127]
    ds_read_b128 v[192:195], v17 offset:0
    buffer_load_dwordx4 v10, s[48:51], s35 offen lds
    s_add_u32 m0, s4, 139264
    s_add_u32 s35, s60, 384
    s_waitcnt lgkmcnt(7)
    v_mfma_f32_32x32x16_bf16 v[32:47], a[16:19], v[160:163], v[32:47]
    ds_read_b128 v[196:199], v17 offset:4096
    v_mfma_f32_32x32x16_bf16 v[48:63], a[16:19], v[164:167], v[48:63]
    ds_read_b128 v[200:203], v17 offset:8192
    buffer_load_dwordx4 v8, s[40:43], s35 offen lds
    s_add_u32 m0, s4, 143360
    s_add_u32 s35, s61, 384
    v_mfma_f32_32x32x16_bf16 v[64:79], a[16:19], v[168:171], v[64:79]
    ds_read_b128 v[204:207], v17 offset:12288
    v_mfma_f32_32x32x16_bf16 v[80:95], a[16:19], v[172:175], v[80:95]
    ds_read_b64_tr_b16 a[24:25], v24 offset:49152
    ds_read_b64_tr_b16 a[26:27], v24 offset:49664
    ds_read_b128 v[160:163], v14 offset:57344
    buffer_load_dwordx4 v8, s[40:43], s35 offen lds
    s_waitcnt lgkmcnt(7)
    v_mfma_f32_32x32x16_bf16 v[96:111], a[16:19], v[176:179], v[96:111]
    ds_read_b128 v[164:167], v14 offset:61440
    s_add_u32 m0, s4, 147456
    s_add_u32 s35, s62, 384
    v_mfma_f32_32x32x16_bf16 v[112:127], a[16:19], v[180:183], v[112:127]
    ds_read_b128 v[168:171], v18 offset:0
    buffer_load_dwordx4 v8, s[40:43], s35 offen lds
    s_add_u32 m0, s4, 151552
    s_add_u32 s35, s63, 384
    v_mfma_f32_32x32x16_bf16 v[32:47], a[20:23], v[184:187], v[32:47]
    ds_read_b128 v[172:175], v18 offset:4096
    v_mfma_f32_32x32x16_bf16 v[48:63], a[20:23], v[188:191], v[48:63]
    ds_read_b128 v[176:179], v18 offset:8192
    buffer_load_dwordx4 v8, s[40:43], s35 offen lds
    s_add_u32 m0, s4, 155648
    s_add_u32 s35, s64, 384
    s_waitcnt lgkmcnt(7)
    v_mfma_f32_32x32x16_bf16 v[64:79], a[20:23], v[192:195], v[64:79]
    ds_read_b128 v[180:183], v18 offset:12288
    v_mfma_f32_32x32x16_bf16 v[80:95], a[20:23], v[196:199], v[80:95]
    ds_read_b64_tr_b16 a[28:29], v24 offset:51200
    ds_read_b64_tr_b16 a[30:31], v24 offset:51712
    ds_read_b128 v[184:187], v15 offset:57344
    buffer_load_dwordx4 v8, s[40:43], s35 offen lds
    v_mfma_f32_32x32x16_bf16 v[96:111], a[20:23], v[200:203], v[96:111]
    ds_read_b128 v[188:191], v15 offset:61440
    s_add_u32 m0, s4, 159744
    s_add_u32 s35, s65, 384
    v_mfma_f32_32x32x16_bf16 v[112:127], a[20:23], v[204:207], v[112:127]
    ds_read_b128 v[192:195], v19 offset:0
    buffer_load_dwordx4 v8, s[40:43], s35 offen lds
    s_add_u32 m0, s4, 131072
    s_add_u32 s35, s9, 802816
    s_waitcnt lgkmcnt(7)
    v_mfma_f32_32x32x16_bf16 v[32:47], a[24:27], v[160:163], v[32:47]
    ds_read_b128 v[196:199], v19 offset:4096
    v_mfma_f32_32x32x16_bf16 v[48:63], a[24:27], v[164:167], v[48:63]
    ds_read_b128 v[200:203], v19 offset:8192
    buffer_load_dwordx4 v9, s[44:47], s35 offen lds
    s_add_u32 m0, s4, 135168
    s_add_u32 s35, s9, 802816
    v_mfma_f32_32x32x16_bf16 v[64:79], a[24:27], v[168:171], v[64:79]
    ds_read_b128 v[204:207], v19 offset:12288
    v_mfma_f32_32x32x16_bf16 v[80:95], a[24:27], v[172:175], v[80:95]
    buffer_load_dwordx4 v10, s[48:51], s35 offen lds
    s_waitcnt lgkmcnt(4)
    v_mfma_f32_32x32x16_bf16 v[96:111], a[24:27], v[176:179], v[96:111]
    v_mfma_f32_32x32x16_bf16 v[112:127], a[24:27], v[180:183], v[112:127]
    s_waitcnt vmcnt(10) lgkmcnt(0)
    s_barrier
    ds_read_b64_tr_b16 a[32:33], v25 offset:16384
    ds_read_b64_tr_b16 a[34:35], v25 offset:16896
    ds_read_b128 v[160:163], v16 offset:32768
    s_add_u32 m0, s4, 0
    s_add_u32 s35, s9, 917504
    v_mfma_f32_32x32x16_bf16 v[32:47], a[28:31], v[184:187], v[32:47]
    ds_read_b128 v[164:167], v16 offset:36864
    ds_read_b128 v[168:171], v16 offset:40960
    ds_read_b128 v[172:175], v16 offset:45056
    buffer_load_dwordx4 v9, s[44:47], s35 offen lds
    v_mfma_f32_32x32x16_bf16 v[48:63], a[28:31], v[188:191], v[48:63]
    ds_read_b128 v[176:179], v16 offset:49152
    s_add_u32 m0, s4, 4096
    s_add_u32 s35, s9, 917504
    v_mfma_f32_32x32x16_bf16 v[64:79], a[28:31], v[192:195], v[64:79]
    ds_read_b128 v[180:183], v16 offset:53248
    buffer_load_dwordx4 v10, s[48:51], s35 offen lds
    s_add_u32 m0, s4, 16384
    s_add_u32 s35, s60, 512
    v_mfma_f32_32x32x16_bf16 v[80:95], a[28:31], v[196:199], v[80:95]
    ds_read_b64_tr_b16 a[36:37], v25 offset:18432
    ds_read_b64_tr_b16 a[38:39], v25 offset:18944
    ds_read_b128 v[184:187], v17 offset:32768
    v_mfma_f32_32x32x16_bf16 v[96:111], a[28:31], v[200:203], v[96:111]
    ds_read_b128 v[188:191], v17 offset:36864
    buffer_load_dwordx4 v8, s[40:43], s35 offen lds
    s_add_u32 m0, s4, 20480
    s_add_u32 s35, s61, 512
    v_mfma_f32_32x32x16_bf16 v[112:127], a[28:31], v[204:207], v[112:127]
    ds_read_b128 v[192:195], v17 offset:40960
    s_waitcnt lgkmcnt(7)
    v_mfma_f32_32x32x16_bf16 v[32:47], a[32:35], v[160:163], v[32:47]
    ds_read_b128 v[196:199], v17 offset:45056
    buffer_load_dwordx4 v8, s[40:43], s35 offen lds
    s_add_u32 m0, s4, 24576
    s_add_u32 s35, s62, 512
    v_mfma_f32_32x32x16_bf16 v[48:63], a[32:35], v[164:167], v[48:63]
    ds_read_b128 v[200:203], v17 offset:49152
    v_mfma_f32_32x32x16_bf16 v[64:79], a[32:35], v[168:171], v[64:79]
    ds_read_b128 v[204:207], v17 offset:53248
    buffer_load_dwordx4 v8, s[40:43], s35 offen lds
    s_add_u32 m0, s4, 28672
    s_add_u32 s35, s63, 512
    v_mfma_f32_32x32x16_bf16 v[80:95], a[32:35], v[172:175], v[80:95]
    ds_read_b64_tr_b16 a[40:41], v25 offset:24576
    ds_read_b64_tr_b16 a[42:43], v25 offset:25088
    ds_read_b128 v[160:163], v18 offset:32768
    s_waitcnt lgkmcnt(7)
    v_mfma_f32_32x32x16_bf16 v[96:111], a[32:35], v[176:179], v[96:111]
    ds_read_b128 v[164:167], v18 offset:36864
    buffer_load_dwordx4 v8, s[40:43], s35 offen lds
    s_add_u32 m0, s4, 32768
    s_add_u32 s35, s64, 512
    v_mfma_f32_32x32x16_bf16 v[112:127], a[32:35], v[180:183], v[112:127]
    ds_read_b128 v[168:171], v18 offset:40960
    v_mfma_f32_32x32x16_bf16 v[32:47], a[36:39], v[184:187], v[32:47]
    ds_read_b128 v[172:175], v18 offset:45056
    buffer_load_dwordx4 v8, s[40:43], s35 offen lds
    s_add_u32 m0, s4, 36864
    s_add_u32 s35, s65, 512
    v_mfma_f32_32x32x16_bf16 v[48:63], a[36:39], v[188:191], v[48:63]
    ds_read_b128 v[176:179], v18 offset:49152
    s_waitcnt lgkmcnt(7)
    v_mfma_f32_32x32x16_bf16 v[64:79], a[36:39], v[192:195], v[64:79]
    ds_read_b128 v[180:183], v18 offset:53248
    buffer_load_dwordx4 v8, s[40:43], s35 offen lds
    s_add_u32 m0, s4, 8192
    s_add_u32 s35, s9, 1032192
    v_mfma_f32_32x32x16_bf16 v[80:95], a[36:39], v[196:199], v[80:95]
    ds_read_b64_tr_b16 a[44:45], v25 offset:26624
    ds_read_b64_tr_b16 a[46:47], v25 offset:27136
    ds_read_b128 v[184:187], v19 offset:32768
    v_mfma_f32_32x32x16_bf16 v[96:111], a[36:39], v[200:203], v[96:111]
    ds_read_b128 v[188:191], v19 offset:36864
    buffer_load_dwordx4 v9, s[44:47], s35 offen lds
    s_add_u32 m0, s4, 12288
    s_add_u32 s35, s9, 1032192
    v_mfma_f32_32x32x16_bf16 v[112:127], a[36:39], v[204:207], v[112:127]
    ds_read_b128 v[192:195], v19 offset:40960
    s_waitcnt lgkmcnt(7)
    v_mfma_f32_32x32x16_bf16 v[32:47], a[40:43], v[160:163], v[32:47]
    ds_read_b128 v[196:199], v19 offset:45056
    buffer_load_dwordx4 v10, s[48:51], s35 offen lds
    v_mfma_f32_32x32x16_bf16 v[48:63], a[40:43], v[164:167], v[48:63]
    ds_read_b128 v[200:203], v19 offset:49152
    v_mfma_f32_32x32x16_bf16 v[64:79], a[40:43], v[168:171], v[64:79]
    ds_read_b128 v[204:207], v19 offset:53248
    v_mfma_f32_32x32x16_bf16 v[80:95], a[40:43], v[172:175], v[80:95]
    s_waitcnt lgkmcnt(4)
    v_mfma_f32_32x32x16_bf16 v[96:111], a[40:43], v[176:179], v[96:111]
    v_mfma_f32_32x32x16_bf16 v[112:127], a[40:43], v[180:183], v[112:127]
    s_waitcnt vmcnt(10) lgkmcnt(0)
    s_barrier
    ds_read_b64_tr_b16 a[48:49], v25 offset:57344
    ds_read_b64_tr_b16 a[50:51], v25 offset:57856
    ds_read_b128 v[160:163], v20 offset:8192
    s_add_u32 m0, s4, 40960
    s_add_u32 s35, s9, 1146880
    v_mfma_f32_32x32x16_bf16 v[32:47], a[44:47], v[184:187], v[32:47]
    ds_read_b128 v[164:167], v20 offset:12288
    ds_read_b128 v[168:171], v20 offset:16384
    ds_read_b128 v[172:175], v20 offset:20480
    buffer_load_dwordx4 v9, s[44:47], s35 offen lds
    v_mfma_f32_32x32x16_bf16 v[48:63], a[44:47], v[188:191], v[48:63]
    ds_read_b128 v[176:179], v20 offset:24576
    s_add_u32 m0, s4, 45056
    s_add_u32 s35, s9, 1146880
    v_mfma_f32_32x32x16_bf16 v[64:79], a[44:47], v[192:195], v[64:79]
    ds_read_b128 v[180:183], v20 offset:28672
    buffer_load_dwordx4 v10, s[48:51], s35 offen lds
    s_add_u32 m0, s4, 57344
    s_add_u32 s35, s60, 640
    v_mfma_f32_32x32x16_bf16 v[80:95], a[44:47], v[196:199], v[80:95]
    ds_read_b64_tr_b16 a[52:53], v25 offset:59392
    ds_read_b64_tr_b16 a[54:55], v25 offset:59904
    ds_read_b128 v[184:187], v21 offset:8192
    v_mfma_f32_32x32x16_bf16 v[96:111], a[44:47], v[200:203], v[96:111]
    ds_read_b128 v[188:191], v21 offset:12288
    buffer_load_dwordx4 v8, s[40:43], s35 offen lds
    s_add_u32 m0, s4, 61440
    s_add_u32 s35, s61, 640
    v_mfma_f32_32x32x16_bf16 v[112:127], a[44:47], v[204:207], v[112:127]
    ds_read_b128 v[192:195], v21 offset:16384
    s_waitcnt lgkmcnt(7)
    v_mfma_f32_32x32x16_bf16 v[32:47], a[48:51], v[160:163], v[32:47]
    ds_read_b128 v[196:199], v21 offset:20480
    buffer_load_dwordx4 v8, s[40:43], s35 offen lds
    s_add_u32 m0, s4, 65536
    s_add_u32 s35, s62, 640
    v_mfma_f32_32x32x16_bf16 v[48:63], a[48:51], v[164:167], v[48:63]
    ds_read_b128 v[200:203], v21 offset:24576
    v_mfma_f32_32x32x16_bf16 v[64:79], a[48:51], v[168:171], v[64:79]
    ds_read_b128 v[204:207], v21 offset:28672
    buffer_load_dwordx4 v8, s[40:43], s35 offen lds
    s_add_u32 m0, s4, 69632
    s_add_u32 s35, s63, 640
    v_mfma_f32_32x32x16_bf16 v[80:95], a[48:51], v[172:175], v[80:95]
    ds_read_b64_tr_b16 a[56:57], v26 offset:0
    ds_read_b64_tr_b16 a[58:59], v26 offset:512
    ds_read_b128 v[160:163], v22 offset:8192
    s_waitcnt lgkmcnt(7)
    v_mfma_f32_32x32x16_bf16 v[96:111], a[48:51], v[176:179], v[96:111]
    ds_read_b128 v[164:167], v22 offset:12288
    buffer_load_dwordx4 v8, s[40:43], s35 offen lds
    s_add_u32 m0, s4, 73728
    s_add_u32 s35, s64, 640
    v_mfma_f32_32x32x16_bf16 v[112:127], a[48:51], v[180:183], v[112:127]
    ds_read_b128 v[168:171], v22 offset:16384
    v_mfma_f32_32x32x16_bf16 v[32:47], a[52:55], v[184:187], v[32:47]
    ds_read_b128 v[172:175], v22 offset:20480
    buffer_load_dwordx4 v8, s[40:43], s35 offen lds
    s_add_u32 m0, s4, 77824
    s_add_u32 s35, s65, 640
    v_mfma_f32_32x32x16_bf16 v[48:63], a[52:55], v[188:191], v[48:63]
    ds_read_b128 v[176:179], v22 offset:24576
    s_waitcnt lgkmcnt(7)
    v_mfma_f32_32x32x16_bf16 v[64:79], a[52:55], v[192:195], v[64:79]
    ds_read_b128 v[180:183], v22 offset:28672
    buffer_load_dwordx4 v8, s[40:43], s35 offen lds
    s_add_u32 m0, s4, 49152
    s_add_u32 s35, s9, 1261568
    v_mfma_f32_32x32x16_bf16 v[80:95], a[52:55], v[196:199], v[80:95]
    ds_read_b64_tr_b16 a[60:61], v26 offset:2048
    ds_read_b64_tr_b16 a[62:63], v26 offset:2560
    ds_read_b128 v[184:187], v23 offset:8192
    v_mfma_f32_32x32x16_bf16 v[96:111], a[52:55], v[200:203], v[96:111]
    ds_read_b128 v[188:191], v23 offset:12288
    buffer_load_dwordx4 v9, s[44:47], s35 offen lds
    s_add_u32 m0, s4, 53248
    s_add_u32 s35, s9, 1261568
    v_mfma_f32_32x32x16_bf16 v[112:127], a[52:55], v[204:207], v[112:127]
    ds_read_b128 v[192:195], v23 offset:16384
    s_waitcnt lgkmcnt(7)
    v_mfma_f32_32x32x16_bf16 v[32:47], a[56:59], v[160:163], v[32:47]
    ds_read_b128 v[196:199], v23 offset:20480
    buffer_load_dwordx4 v10, s[48:51], s35 offen lds
    v_mfma_f32_32x32x16_bf16 v[48:63], a[56:59], v[164:167], v[48:63]
    ds_read_b128 v[200:203], v23 offset:24576
    v_mfma_f32_32x32x16_bf16 v[64:79], a[56:59], v[168:171], v[64:79]
    ds_read_b128 v[204:207], v23 offset:28672
    v_mfma_f32_32x32x16_bf16 v[80:95], a[56:59], v[172:175], v[80:95]
    s_waitcnt lgkmcnt(4)
    v_mfma_f32_32x32x16_bf16 v[96:111], a[56:59], v[176:179], v[96:111]
    v_mfma_f32_32x32x16_bf16 v[112:127], a[56:59], v[180:183], v[112:127]
    s_waitcnt vmcnt(10) lgkmcnt(0)
    s_barrier
    ds_read_b64_tr_b16 a[64:65], v24 offset:0
    ds_read_b64_tr_b16 a[66:67], v24 offset:512
    ds_read_b128 v[160:163], v12 offset:16384
    s_add_u32 m0, s4, 81920
    s_add_u32 s35, s9, 1376256
    v_mfma_f32_32x32x16_bf16 v[32:47], a[60:63], v[184:187], v[32:47]
    ds_read_b128 v[164:167], v12 offset:20480
    ds_read_b128 v[168:171], v12 offset:24576
    ds_read_b128 v[172:175], v12 offset:28672
    buffer_load_dwordx4 v9, s[44:47], s35 offen lds
    v_mfma_f32_32x32x16_bf16 v[48:63], a[60:63], v[188:191], v[48:63]
    ds_read_b128 v[176:179], v12 offset:32768
    s_add_u32 m0, s4, 86016
    s_add_u32 s35, s9, 1376256
    v_mfma_f32_32x32x16_bf16 v[64:79], a[60:63], v[192:195], v[64:79]
    ds_read_b128 v[180:183], v12 offset:36864
    buffer_load_dwordx4 v10, s[48:51], s35 offen lds
    s_add_u32 m0, s4, 98304
    s_add_u32 s35, s60, 768
    v_mfma_f32_32x32x16_bf16 v[80:95], a[60:63], v[196:199], v[80:95]
    ds_read_b64_tr_b16 a[68:69], v24 offset:2048
    ds_read_b64_tr_b16 a[70:71], v24 offset:2560
    ds_read_b128 v[184:187], v13 offset:16384
    v_mfma_f32_32x32x16_bf16 v[96:111], a[60:63], v[200:203], v[96:111]
    ds_read_b128 v[188:191], v13 offset:20480
    buffer_load_dwordx4 v8, s[40:43], s35 offen lds
    s_add_u32 m0, s4, 102400
    s_add_u32 s35, s61, 768
    v_mfma_f32_32x32x16_bf16 v[112:127], a[60:63], v[204:207], v[112:127]
    ds_read_b128 v[192:195], v13 offset:24576
    s_waitcnt lgkmcnt(7)
    v_mfma_f32_32x32x16_bf16 v[32:47], a[64:67], v[160:163], v[32:47]
    ds_read_b128 v[196:199], v13 offset:28672
    buffer_load_dwordx4 v8, s[40:43], s35 offen lds
    s_add_u32 m0, s4, 106496
    s_add_u32 s35, s62, 768
    v_mfma_f32_32x32x16_bf16 v[48:63], a[64:67], v[164:167], v[48:63]
    ds_read_b128 v[200:203], v13 offset:32768
    v_mfma_f32_32x32x16_bf16 v[64:79], a[64:67], v[168:171], v[64:79]
    ds_read_b128 v[204:207], v13 offset:36864
    buffer_load_dwordx4 v8, s[40:43], s35 offen lds
    s_add_u32 m0, s4, 110592
    s_add_u32 s35, s63, 768
    v_mfma_f32_32x32x16_bf16 v[80:95], a[64:67], v[172:175], v[80:95]
    ds_read_b64_tr_b16 a[72:73], v24 offset:8192
    ds_read_b64_tr_b16 a[74:75], v24 offset:8704
    ds_read_b128 v[160:163], v14 offset:16384
    s_waitcnt lgkmcnt(7)
    v_mfma_f32_32x32x16_bf16 v[96:111], a[64:67], v[176:179], v[96:111]
    ds_read_b128 v[164:167], v14 offset:20480
    buffer_load_dwordx4 v8, s[40:43], s35 offen lds
    s_add_u32 m0, s4, 114688
    s_add_u32 s35, s64, 768
    v_mfma_f32_32x32x16_bf16 v[112:127], a[64:67], v[180:183], v[112:127]
    ds_read_b128 v[168:171], v14 offset:24576
    v_mfma_f32_32x32x16_bf16 v[32:47], a[68:71], v[184:187], v[32:47]
    ds_read_b128 v[172:175], v14 offset:28672
    buffer_load_dwordx4 v8, s[40:43], s35 offen lds
    s_add_u32 m0, s4, 118784
    s_add_u32 s35, s65, 768
    v_mfma_f32_32x32x16_bf16 v[48:63], a[68:71], v[188:191], v[48:63]
    ds_read_b128 v[176:179], v14 offset:32768
    s_waitcnt lgkmcnt(7)
    v_mfma_f32_32x32x16_bf16 v[64:79], a[68:71], v[192:195], v[64:79]
    ds_read_b128 v[180:183], v14 offset:36864
    buffer_load_dwordx4 v8, s[40:43], s35 offen lds
    s_add_u32 m0, s4, 90112
    s_add_u32 s35, s9, 1490944
    v_mfma_f32_32x32x16_bf16 v[80:95], a[68:71], v[196:199], v[80:95]
    ds_read_b64_tr_b16 a[76:77], v24 offset:10240
    ds_read_b64_tr_b16 a[78:79], v24 offset:10752
    ds_read_b128 v[184:187], v15 offset:16384
    v_mfma_f32_32x32x16_bf16 v[96:111], a[68:71], v[200:203], v[96:111]
    ds_read_b128 v[188:191], v15 offset:20480
    buffer_load_dwordx4 v9, s[44:47], s35 offen lds
    s_add_u32 m0, s4, 94208
    s_add_u32 s35, s9, 1490944
    v_mfma_f32_32x32x16_bf16 v[112:127], a[68:71], v[204:207], v[112:127]
    ds_read_b128 v[192:195], v15 offset:24576
    s_waitcnt lgkmcnt(7)
    v_mfma_f32_32x32x16_bf16 v[32:47], a[72:75], v[160:163], v[32:47]
    ds_read_b128 v[196:199], v15 offset:28672
    buffer_load_dwordx4 v10, s[48:51], s35 offen lds
    v_mfma_f32_32x32x16_bf16 v[48:63], a[72:75], v[164:167], v[48:63]
    ds_read_b128 v[200:203], v15 offset:32768
    v_mfma_f32_32x32x16_bf16 v[64:79], a[72:75], v[168:171], v[64:79]
    ds_read_b128 v[204:207], v15 offset:36864
    v_mfma_f32_32x32x16_bf16 v[80:95], a[72:75], v[172:175], v[80:95]
    s_waitcnt lgkmcnt(4)
    v_mfma_f32_32x32x16_bf16 v[96:111], a[72:75], v[176:179], v[96:111]
    v_mfma_f32_32x32x16_bf16 v[112:127], a[72:75], v[180:183], v[112:127]
    s_waitcnt vmcnt(10) lgkmcnt(0)
    s_barrier
    ds_read_b64_tr_b16 a[80:81], v24 offset:40960
    ds_read_b64_tr_b16 a[82:83], v24 offset:41472
    ds_read_b128 v[160:163], v12 offset:57344
    s_add_u32 m0, s4, 122880
    s_add_u32 s35, s66, 0
    v_mfma_f32_32x32x16_bf16 v[32:47], a[76:79], v[184:187], v[32:47]
    ds_read_b128 v[164:167], v12 offset:61440
    ds_read_b128 v[168:171], v16 offset:0
    ds_read_b128 v[172:175], v16 offset:4096
    buffer_load_dwordx4 v8, s[40:43], s35 offen lds
    v_mfma_f32_32x32x16_bf16 v[48:63], a[76:79], v[188:191], v[48:63]
    ds_read_b128 v[176:179], v16 offset:8192
    s_add_u32 m0, s4, 126976
    s_add_u32 s35, s66, 128
    v_mfma_f32_32x32x16_bf16 v[64:79], a[76:79], v[192:195], v[64:79]
    ds_read_b128 v[180:183], v16 offset:12288
    buffer_load_dwordx4 v8, s[40:43], s35 offen lds
    s_add_u32 m0, s4, 131072
    s_add_u32 s35, s66, 256
    v_mfma_f32_32x32x16_bf16 v[80:95], a[76:79], v[196:199], v[80:95]
    ds_read_b64_tr_b16 a[84:85], v24 offset:43008
    ds_read_b64_tr_b16 a[86:87], v24 offset:43520
    ds_read_b128 v[184:187], v13 offset:57344
    v_mfma_f32_32x32x16_bf16 v[96:111], a[76:79], v[200:203], v[96:111]
    ds_read_b128 v[188:191], v13 offset:61440
    buffer_load_dwordx4 v8, s[40:43], s35 offen lds
    s_add_u32 m0, s4, 135168
    s_add_u32 s35, s66, 384
    v_mfma_f32_32x32x16_bf16 v[112:127], a[76:79], v[204:207], v[112:127]
    ds_read_b128 v[192:195], v17 offset:0
    s_waitcnt lgkmcnt(7)
    v_mfma_f32_32x32x16_bf16 v[32:47], a[80:83], v[160:163], v[32:47]
    ds_read_b128 v[196:199], v17 offset:4096
    buffer_load_dwordx4 v8, s[40:43], s35 offen lds
    s_add_u32 m0, s4, 139264
    s_add_u32 s35, s66, 512
    v_mfma_f32_32x32x16_bf16 v[48:63], a[80:83], v[164:167], v[48:63]
    ds_read_b128 v[200:203], v17 offset:8192
    v_mfma_f32_32x32x16_bf16 v[64:79], a[80:83], v[168:171], v[64:79]
    ds_read_b128 v[204:207], v17 offset:12288
    buffer_load_dwordx4 v8, s[40:43], s35 offen lds
    s_add_u32 m0, s4, 143360
    s_add_u32 s35, s66, 640
    v_mfma_f32_32x32x16_bf16 v[80:95], a[80:83], v[172:175], v[80:95]
    ds_read_b64_tr_b16 a[88:89], v24 offset:49152
    ds_read_b64_tr_b16 a[90:91], v24 offset:49664
    ds_read_b128 v[160:163], v14 offset:57344
    s_waitcnt lgkmcnt(7)
    v_mfma_f32_32x32x16_bf16 v[96:111], a[80:83], v[176:179], v[96:111]
    ds_read_b128 v[164:167], v14 offset:61440
    buffer_load_dwordx4 v8, s[40:43], s35 offen lds
    s_add_u32 m0, s4, 147456
    s_add_u32 s35, s66, 768
    v_mfma_f32_32x32x16_bf16 v[112:127], a[80:83], v[180:183], v[112:127]
    ds_read_b128 v[168:171], v18 offset:0
    v_mfma_f32_32x32x16_bf16 v[32:47], a[84:87], v[184:187], v[32:47]
    ds_read_b128 v[172:175], v18 offset:4096
    buffer_load_dwordx4 v8, s[40:43], s35 offen lds
    v_mfma_f32_32x32x16_bf16 v[48:63], a[84:87], v[188:191], v[48:63]
    ds_read_b128 v[176:179], v18 offset:8192
    s_waitcnt lgkmcnt(7)
    v_mfma_f32_32x32x16_bf16 v[64:79], a[84:87], v[192:195], v[64:79]
    ds_read_b128 v[180:183], v18 offset:12288
    v_mfma_f32_32x32x16_bf16 v[80:95], a[84:87], v[196:199], v[80:95]
    ds_read_b64_tr_b16 a[92:93], v24 offset:51200
    ds_read_b64_tr_b16 a[94:95], v24 offset:51712
    ds_read_b128 v[184:187], v15 offset:57344
    v_mfma_f32_32x32x16_bf16 v[96:111], a[84:87], v[200:203], v[96:111]
    ds_read_b128 v[188:191], v15 offset:61440
    v_mfma_f32_32x32x16_bf16 v[112:127], a[84:87], v[204:207], v[112:127]
    ds_read_b128 v[192:195], v19 offset:0
    s_waitcnt lgkmcnt(7)
    v_mfma_f32_32x32x16_bf16 v[32:47], a[88:91], v[160:163], v[32:47]
    ds_read_b128 v[196:199], v19 offset:4096
    v_mfma_f32_32x32x16_bf16 v[48:63], a[88:91], v[164:167], v[48:63]
    ds_read_b128 v[200:203], v19 offset:8192
    v_mfma_f32_32x32x16_bf16 v[64:79], a[88:91], v[168:171], v[64:79]
    ds_read_b128 v[204:207], v19 offset:12288
    v_mfma_f32_32x32x16_bf16 v[80:95], a[88:91], v[172:175], v[80:95]
    s_waitcnt lgkmcnt(4)
    v_mfma_f32_32x32x16_bf16 v[96:111], a[88:91], v[176:179], v[96:111]
    v_mfma_f32_32x32x16_bf16 v[112:127], a[88:91], v[180:183], v[112:127]
    s_waitcnt vmcnt(7) lgkmcnt(0)
    s_barrier
    ds_read_b64_tr_b16 a[96:97], v25 offset:16384
    ds_read_b64_tr_b16 a[98:99], v25 offset:16896
    ds_read_b128 v[160:163], v16 offset:32768
    s_add_u32 m0, s4, 0
    s_add_u32 s35, s67, 0
    v_mfma_f32_32x32x16_bf16 v[32:47], a[92:95], v[184:187], v[32:47]
    ds_read_b128 v[164:167], v16 offset:36864
    ds_read_b128 v[168:171], v16 offset:40960
    ds_read_b128 v[172:175], v16 offset:45056
    buffer_load_dwordx4 v8, s[40:43], s35 offen lds
    v_mfma_f32_32x32x16_bf16 v[48:63], a[92:95], v[188:191], v[48:63]
    ds_read_b128 v[176:179], v16 offset:49152
    s_add_u32 m0, s4, 4096
    s_add_u32 s35, s67, 128
    v_mfma_f32_32x32x16_bf16 v[64:79], a[92:95], v[192:195], v[64:79]
    ds_read_b128 v[180:183], v16 offset:53248
    buffer_load_dwordx4 v8, s[40:43], s35 offen lds
    s_add_u32 m0, s4, 8192
    s_add_u32 s35, s67, 256
    v_mfma_f32_32x32x16_bf16 v[80:95], a[92:95], v[196:199], v[80:95]
    ds_read_b64_tr_b16 a[100:101], v25 offset:18432
    ds_read_b64_tr_b16 a[102:103], v25 offset:18944
    ds_read_b128 v[184:187], v17 offset:32768
    v_mfma_f32_32x32x16_bf16 v[96:111], a[92:95], v[200:203], v[96:111]
    ds_read_b128 v[188:191], v17 offset:36864
    buffer_load_dwordx4 v8, s[40:43], s35 offen lds
    s_add_u32 m0, s4, 12288
    s_add_u32 s35, s67, 384
    v_mfma_f32_32x32x16_bf16 v[112:127], a[92:95], v[204:207], v[112:127]
    ds_read_b128 v[192:195], v17 offset:40960
    s_waitcnt lgkmcnt(7)
    v_mfma_f32_32x32x16_bf16 v[32:47], a[96:99], v[160:163], v[32:47]
    ds_read_b128 v[196:199], v17 offset:45056
    buffer_load_dwordx4 v8, s[40:43], s35 offen lds
    s_add_u32 m0, s4, 16384
    s_add_u32 s35, s67, 512
    v_mfma_f32_32x32x16_bf16 v[48:63], a[96:99], v[164:167], v[48:63]
    ds_read_b128 v[200:203], v17 offset:49152
    v_mfma_f32_32x32x16_bf16 v[64:79], a[96:99], v[168:171], v[64:79]
    ds_read_b128 v[204:207], v17 offset:53248
    buffer_load_dwordx4 v8, s[40:43], s35 offen lds
    s_add_u32 m0, s4, 20480
    s_add_u32 s35, s67, 640
    v_mfma_f32_32x32x16_bf16 v[80:95], a[96:99], v[172:175], v[80:95]
    ds_read_b64_tr_b16 a[104:105], v25 offset:24576
    ds_read_b64_tr_b16 a[106:107], v25 offset:25088
    ds_read_b128 v[160:163], v18 offset:32768
    s_waitcnt lgkmcnt(7)
    v_mfma_f32_32x32x16_bf16 v[96:111], a[96:99], v[176:179], v[96:111]
    ds_read_b128 v[164:167], v18 offset:36864
    buffer_load_dwordx4 v8, s[40:43], s35 offen lds
    s_add_u32 m0, s4, 24576
    s_add_u32 s35, s67, 768
    v_mfma_f32_32x32x16_bf16 v[112:127], a[96:99], v[180:183], v[112:127]
    ds_read_b128 v[168:171], v18 offset:40960
    v_mfma_f32_32x32x16_bf16 v[32:47], a[100:103], v[184:187], v[32:47]
    ds_read_b128 v[172:175], v18 offset:45056
    buffer_load_dwordx4 v8, s[40:43], s35 offen lds
    v_mfma_f32_32x32x16_bf16 v[48:63], a[100:103], v[188:191], v[48:63]
    ds_read_b128 v[176:179], v18 offset:49152
    s_waitcnt lgkmcnt(7)
    v_mfma_f32_32x32x16_bf16 v[64:79], a[100:103], v[192:195], v[64:79]
    ds_read_b128 v[180:183], v18 offset:53248
    v_mfma_f32_32x32x16_bf16 v[80:95], a[100:103], v[196:199], v[80:95]
    ds_read_b64_tr_b16 a[108:109], v25 offset:26624
    ds_read_b64_tr_b16 a[110:111], v25 offset:27136
    ds_read_b128 v[184:187], v19 offset:32768
    v_mfma_f32_32x32x16_bf16 v[96:111], a[100:103], v[200:203], v[96:111]
    ds_read_b128 v[188:191], v19 offset:36864
    v_mfma_f32_32x32x16_bf16 v[112:127], a[100:103], v[204:207], v[112:127]
    ds_read_b128 v[192:195], v19 offset:40960
    s_waitcnt lgkmcnt(7)
    v_mfma_f32_32x32x16_bf16 v[32:47], a[104:107], v[160:163], v[32:47]
    ds_read_b128 v[196:199], v19 offset:45056
    v_mfma_f32_32x32x16_bf16 v[48:63], a[104:107], v[164:167], v[48:63]
    ds_read_b128 v[200:203], v19 offset:49152
    v_mfma_f32_32x32x16_bf16 v[64:79], a[104:107], v[168:171], v[64:79]
    ds_read_b128 v[204:207], v19 offset:53248
    v_mfma_f32_32x32x16_bf16 v[80:95], a[104:107], v[172:175], v[80:95]
    s_waitcnt lgkmcnt(4)
    v_mfma_f32_32x32x16_bf16 v[96:111], a[104:107], v[176:179], v[96:111]
    v_mfma_f32_32x32x16_bf16 v[112:127], a[104:107], v[180:183], v[112:127]
    s_waitcnt vmcnt(7) lgkmcnt(0)
    s_barrier
    ds_read_b128 v[160:163], v16 offset:57344
    ds_read_b128 v[164:167], v17 offset:57344
    ds_read_b128 v[168:171], v18 offset:57344
    s_add_u32 m0, s4, 28672
    s_add_u32 s35, s68, 0
    v_mfma_f32_32x32x16_bf16 v[32:47], a[108:111], v[184:187], v[32:47]
    ds_read_b128 v[172:175], v19 offset:57344
    buffer_load_dwordx4 v8, s[40:43], s35 offen lds
    s_add_u32 m0, s4, 32768
    s_add_u32 s35, s68, 128
    v_mfma_f32_32x32x16_bf16 v[48:63], a[108:111], v[188:191], v[48:63]
    ds_read_b128 v[176:179], v16 offset:61440
    v_mfma_f32_32x32x16_bf16 v[64:79], a[108:111], v[192:195], v[64:79]
    ds_read_b128 v[180:183], v17 offset:61440
    buffer_load_dwordx4 v8, s[40:43], s35 offen lds
    s_add_u32 m0, s4, 36864
    s_add_u32 s35, s68, 256
    s_nop 0
    v_mul_f32 v32, s14, v32
    v_mfma_f32_32x32x16_bf16 v[80:95], a[108:111], v[196:199], v[80:95]
    ds_read_b128 v[184:187], v18 offset:61440
    v_mul_f32 v33, s14, v33
    v_mul_f32 v34, s14, v34
    v_mul_f32 v35, s14, v35
    v_mul_f32 v36, s14, v36
    v_mul_f32 v37, s14, v37
    v_mul_f32 v38, s14, v38
    v_mfma_f32_32x32x16_bf16 v[96:111], a[108:111], v[200:203], v[96:111]
    ds_read_b128 v[188:191], v19 offset:61440
    buffer_load_dwordx4 v8, s[40:43], s35 offen lds
    s_add_u32 m0, s4, 40960
    s_add_u32 s35, s68, 384
    v_mul_f32 v39, s14, v39
    v_mfma_f32_32x32x16_bf16 v[112:127], a[108:111], v[204:207], v[112:127]
    ds_read_b128 v[192:195], v20 offset:0
    v_exp_f32 v32, v32
    v_exp_f32 v33, v33
    v_exp_f32 v34, v34
    s_waitcnt lgkmcnt(5)
    v_mfma_f32_32x32x16_bf16 v[128:143], a[0:3], v[160:163], 0
    ds_read_b128 v[196:199], v21 offset:0
    buffer_load_dwordx4 v8, s[40:43], s35 offen lds
    s_add_u32 m0, s4, 45056
    s_add_u32 s35, s68, 512
    v_mfma_f32_32x32x16_bf16 v[128:143], a[4:7], v[164:167], v[128:143]
    ds_read_b128 v[200:203], v22 offset:0
    v_exp_f32 v35, v35
    v_exp_f32 v36, v36
    v_exp_f32 v37, v37
    v_mfma_f32_32x32x16_bf16 v[128:143], a[8:11], v[168:171], v[128:143]
    ds_read_b128 v[204:207], v23 offset:0
    buffer_load_dwordx4 v8, s[40:43], s35 offen lds
    s_add_u32 m0, s4, 49152
    s_add_u32 s35, s68, 640
    v_mfma_f32_32x32x16_bf16 v[128:143], a[12:15], v[172:175], v[128:143]
    ds_read_b128 v[160:163], v20 offset:4096
    v_exp_f32 v38, v38
    v_exp_f32 v39, v39
    v_add_f32 v32, 1.0, v32
    v_add_f32 v33, 1.0, v33
    s_waitcnt lgkmcnt(5)
    v_mfma_f32_32x32x16_bf16 v[128:143], a[16:19], v[176:179], v[128:143]
    ds_read_b128 v[164:167], v21 offset:4096
    buffer_load_dwordx4 v8, s[40:43], s35 offen lds
    s_add_u32 m0, s4, 53248
    s_add_u32 s35, s68, 768
    v_mfma_f32_32x32x16_bf16 v[128:143], a[20:23], v[180:183], v[128:143]
    ds_read_b128 v[168:171], v22 offset:4096
    v_add_f32 v34, 1.0, v34
    v_add_f32 v35, 1.0, v35
    v_add_f32 v36, 1.0, v36
    v_add_f32 v37, 1.0, v37
    v_add_f32 v38, 1.0, v38
    v_add_f32 v39, 1.0, v39
    v_mfma_f32_32x32x16_bf16 v[128:143], a[24:27], v[184:187], v[128:143]
    ds_read_b128 v[172:175], v23 offset:4096
    buffer_load_dwordx4 v8, s[40:43], s35 offen lds
    v_rcp_f32 v32, v32
    v_mfma_f32_32x32x16_bf16 v[128:143], a[28:31], v[188:191], v[128:143]
    ds_read_b128 v[176:179], v20 offset:8192
    s_add_u32 s95, s94, 0
    s_and_b32 s95, s95, 3
    s_sub_i32 s95, s97, s95
    s_add_i32 s35, s95, 7
    s_cmp_lt_i32 s95, 0
    s_cselect_b32 s95, s35, s95
    s_mul_i32 s95, s95, 57344
    s_add_u32 s95, s95, s32
    s_add_u32 m0, s34, 0
    s_add_u32 s35, s95, 0
    buffer_load_dwordx4 v29, s[20:23], s35 offen lds
    s_add_u32 m0, s34, 1024
    s_add_u32 s35, s95, 7168
    buffer_load_dwordx4 v29, s[20:23], s35 offen lds
    s_waitcnt lgkmcnt(5)
    v_mfma_f32_32x32x16_bf16 v[128:143], a[32:35], v[192:195], v[128:143]
    ds_read_b128 v[180:183], v21 offset:8192
    s_add_u32 m0, s34, 2048
    s_add_u32 s35, s95, 14336
    buffer_load_dwordx4 v29, s[20:23], s35 offen lds
    s_add_u32 m0, s34, 3072
    s_add_u32 s35, s95, 21504
    buffer_load_dwordx4 v29, s[20:23], s35 offen lds
    v_mfma_f32_32x32x16_bf16 v[128:143], a[36:39], v[196:199], v[128:143]
    ds_read_b128 v[184:187], v22 offset:8192
    s_add_u32 m0, s34, 4096
    s_add_u32 s35, s95, 28672
    buffer_load_dwordx4 v29, s[20:23], s35 offen lds
    s_add_u32 m0, s34, 5120
    s_add_u32 s35, s95, 35840
    buffer_load_dwordx4 v29, s[20:23], s35 offen lds
    v_mfma_f32_32x32x16_bf16 v[128:143], a[40:43], v[200:203], v[128:143]
    ds_read_b128 v[188:191], v23 offset:8192
    s_add_u32 m0, s34, 6144
    s_add_u32 s35, s95, 43008
    buffer_load_dwordx4 v29, s[20:23], s35 offen lds
    s_add_u32 m0, s34, 7168
    s_add_u32 s35, s95, 50176
    buffer_load_dwordx4 v29, s[20:23], s35 offen lds
    v_mfma_f32_32x32x16_bf16 v[128:143], a[44:47], v[204:207], v[128:143]
    ds_read_b128 v[192:195], v20 offset:12288
    v_rcp_f32 v33, v33
    v_rcp_f32 v34, v34
    v_rcp_f32 v35, v35
    s_waitcnt lgkmcnt(5)
    v_mfma_f32_32x32x16_bf16 v[128:143], a[48:51], v[160:163], v[128:143]
    ds_read_b128 v[196:199], v21 offset:12288
    v_rcp_f32 v36, v36
    v_rcp_f32 v37, v37
    v_mfma_f32_32x32x16_bf16 v[128:143], a[52:55], v[164:167], v[128:143]
    ds_read_b128 v[200:203], v22 offset:12288
    v_rcp_f32 v38, v38
    v_rcp_f32 v39, v39
    v_mul_f32 v32, v32, v40
    v_mul_f32 v33, v33, v41
    v_mfma_f32_32x32x16_bf16 v[128:143], a[56:59], v[168:171], v[128:143]
    ds_read_b128 v[204:207], v23 offset:12288
    v_mul_f32 v34, v34, v42
    v_mul_f32 v35, v35, v43
    v_mul_f32 v36, v36, v44
    v_mul_f32 v37, v37, v45
    v_mul_f32 v38, v38, v46
    v_mul_f32 v39, v39, v47
    v_mfma_f32_32x32x16_bf16 v[128:143], a[60:63], v[172:175], v[128:143]
    ds_read_b128 v[160:163], v20 offset:16384
    v_cvt_pk_bf16_f32 v32, v32, v33
    v_cvt_pk_bf16_f32 v33, v34, v35
    v_cvt_pk_bf16_f32 v34, v36, v37
    v_cvt_pk_bf16_f32 v35, v38, v39
    s_waitcnt lgkmcnt(5)
    v_mfma_f32_32x32x16_bf16 v[128:143], a[64:67], v[176:179], v[128:143]
    ds_read_b128 v[164:167], v21 offset:16384
    s_add_u32 s6, s10, s72
    buffer_store_dwordx4 v[32:35], v11, s[52:55], s6 offen sc1
    v_mul_f32 v48, s14, v48
    v_mul_f32 v49, s14, v49
    v_mfma_f32_32x32x16_bf16 v[128:143], a[68:71], v[180:183], v[128:143]
    ds_read_b128 v[168:171], v22 offset:16384
    v_mul_f32 v50, s14, v50
    v_mul_f32 v51, s14, v51
    v_mul_f32 v52, s14, v52
    v_mul_f32 v53, s14, v53
    v_mul_f32 v54, s14, v54
    v_mul_f32 v55, s14, v55
    v_mfma_f32_32x32x16_bf16 v[128:143], a[72:75], v[184:187], v[128:143]
    ds_read_b128 v[172:175], v23 offset:16384
    v_exp_f32 v48, v48
    v_exp_f32 v49, v49
    v_exp_f32 v50, v50
    v_mfma_f32_32x32x16_bf16 v[128:143], a[76:79], v[188:191], v[128:143]
    v_exp_f32 v51, v51
    v_exp_f32 v52, v52
    v_exp_f32 v53, v53
    s_waitcnt lgkmcnt(4)
    v_mfma_f32_32x32x16_bf16 v[128:143], a[80:83], v[192:195], v[128:143]
    v_exp_f32 v54, v54
    v_exp_f32 v55, v55
    v_add_f32 v48, 1.0, v48
    v_add_f32 v49, 1.0, v49
    v_mfma_f32_32x32x16_bf16 v[128:143], a[84:87], v[196:199], v[128:143]
    s_waitcnt vmcnt(16) lgkmcnt(0)
    s_barrier
    ds_read_b128 v[176:179], v12 offset:0
    ds_read_b128 v[180:183], v13 offset:0
    ds_read_b128 v[184:187], v14 offset:0
    s_add_u32 m0, s4, 57344
    s_add_u32 s35, s69, 0
    v_add_f32 v50, 1.0, v50
    v_add_f32 v51, 1.0, v51
    v_mfma_f32_32x32x16_bf16 v[128:143], a[88:91], v[200:203], v[128:143]
    ds_read_b128 v[188:191], v15 offset:0
    buffer_load_dwordx4 v8, s[40:43], s35 offen lds
    s_add_u32 m0, s4, 61440
    s_add_u32 s35, s69, 128
    v_add_f32 v52, 1.0, v52
    v_mfma_f32_32x32x16_bf16 v[128:143], a[92:95], v[204:207], v[128:143]
    ds_read_b128 v[192:195], v12 offset:4096
    v_add_f32 v53, 1.0, v53
    v_add_f32 v54, 1.0, v54
    v_add_f32 v55, 1.0, v55
    v_rcp_f32 v48, v48
    v_mfma_f32_32x32x16_bf16 v[128:143], a[96:99], v[160:163], v[128:143]
    ds_read_b128 v[196:199], v13 offset:4096
    buffer_load_dwordx4 v8, s[40:43], s35 offen lds
    s_add_u32 m0, s4, 65536
    s_add_u32 s35, s69, 256
    v_mfma_f32_32x32x16_bf16 v[128:143], a[100:103], v[164:167], v[128:143]
    ds_read_b128 v[200:203], v14 offset:4096
    v_rcp_f32 v49, v49
    v_rcp_f32 v50, v50
    v_rcp_f32 v51, v51
    v_mfma_f32_32x32x16_bf16 v[128:143], a[104:107], v[168:171], v[128:143]
    ds_read_b128 v[204:207], v15 offset:4096
    buffer_load_dwordx4 v8, s[40:43], s35 offen lds
    s_add_u32 m0, s4, 69632
    s_add_u32 s35, s69, 384
    v_mfma_f32_32x32x16_bf16 v[128:143], a[108:111], v[172:175], v[128:143]
    ds_read_b128 v[160:163], v12 offset:8192
    v_rcp_f32 v52, v52
    v_rcp_f32 v53, v53
    v_rcp_f32 v54, v54
    s_waitcnt lgkmcnt(5)
    v_mfma_f32_32x32x16_bf16 v[144:159], a[0:3], v[176:179], 0
    ds_read_b128 v[164:167], v13 offset:8192
    buffer_load_dwordx4 v8, s[40:43], s35 offen lds
    s_add_u32 m0, s4, 73728
    s_add_u32 s35, s69, 512
    v_mfma_f32_32x32x16_bf16 v[144:159], a[4:7], v[180:183], v[144:159]
    ds_read_b128 v[168:171], v14 offset:8192
    v_rcp_f32 v55, v55
    v_mul_f32 v48, v48, v56
    v_mul_f32 v49, v49, v57
    v_mul_f32 v50, v50, v58
    v_mul_f32 v51, v51, v59
    v_mfma_f32_32x32x16_bf16 v[144:159], a[8:11], v[184:187], v[144:159]
    ds_read_b128 v[172:175], v15 offset:8192
    buffer_load_dwordx4 v8, s[40:43], s35 offen lds
    s_add_u32 m0, s4, 77824
    s_add_u32 s35, s69, 640
    v_mul_f32 v52, v52, v60
    v_mfma_f32_32x32x16_bf16 v[144:159], a[12:15], v[188:191], v[144:159]
    ds_read_b128 v[176:179], v12 offset:12288
    v_mul_f32 v53, v53, v61
    v_mul_f32 v54, v54, v62
    v_mul_f32 v55, v55, v63
    v_cvt_pk_bf16_f32 v48, v48, v49
    v_cvt_pk_bf16_f32 v49, v50, v51
    v_cvt_pk_bf16_f32 v50, v52, v53
    s_waitcnt lgkmcnt(5)
    v_mfma_f32_32x32x16_bf16 v[144:159], a[16:19], v[192:195], v[144:159]
    ds_read_b128 v[180:183], v13 offset:12288
    buffer_load_dwordx4 v8, s[40:43], s35 offen lds
    s_add_u32 m0, s4, 81920
    s_add_u32 s35, s69, 768
    v_mfma_f32_32x32x16_bf16 v[144:159], a[20:23], v[196:199], v[144:159]
    ds_read_b128 v[184:187], v14 offset:12288
    v_cvt_pk_bf16_f32 v51, v54, v55
    s_add_u32 s6, s10, s73
    buffer_store_dwordx4 v[48:51], v11, s[52:55], s6 offen sc1
    v_mul_f32 v64, s14, v64
    v_mul_f32 v65, s14, v65
    v_mfma_f32_32x32x16_bf16 v[144:159], a[24:27], v[200:203], v[144:159]
    ds_read_b128 v[188:191], v15 offset:12288
    buffer_load_dwordx4 v8, s[40:43], s35 offen lds
    buffer_load_dwordx2 v[208:209], v28, s[16:19], 0 offen sc1
    v_mfma_f32_32x32x16_bf16 v[144:159], a[28:31], v[204:207], v[144:159]
    ds_read_b128 v[192:195], v12 offset:16384
    v_mul_f32 v66, s14, v66
    v_mul_f32 v67, s14, v67
    v_mul_f32 v68, s14, v68
    v_mul_f32 v69, s14, v69
    v_mul_f32 v70, s14, v70
    v_mul_f32 v71, s14, v71
    s_waitcnt lgkmcnt(5)
    v_mfma_f32_32x32x16_bf16 v[144:159], a[32:35], v[160:163], v[144:159]
    ds_read_b128 v[196:199], v13 offset:16384
    v_exp_f32 v64, v64
    v_exp_f32 v65, v65
    v_mfma_f32_32x32x16_bf16 v[144:159], a[36:39], v[164:167], v[144:159]
    ds_read_b128 v[200:203], v14 offset:16384
    s_waitcnt vmcnt(16)
    ds_read_b64_tr_b16 a[144:145], v30 offset:0
    ds_read_b64_tr_b16 a[146:147], v30 offset:1024
    ds_read_b64_tr_b16 a[148:149], v31 offset:0
    ds_read_b64_tr_b16 a[150:151], v31 offset:1024
    v_exp_f32 v66, v66
    v_mfma_f32_32x32x16_bf16 v[144:159], a[40:43], v[168:171], v[144:159]
    ds_read_b128 v[204:207], v15 offset:16384
    s_waitcnt vmcnt(14)
    ds_read_b64_tr_b16 a[152:153], v30 offset:2048
    ds_read_b64_tr_b16 a[154:155], v30 offset:3072
    ds_read_b64_tr_b16 a[156:157], v31 offset:2048
    s_waitcnt lgkmcnt(7)
    ds_read_b64_tr_b16 a[158:159], v31 offset:3072
    v_exp_f32 v67, v67
    v_mfma_f32_32x32x16_bf16 v[144:159], a[44:47], v[172:175], v[144:159]
    ds_read_b128 v[160:163], v12 offset:20480
    s_waitcnt vmcnt(12)
    ds_read_b64_tr_b16 a[160:161], v30 offset:4096
    ds_read_b64_tr_b16 a[162:163], v30 offset:5120
    ds_read_b64_tr_b16 a[164:165], v31 offset:4096
    ds_read_b64_tr_b16 a[166:167], v31 offset:5120
    v_exp_f32 v68, v68
    v_mfma_f32_32x32x16_bf16 v[144:159], a[48:51], v[176:179], v[144:159]
    s_waitcnt vmcnt(10)
    ds_read_b64_tr_b16 a[168:169], v30 offset:6144
    ds_read_b64_tr_b16 a[170:171], v30 offset:7168
    s_waitcnt lgkmcnt(7)
    ds_read_b64_tr_b16 a[172:173], v31 offset:6144
    ds_read_b64_tr_b16 a[174:175], v31 offset:7168
    v_exp_f32 v69, v69
    v_mfma_f32_32x32x16_bf16 v[144:159], a[52:55], v[180:183], v[144:159]
    ds_read_b128 v[164:167], v13 offset:20480
    ds_read_b128 v[168:171], v14 offset:20480
    s_add_u32 s95, s94, 1
    s_and_b32 s95, s95, 3
    s_sub_i32 s95, s97, s95
    s_add_i32 s35, s95, 7
    s_cmp_lt_i32 s95, 0
    s_cselect_b32 s95, s35, s95
    s_mul_i32 s95, s95, 57344
    s_add_u32 s95, s95, s32
    s_add_u32 m0, s34, 0
    s_add_u32 s35, s95, 0
    buffer_load_dwordx4 v29, s[20:23], s35 offen lds
    s_add_u32 m0, s34, 1024
    s_add_u32 s35, s95, 7168
    buffer_load_dwordx4 v29, s[20:23], s35 offen lds
    v_mfma_f32_32x32x16_bf16 v[144:159], a[56:59], v[184:187], v[144:159]
    ds_read_b128 v[172:175], v15 offset:20480
    s_add_u32 m0, s34, 2048
    s_add_u32 s35, s95, 14336
    buffer_load_dwordx4 v29, s[20:23], s35 offen lds
    s_add_u32 m0, s34, 3072
    s_add_u32 s35, s95, 21504
    buffer_load_dwordx4 v29, s[20:23], s35 offen lds
    v_mfma_f32_32x32x16_bf16 v[144:159], a[60:63], v[188:191], v[144:159]
    ds_read_b128 v[176:179], v12 offset:24576
    v_exp_f32 v70, v70
    v_exp_f32 v71, v71
    v_add_f32 v64, 1.0, v64
    v_add_f32 v65, 1.0, v65
    v_mfma_f32_32x32x16_bf16 v[144:159], a[64:67], v[192:195], v[144:159]
    v_add_f32 v66, 1.0, v66
    v_add_f32 v67, 1.0, v67
    v_add_f32 v68, 1.0, v68
    v_add_f32 v69, 1.0, v69
    v_add_f32 v70, 1.0, v70
    v_add_f32 v71, 1.0, v71
    v_mfma_f32_32x32x16_bf16 v[144:159], a[68:71], v[196:199], v[144:159]
    v_rcp_f32 v64, v64
    v_rcp_f32 v65, v65
    v_rcp_f32 v66, v66
    v_mfma_f32_32x32x16_bf16 v[144:159], a[72:75], v[200:203], v[144:159]
    v_rcp_f32 v67, v67
    v_rcp_f32 v68, v68
    v_rcp_f32 v69, v69
    v_mfma_f32_32x32x16_bf16 v[144:159], a[76:79], v[204:207], v[144:159]
    v_rcp_f32 v70, v70
    v_rcp_f32 v71, v71
    v_mul_f32 v64, v64, v72
    v_mul_f32 v65, v65, v73
    v_mul_f32 v66, v66, v74
    s_waitcnt lgkmcnt(1)
    v_mfma_f32_32x32x16_bf16 v[144:159], a[80:83], v[160:163], v[144:159]
    ds_read_b128 v[180:183], v13 offset:24576
    ds_read_b128 v[184:187], v14 offset:24576
    ds_read_b128 v[188:191], v15 offset:24576
    v_mul_f32 v67, v67, v75
    v_mul_f32 v68, v68, v76
    v_mul_f32 v69, v69, v77
    v_mfma_f32_32x32x16_bf16 v[144:159], a[84:87], v[164:167], v[144:159]
    s_waitcnt lgkmcnt(0)
    s_barrier
    ds_read_b128 v[192:195], v12 offset:28672
    ds_read_b128 v[196:199], v13 offset:28672
    ds_read_b128 v[200:203], v14 offset:28672
    s_add_u32 m0, s4, 0
    s_add_u32 s35, s70, 0
    v_mul_f32 v70, v70, v78
    v_mul_f32 v71, v71, v79
    v_mfma_f32_32x32x16_bf16 v[144:159], a[88:91], v[168:171], v[144:159]
    ds_read_b128 v[204:207], v15 offset:28672
    buffer_load_dwordx4 v8, s[40:43], s35 offen lds
    s_add_u32 m0, s4, 4096
    s_add_u32 s35, s70, 128
    v_cvt_pk_bf16_f32 v64, v64, v65
    v_mfma_f32_32x32x16_bf16 v[144:159], a[92:95], v[172:175], v[144:159]
    ds_read_b128 v[160:163], v12 offset:32768
    v_cvt_pk_bf16_f32 v65, v66, v67
    v_cvt_pk_bf16_f32 v66, v68, v69
    v_cvt_pk_bf16_f32 v67, v70, v71
    s_add_u32 s6, s10, s74
    buffer_store_dwordx4 v[64:67], v11, s[52:55], s6 offen sc1
    v_mfma_f32_32x32x16_bf16 v[144:159], a[96:99], v[176:179], v[144:159]
    ds_read_b128 v[164:167], v13 offset:32768
    buffer_load_dwordx4 v8, s[40:43], s35 offen lds
    s_add_u32 m0, s4, 8192
    s_add_u32 s35, s70, 256
    v_mul_f32 v80, s14, v80
    v_mfma_f32_32x32x16_bf16 v[144:159], a[100:103], v[180:183], v[144:159]
    ds_read_b128 v[168:171], v14 offset:32768
    v_mul_f32 v81, s14, v81
    v_mul_f32 v82, s14, v82
    v_mul_f32 v83, s14, v83
    v_mul_f32 v84, s14, v84
    v_mul_f32 v85, s14, v85
    v_mul_f32 v86, s14, v86
    v_mfma_f32_32x32x16_bf16 v[144:159], a[104:107], v[184:187], v[144:159]
    ds_read_b128 v[172:175], v15 offset:32768
    buffer_load_dwordx4 v8, s[40:43], s35 offen lds
    s_add_u32 m0, s4, 12288
    s_add_u32 s35, s70, 384
    v_mul_f32 v87, s14, v87
    v_mfma_f32_32x32x16_bf16 v[144:159], a[108:111], v[188:191], v[144:159]
    ds_read_b128 v[176:179], v12 offset:36864
    v_exp_f32 v80, v80
    v_exp_f32 v81, v81
    v_exp_f32 v82, v82
    s_waitcnt lgkmcnt(5)
    v_mfma_f32_32x32x16_bf16 v[32:47], a[0:3], v[192:195], 0
    ds_read_b128 v[180:183], v13 offset:36864
    buffer_load_dwordx4 v8, s[40:43], s35 offen lds
    s_add_u32 m0, s4, 16384
    s_add_u32 s35, s70, 512
    v_mfma_f32_32x32x16_bf16 v[32:47], a[4:7], v[196:199], v[32:47]
    ds_read_b128 v[184:187], v14 offset:36864
    v_exp_f32 v83, v83
    v_exp_f32 v84, v84
    v_exp_f32 v85, v85
    v_mfma_f32_32x32x16_bf16 v[32:47], a[8:11], v[200:203], v[32:47]
    ds_read_b128 v[188:191], v15 offset:36864
    buffer_load_dwordx4 v8, s[40:43], s35 offen lds
    s_add_u32 m0, s4, 20480
    s_add_u32 s35, s70, 640
    v_mfma_f32_32x32x16_bf16 v[32:47], a[12:15], v[204:207], v[32:47]
    ds_read_b128 v[192:195], v12 offset:40960
    v_exp_f32 v86, v86
    v_exp_f32 v87, v87
    v_add_f32 v80, 1.0, v80
    v_add_f32 v81, 1.0, v81
    s_waitcnt lgkmcnt(5)
    v_mfma_f32_32x32x16_bf16 v[32:47], a[16:19], v[160:163], v[32:47]
    ds_read_b128 v[196:199], v13 offset:40960
    buffer_load_dwordx4 v8, s[40:43], s35 offen lds
    s_add_u32 m0, s4, 24576
    s_add_u32 s35, s70, 768
    v_mfma_f32_32x32x16_bf16 v[32:47], a[20:23], v[164:167], v[32:47]
    ds_read_b128 v[200:203], v14 offset:40960
    v_add_f32 v82, 1.0, v82
    v_add_f32 v83, 1.0, v83
    v_add_f32 v84, 1.0, v84
    v_add_f32 v85, 1.0, v85
    v_add_f32 v86, 1.0, v86
    v_add_f32 v87, 1.0, v87
    v_mfma_f32_32x32x16_bf16 v[32:47], a[24:27], v[168:171], v[32:47]
    ds_read_b128 v[204:207], v15 offset:40960
    buffer_load_dwordx4 v8, s[40:43], s35 offen lds
    v_rcp_f32 v80, v80
    v_mfma_f32_32x32x16_bf16 v[32:47], a[28:31], v[172:175], v[32:47]
    ds_read_b128 v[160:163], v12 offset:45056
    s_add_u32 m0, s34, 4096
    s_add_u32 s35, s95, 28672
    buffer_load_dwordx4 v29, s[20:23], s35 offen lds
    s_add_u32 m0, s34, 5120
    s_add_u32 s35, s95, 35840
    buffer_load_dwordx4 v29, s[20:23], s35 offen lds
    s_waitcnt lgkmcnt(5)
    v_mfma_f32_32x32x16_bf16 v[32:47], a[32:35], v[176:179], v[32:47]
    ds_read_b128 v[164:167], v13 offset:45056
    s_add_u32 m0, s34, 6144
    s_add_u32 s35, s95, 43008
    buffer_load_dwordx4 v29, s[20:23], s35 offen lds
    s_add_u32 m0, s34, 7168
    s_add_u32 s35, s95, 50176
    buffer_load_dwordx4 v29, s[20:23], s35 offen lds
    v_mfma_f32_32x32x16_bf16 v[32:47], a[36:39], v[180:183], v[32:47]
    ds_read_b128 v[168:171], v14 offset:45056
    v_rcp_f32 v81, v81
    v_rcp_f32 v82, v82
    v_rcp_f32 v83, v83
    v_mfma_f32_32x32x16_bf16 v[32:47], a[40:43], v[184:187], v[32:47]
    ds_read_b128 v[172:175], v15 offset:45056
    v_rcp_f32 v84, v84
    v_rcp_f32 v85, v85
    v_rcp_f32 v86, v86
    v_mfma_f32_32x32x16_bf16 v[32:47], a[44:47], v[188:191], v[32:47]
    ds_read_b128 v[176:179], v12 offset:49152
    v_rcp_f32 v87, v87
    v_mul_f32 v80, v80, v88
    v_mul_f32 v81, v81, v89
    v_mul_f32 v82, v82, v90
    v_mul_f32 v83, v83, v91
    s_waitcnt lgkmcnt(5)
    v_mfma_f32_32x32x16_bf16 v[32:47], a[48:51], v[192:195], v[32:47]
    ds_read_b128 v[180:183], v13 offset:49152
    v_mul_f32 v84, v84, v92
    v_mul_f32 v85, v85, v93
    v_mul_f32 v86, v86, v94
    v_mul_f32 v87, v87, v95
    v_cvt_pk_bf16_f32 v80, v80, v81
    v_mfma_f32_32x32x16_bf16 v[32:47], a[52:55], v[196:199], v[32:47]
    ds_read_b128 v[184:187], v14 offset:49152
    v_cvt_pk_bf16_f32 v81, v82, v83
    v_cvt_pk_bf16_f32 v82, v84, v85
    v_cvt_pk_bf16_f32 v83, v86, v87
    s_add_u32 s6, s10, s75
    buffer_store_dwordx4 v[80:83], v11, s[52:55], s6 offen sc1
    v_mfma_f32_32x32x16_bf16 v[32:47], a[56:59], v[200:203], v[32:47]
    ds_read_b128 v[188:191], v15 offset:49152
    v_mul_f32 v96, s14, v96
    v_mul_f32 v97, s14, v97
    v_mul_f32 v98, s14, v98
    v_mul_f32 v99, s14, v99
    v_mul_f32 v100, s14, v100
    v_mul_f32 v101, s14, v101
    v_mfma_f32_32x32x16_bf16 v[32:47], a[60:63], v[204:207], v[32:47]
    ds_read_b128 v[192:195], v12 offset:53248
    s_waitcnt vmcnt(15)
    ds_read_b64_tr_b16 a[176:177], v30 offset:0
    ds_read_b64_tr_b16 a[178:179], v30 offset:1024
    ds_read_b64_tr_b16 a[180:181], v31 offset:0
    ds_read_b64_tr_b16 a[182:183], v31 offset:1024
    v_mul_f32 v102, s14, v102
    v_mul_f32 v103, s14, v103
    s_waitcnt lgkmcnt(9)
    v_mfma_f32_32x32x16_bf16 v[32:47], a[64:67], v[160:163], v[32:47]
    ds_read_b128 v[196:199], v13 offset:53248
    s_waitcnt vmcnt(13)
    ds_read_b64_tr_b16 a[184:185], v30 offset:2048
    ds_read_b64_tr_b16 a[186:187], v30 offset:3072
    ds_read_b64_tr_b16 a[188:189], v31 offset:2048
    ds_read_b64_tr_b16 a[190:191], v31 offset:3072
    v_mfma_f32_32x32x16_bf16 v[32:47], a[68:71], v[164:167], v[32:47]
    v_exp_f32 v96, v96
    v_exp_f32 v97, v97
    v_exp_f32 v98, v98
    v_mfma_f32_32x32x16_bf16 v[32:47], a[72:75], v[168:171], v[32:47]
    v_exp_f32 v99, v99
    v_exp_f32 v100, v100
    v_exp_f32 v101, v101
    v_mfma_f32_32x32x16_bf16 v[32:47], a[76:79], v[172:175], v[32:47]
    v_exp_f32 v102, v102
    v_exp_f32 v103, v103
    v_add_f32 v96, 1.0, v96
    v_add_f32 v97, 1.0, v97
    v_add_f32 v98, 1.0, v98
    s_waitcnt lgkmcnt(10)
    v_mfma_f32_32x32x16_bf16 v[32:47], a[80:83], v[176:179], v[32:47]
    ds_read_b128 v[200:203], v14 offset:53248
    ds_read_b128 v[204:207], v15 offset:53248
    v_add_f32 v99, 1.0, v99
    v_add_f32 v100, 1.0, v100
    v_add_f32 v101, 1.0, v101
    v_add_f32 v102, 1.0, v102
    v_mfma_f32_32x32x16_bf16 v[32:47], a[84:87], v[180:183], v[32:47]
    s_waitcnt lgkmcnt(0)
    s_barrier
    ds_read_b128 v[160:163], v12 offset:57344
    ds_read_b128 v[164:167], v13 offset:57344
    ds_read_b128 v[168:171], v14 offset:57344
    v_add_f32 v103, 1.0, v103
    v_rcp_f32 v96, v96
    v_mfma_f32_32x32x16_bf16 v[32:47], a[88:91], v[184:187], v[32:47]
    ds_read_b128 v[172:175], v15 offset:57344
    s_add_u32 s95, s94, 2
    s_and_b32 s95, s95, 3
    s_sub_i32 s95, s97, s95
    s_add_i32 s35, s95, 7
    s_cmp_lt_i32 s95, 0
    s_cselect_b32 s95, s35, s95
    s_mul_i32 s95, s95, 57344
    s_add_u32 s95, s95, s32
    s_add_u32 m0, s34, 0
    s_add_u32 s35, s95, 0
    buffer_load_dwordx4 v29, s[20:23], s35 offen lds
    s_add_u32 m0, s34, 1024
    s_add_u32 s35, s95, 7168
    buffer_load_dwordx4 v29, s[20:23], s35 offen lds
    v_mfma_f32_32x32x16_bf16 v[32:47], a[92:95], v[188:191], v[32:47]
    ds_read_b128 v[176:179], v12 offset:61440
    s_add_u32 m0, s34, 2048
    s_add_u32 s35, s95, 14336
    buffer_load_dwordx4 v29, s[20:23], s35 offen lds
    s_add_u32 m0, s34, 3072
    s_add_u32 s35, s95, 21504
    buffer_load_dwordx4 v29, s[20:23], s35 offen lds
    v_mfma_f32_32x32x16_bf16 v[32:47], a[96:99], v[192:195], v[32:47]
    ds_read_b128 v[180:183], v13 offset:61440
    v_rcp_f32 v97, v97
    v_rcp_f32 v98, v98
    v_rcp_f32 v99, v99
    v_mfma_f32_32x32x16_bf16 v[32:47], a[100:103], v[196:199], v[32:47]
    ds_read_b128 v[184:187], v14 offset:61440
    v_rcp_f32 v100, v100
    v_rcp_f32 v101, v101
    v_rcp_f32 v102, v102
    v_mfma_f32_32x32x16_bf16 v[32:47], a[104:107], v[200:203], v[32:47]
    ds_read_b128 v[188:191], v15 offset:61440
    v_rcp_f32 v103, v103
    v_mul_f32 v96, v96, v104
    v_mul_f32 v97, v97, v105
    v_mul_f32 v98, v98, v106
    v_mul_f32 v99, v99, v107
    v_mfma_f32_32x32x16_bf16 v[32:47], a[108:111], v[204:207], v[32:47]
    ds_read_b128 v[192:195], v16 offset:0
    v_mul_f32 v100, v100, v108
    v_mul_f32 v101, v101, v109
    v_mul_f32 v102, v102, v110
    v_mul_f32 v103, v103, v111
    v_cvt_pk_bf16_f32 v96, v96, v97
    v_cvt_pk_bf16_f32 v97, v98, v99
    s_waitcnt lgkmcnt(5)
    v_mfma_f32_32x32x16_bf16 v[48:63], a[0:3], v[160:163], 0
    ds_read_b128 v[196:199], v17 offset:0
    v_cvt_pk_bf16_f32 v98, v100, v101
    v_cvt_pk_bf16_f32 v99, v102, v103
    s_add_u32 s6, s10, s76
    buffer_store_dwordx4 v[96:99], v11, s[52:55], s6 offen sc1
    v_mfma_f32_32x32x16_bf16 v[48:63], a[4:7], v[164:167], v[48:63]
    ds_read_b128 v[200:203], v18 offset:0
    v_mul_f32 v112, s14, v112
    v_mul_f32 v113, s14, v113
    v_mul_f32 v114, s14, v114
    v_mul_f32 v115, s14, v115
    v_mul_f32 v116, s14, v116
    v_mul_f32 v117, s14, v117
    v_mfma_f32_32x32x16_bf16 v[48:63], a[8:11], v[168:171], v[48:63]
    ds_read_b128 v[204:207], v19 offset:0
    v_mul_f32 v118, s14, v118
    v_mul_f32 v119, s14, v119
    v_exp_f32 v112, v112
    v_exp_f32 v113, v113
    v_mfma_f32_32x32x16_bf16 v[48:63], a[12:15], v[172:175], v[48:63]
    ds_read_b128 v[160:163], v16 offset:4096
    v_exp_f32 v114, v114
    v_exp_f32 v115, v115
    v_exp_f32 v116, v116
    s_waitcnt lgkmcnt(5)
    v_mfma_f32_32x32x16_bf16 v[48:63], a[16:19], v[176:179], v[48:63]
    ds_read_b128 v[164:167], v17 offset:4096
    v_exp_f32 v117, v117
    v_exp_f32 v118, v118
    v_mfma_f32_32x32x16_bf16 v[48:63], a[20:23], v[180:183], v[48:63]
    ds_read_b128 v[168:171], v18 offset:4096
    v_exp_f32 v119, v119
    v_add_f32 v112, 1.0, v112
    v_add_f32 v113, 1.0, v113
    v_add_f32 v114, 1.0, v114
    v_add_f32 v115, 1.0, v115
    v_mfma_f32_32x32x16_bf16 v[48:63], a[24:27], v[184:187], v[48:63]
    ds_read_b128 v[172:175], v19 offset:4096
    v_add_f32 v116, 1.0, v116
    v_add_f32 v117, 1.0, v117
    v_add_f32 v118, 1.0, v118
    v_add_f32 v119, 1.0, v119
    v_rcp_f32 v112, v112
    v_mfma_f32_32x32x16_bf16 v[48:63], a[28:31], v[188:191], v[48:63]
    ds_read_b128 v[176:179], v16 offset:8192
    v_rcp_f32 v113, v113
    v_rcp_f32 v114, v114
    v_rcp_f32 v115, v115
    s_waitcnt lgkmcnt(5)
    v_mfma_f32_32x32x16_bf16 v[48:63], a[32:35], v[192:195], v[48:63]
    ds_read_b128 v[180:183], v17 offset:8192
    v_rcp_f32 v116, v116
    v_rcp_f32 v117, v117
    v_mfma_f32_32x32x16_bf16 v[48:63], a[36:39], v[196:199], v[48:63]
    ds_read_b128 v[184:187], v18 offset:8192
    s_waitcnt vmcnt(8)
    ds_read_b64_tr_b16 a[192:193], v30 offset:4096
    ds_read_b64_tr_b16 a[194:195], v30 offset:5120
    ds_read_b64_tr_b16 a[196:197], v31 offset:4096
    ds_read_b64_tr_b16 a[198:199], v31 offset:5120
    v_rcp_f32 v118, v118
    v_mfma_f32_32x32x16_bf16 v[48:63], a[40:43], v[200:203], v[48:63]
    ds_read_b128 v[188:191], v19 offset:8192
    s_waitcnt vmcnt(6)
    ds_read_b64_tr_b16 a[200:201], v30 offset:6144
    ds_read_b64_tr_b16 a[202:203], v30 offset:7168
    ds_read_b64_tr_b16 a[204:205], v31 offset:6144
    s_waitcnt lgkmcnt(7)
    ds_read_b64_tr_b16 a[206:207], v31 offset:7168
    v_rcp_f32 v119, v119
    v_mfma_f32_32x32x16_bf16 v[48:63], a[44:47], v[204:207], v[48:63]
    ds_read_b128 v[192:195], v16 offset:12288
    v_mul_f32 v112, v112, v120
    v_mul_f32 v113, v113, v121
    v_mul_f32 v114, v114, v122
    v_mul_f32 v115, v115, v123
    v_mul_f32 v116, v116, v124
    v_mul_f32 v117, v117, v125
    v_mfma_f32_32x32x16_bf16 v[48:63], a[48:51], v[160:163], v[48:63]
    ds_read_b128 v[196:199], v17 offset:12288
    v_mul_f32 v118, v118, v126
    v_mul_f32 v119, v119, v127
    v_cvt_pk_bf16_f32 v112, v112, v113
    v_cvt_pk_bf16_f32 v113, v114, v115
    v_cvt_pk_bf16_f32 v114, v116, v117
    v_cvt_pk_bf16_f32 v115, v118, v119
    v_mfma_f32_32x32x16_bf16 v[48:63], a[52:55], v[164:167], v[48:63]
    ds_read_b128 v[200:203], v18 offset:12288
    s_add_u32 s6, s10, s77
    buffer_store_dwordx4 v[112:115], v11, s[52:55], s6 offen sc1
    v_mul_f32 v128, s14, v128
    v_mul_f32 v129, s14, v129
    v_mul_f32 v130, s14, v130
    v_mfma_f32_32x32x16_bf16 v[48:63], a[56:59], v[168:171], v[48:63]
    ds_read_b128 v[204:207], v19 offset:12288
    v_mul_f32 v131, s14, v131
    v_mul_f32 v132, s14, v132
    v_mul_f32 v133, s14, v133
    v_mul_f32 v134, s14, v134
    v_mul_f32 v135, s14, v135
    v_mfma_f32_32x32x16_bf16 v[48:63], a[60:63], v[172:175], v[48:63]
    ds_read_b128 v[160:163], v16 offset:16384
    v_exp_f32 v128, v128
    v_exp_f32 v129, v129
    v_exp_f32 v130, v130
    v_mfma_f32_32x32x16_bf16 v[48:63], a[64:67], v[176:179], v[48:63]
    v_exp_f32 v131, v131
    v_exp_f32 v132, v132
    v_exp_f32 v133, v133
    v_mfma_f32_32x32x16_bf16 v[48:63], a[68:71], v[180:183], v[48:63]
    v_exp_f32 v134, v134
    v_exp_f32 v135, v135
    v_add_f32 v128, 1.0, v128
    v_add_f32 v129, 1.0, v129
    v_add_f32 v130, 1.0, v130
    v_mfma_f32_32x32x16_bf16 v[48:63], a[72:75], v[184:187], v[48:63]
    v_add_f32 v131, 1.0, v131
    v_add_f32 v132, 1.0, v132
    v_add_f32 v133, 1.0, v133
    v_add_f32 v134, 1.0, v134
    v_add_f32 v135, 1.0, v135
    v_rcp_f32 v128, v128
    s_waitcnt lgkmcnt(2)
    v_mfma_f32_32x32x16_bf16 v[48:63], a[76:79], v[188:191], v[48:63]
    ds_read_b128 v[164:167], v17 offset:16384
    ds_read_b128 v[168:171], v18 offset:16384
    ds_read_b128 v[172:175], v19 offset:16384
    v_rcp_f32 v129, v129
    v_mfma_f32_32x32x16_bf16 v[48:63], a[80:83], v[192:195], v[48:63]
    s_add_u32 m0, s34, 4096
    s_add_u32 s35, s95, 28672
    buffer_load_dwordx4 v29, s[20:23], s35 offen lds
    s_add_u32 m0, s34, 5120
    s_add_u32 s35, s95, 35840
    buffer_load_dwordx4 v29, s[20:23], s35 offen lds
    v_mfma_f32_32x32x16_bf16 v[48:63], a[84:87], v[196:199], v[48:63]
    s_waitcnt lgkmcnt(0)
    s_barrier
    ds_read_b128 v[176:179], v12 offset:0
    ds_read_b128 v[180:183], v13 offset:0
    ds_read_b128 v[184:187], v14 offset:0
    v_rcp_f32 v130, v130
    v_rcp_f32 v131, v131
    v_mfma_f32_32x32x16_bf16 v[48:63], a[88:91], v[200:203], v[48:63]
    ds_read_b128 v[188:191], v15 offset:0
    s_add_u32 m0, s34, 6144
    s_add_u32 s35, s95, 43008
    buffer_load_dwordx4 v29, s[20:23], s35 offen lds
    s_add_u32 m0, s34, 7168
    s_add_u32 s35, s95, 50176
    buffer_load_dwordx4 v29, s[20:23], s35 offen lds
    v_mfma_f32_32x32x16_bf16 v[48:63], a[92:95], v[204:207], v[48:63]
    ds_read_b128 v[192:195], v12 offset:4096
    v_rcp_f32 v132, v132
    v_rcp_f32 v133, v133
    v_rcp_f32 v134, v134
    v_mfma_f32_32x32x16_bf16 v[48:63], a[96:99], v[160:163], v[48:63]
    ds_read_b128 v[196:199], v13 offset:4096
    s_waitcnt vmcnt(8)
    ds_read_b64_tr_b16 a[208:209], v30 offset:0
    ds_read_b64_tr_b16 a[210:211], v30 offset:1024
    ds_read_b64_tr_b16 a[212:213], v31 offset:0
    ds_read_b64_tr_b16 a[214:215], v31 offset:1024
    v_rcp_f32 v135, v135
    v_mfma_f32_32x32x16_bf16 v[48:63], a[100:103], v[164:167], v[48:63]
    ds_read_b128 v[200:203], v14 offset:4096
    s_waitcnt vmcnt(6)
    ds_read_b64_tr_b16 a[216:217], v30 offset:2048
    ds_read_b64_tr_b16 a[218:219], v30 offset:3072
    ds_read_b64_tr_b16 a[220:221], v31 offset:2048
    ds_read_b64_tr_b16 a[222:223], v31 offset:3072
    v_mul_f32 v128, v128, v136
    v_mul_f32 v129, v129, v137
    v_mfma_f32_32x32x16_bf16 v[48:63], a[104:107], v[168:171], v[48:63]
    v_mul_f32 v130, v130, v138
    v_mul_f32 v131, v131, v139
    v_mul_f32 v132, v132, v140
    v_mul_f32 v133, v133, v141
    v_mul_f32 v134, v134, v142
    v_mul_f32 v135, v135, v143
    v_cvt_pk_bf16_f32 v128, v128, v129
    v_mfma_f32_32x32x16_bf16 v[48:63], a[108:111], v[172:175], v[48:63]
    v_cvt_pk_bf16_f32 v129, v130, v131
    v_cvt_pk_bf16_f32 v130, v132, v133
    v_cvt_pk_bf16_f32 v131, v134, v135
    s_add_u32 s6, s10, s78
    buffer_store_dwordx4 v[128:131], v11, s[52:55], s6 offen sc1
    v_mul_f32 v144, s14, v144
    s_waitcnt lgkmcnt(11)
    v_mfma_f32_32x32x16_bf16 v[64:79], a[0:3], v[176:179], 0
    ds_read_b128 v[204:207], v15 offset:4096
    ds_read_b128 v[160:163], v12 offset:8192
    v_mul_f32 v145, s14, v145
    v_mul_f32 v146, s14, v146
    v_mul_f32 v147, s14, v147
    v_mul_f32 v148, s14, v148
    v_mfma_f32_32x32x16_bf16 v[64:79], a[4:7], v[180:183], v[64:79]
    v_mul_f32 v149, s14, v149
    v_mul_f32 v150, s14, v150
    v_mul_f32 v151, s14, v151
    v_exp_f32 v144, v144
    v_exp_f32 v145, v145
    v_mfma_f32_32x32x16_bf16 v[64:79], a[8:11], v[184:187], v[64:79]
    v_exp_f32 v146, v146
    v_exp_f32 v147, v147
    v_exp_f32 v148, v148
    v_mfma_f32_32x32x16_bf16 v[64:79], a[12:15], v[188:191], v[64:79]
    v_exp_f32 v149, v149
    v_exp_f32 v150, v150
    v_exp_f32 v151, v151
    v_add_f32 v144, 1.0, v144
    s_waitcnt lgkmcnt(1)
    v_mfma_f32_32x32x16_bf16 v[64:79], a[16:19], v[192:195], v[64:79]
    ds_read_b128 v[164:167], v13 offset:8192
    ds_read_b128 v[168:171], v14 offset:8192
    ds_read_b128 v[172:175], v15 offset:8192
    v_add_f32 v145, 1.0, v145
    v_add_f32 v146, 1.0, v146
    v_add_f32 v147, 1.0, v147
    v_mfma_f32_32x32x16_bf16 v[64:79], a[20:23], v[196:199], v[64:79]
    ds_read_b128 v[176:179], v12 offset:12288
    ds_read_b128 v[180:183], v13 offset:12288
    ds_read_b128 v[184:187], v14 offset:12288
    v_add_f32 v148, 1.0, v148
    v_add_f32 v149, 1.0, v149
    v_add_f32 v150, 1.0, v150
    v_add_f32 v151, 1.0, v151
    v_mfma_f32_32x32x16_bf16 v[64:79], a[24:27], v[200:203], v[64:79]
    ds_read_b128 v[188:191], v15 offset:12288
    s_add_u32 s95, s94, 3
    s_and_b32 s95, s95, 3
    s_sub_i32 s95, s97, s95
    s_add_i32 s35, s95, 7
    s_cmp_lt_i32 s95, 0
    s_cselect_b32 s95, s35, s95
    s_mul_i32 s95, s95, 57344
    s_add_u32 s95, s95, s32
    s_add_u32 m0, s34, 0
    s_add_u32 s35, s95, 0
    buffer_load_dwordx4 v29, s[20:23], s35 offen lds
    s_add_u32 m0, s34, 1024
    s_add_u32 s35, s95, 7168
    buffer_load_dwordx4 v29, s[20:23], s35 offen lds
    v_mfma_f32_32x32x16_bf16 v[64:79], a[28:31], v[204:207], v[64:79]
    ds_read_b128 v[192:195], v12 offset:16384
    s_add_u32 m0, s34, 2048
    s_add_u32 s35, s95, 14336
    buffer_load_dwordx4 v29, s[20:23], s35 offen lds
    s_add_u32 m0, s34, 3072
    s_add_u32 s35, s95, 21504
    buffer_load_dwordx4 v29, s[20:23], s35 offen lds
    s_waitcnt lgkmcnt(5)
    v_mfma_f32_32x32x16_bf16 v[64:79], a[32:35], v[160:163], v[64:79]
    ds_read_b128 v[196:199], v13 offset:16384
    v_rcp_f32 v144, v144
    v_rcp_f32 v145, v145
    v_mfma_f32_32x32x16_bf16 v[64:79], a[36:39], v[164:167], v[64:79]
    ds_read_b128 v[200:203], v14 offset:16384
    v_rcp_f32 v146, v146
    v_rcp_f32 v147, v147
    v_rcp_f32 v148, v148
    v_mfma_f32_32x32x16_bf16 v[64:79], a[40:43], v[168:171], v[64:79]
    ds_read_b128 v[204:207], v15 offset:16384
    v_rcp_f32 v149, v149
    v_rcp_f32 v150, v150
    v_rcp_f32 v151, v151
    v_mfma_f32_32x32x16_bf16 v[64:79], a[44:47], v[172:175], v[64:79]
    ds_read_b128 v[160:163], v12 offset:20480
    v_mul_f32 v144, v144, v152
    v_mul_f32 v145, v145, v153
    v_mul_f32 v146, v146, v154
    v_mul_f32 v147, v147, v155
    v_mul_f32 v148, v148, v156
    v_mul_f32 v149, v149, v157
    s_waitcnt lgkmcnt(5)
    v_mfma_f32_32x32x16_bf16 v[64:79], a[48:51], v[176:179], v[64:79]
    ds_read_b128 v[164:167], v13 offset:20480
    v_mul_f32 v150, v150, v158
    v_mul_f32 v151, v151, v159
    v_cvt_pk_bf16_f32 v144, v144, v145
    v_cvt_pk_bf16_f32 v145, v146, v147
    v_cvt_pk_bf16_f32 v146, v148, v149
    v_mfma_f32_32x32x16_bf16 v[64:79], a[52:55], v[180:183], v[64:79]
    ds_read_b128 v[168:171], v14 offset:20480
    v_cvt_pk_bf16_f32 v147, v150, v151
    s_add_u32 s6, s10, s79
    buffer_store_dwordx4 v[144:147], v11, s[52:55], s6 offen sc1
    v_mul_f32 v32, s14, v32
    v_mul_f32 v33, s14, v33
    v_mfma_f32_32x32x16_bf16 v[64:79], a[56:59], v[184:187], v[64:79]
    ds_read_b128 v[172:175], v15 offset:20480
    v_mul_f32 v34, s14, v34
    v_mul_f32 v35, s14, v35
    v_mul_f32 v36, s14, v36
    v_mul_f32 v37, s14, v37
    v_mul_f32 v38, s14, v38
    v_mul_f32 v39, s14, v39
    v_mfma_f32_32x32x16_bf16 v[64:79], a[60:63], v[188:191], v[64:79]
    ds_read_b128 v[176:179], v12 offset:24576
    v_exp_f32 v32, v32
    v_exp_f32 v33, v33
    v_exp_f32 v34, v34
    s_waitcnt lgkmcnt(5)
    v_mfma_f32_32x32x16_bf16 v[64:79], a[64:67], v[192:195], v[64:79]
    s_waitcnt vmcnt(10)
    s_mov_b32 s6, 262144
GLN_np:
    v_cmp_ne_u64 vcc, 0, v[208:209]
    s_nop 1
    s_cbranch_vccnz GLN_nok
    buffer_load_dwordx2 v[208:209], v28, s[16:19], 0 offen sc1
    s_waitcnt vmcnt(0)
    s_sub_u32 s6, s6, 1
    s_cmp_lg_u32 s6, 0
    s_cbranch_scc1 GLN_np
GLN_nok:
    v_or_b32 v212, 1, v208
    v_mov_b32 v213, v209
    buffer_store_dwordx2 v[212:213], v210, s[24:27], 0 offen sc1
    ds_read_b128 v[180:183], v13 offset:24576
    v_exp_f32 v35, v35
    v_exp_f32 v36, v36
    v_mfma_f32_32x32x16_bf16 v[64:79], a[68:71], v[196:199], v[64:79]
    ds_read_b128 v[184:187], v14 offset:24576
    v_exp_f32 v37, v37
    v_exp_f32 v38, v38
    v_exp_f32 v39, v39
    v_mfma_f32_32x32x16_bf16 v[64:79], a[72:75], v[200:203], v[64:79]
    ds_read_b128 v[188:191], v15 offset:24576
    v_add_f32 v32, 1.0, v32
    v_add_f32 v33, 1.0, v33
    v_add_f32 v34, 1.0, v34
    v_add_f32 v35, 1.0, v35
    v_add_f32 v36, 1.0, v36
    v_add_f32 v37, 1.0, v37
    v_mfma_f32_32x32x16_bf16 v[64:79], a[76:79], v[204:207], v[64:79]
    v_add_f32 v38, 1.0, v38
    v_add_f32 v39, 1.0, v39
    v_rcp_f32 v32, v32
    v_rcp_f32 v33, v33
    s_waitcnt lgkmcnt(4)
    v_mfma_f32_32x32x16_bf16 v[64:79], a[80:83], v[160:163], v[64:79]
    v_rcp_f32 v34, v34
    v_rcp_f32 v35, v35
    v_rcp_f32 v36, v36
    v_mfma_f32_32x32x16_bf16 v[64:79], a[84:87], v[164:167], v[64:79]
    v_rcp_f32 v37, v37
    v_rcp_f32 v38, v38
    v_rcp_f32 v39, v39
    v_mul_f32 v32, v32, v40
    v_mfma_f32_32x32x16_bf16 v[64:79], a[88:91], v[168:171], v[64:79]
    s_waitcnt vmcnt(9)
    ds_read_b64_tr_b16 a[224:225], v30 offset:4096
    ds_read_b64_tr_b16 a[226:227], v30 offset:5120
    ds_read_b64_tr_b16 a[228:229], v31 offset:4096
    ds_read_b64_tr_b16 a[230:231], v31 offset:5120
    v_mul_f32 v33, v33, v41
    v_mul_f32 v34, v34, v42
    v_mul_f32 v35, v35, v43
    v_mfma_f32_32x32x16_bf16 v[64:79], a[92:95], v[172:175], v[64:79]
    v_mul_f32 v36, v36, v44
    v_mul_f32 v37, v37, v45
    v_mul_f32 v38, v38, v46
    v_mul_f32 v39, v39, v47
    v_cvt_pk_bf16_f32 v32, v32, v33
    v_cvt_pk_bf16_f32 v33, v34, v35
    v_cvt_pk_bf16_f32 v34, v36, v37
    s_waitcnt lgkmcnt(4)
    v_mfma_f32_32x32x16_bf16 v[64:79], a[96:99], v[176:179], v[64:79]
    s_waitcnt vmcnt(7)
    ds_read_b64_tr_b16 a[232:233], v30 offset:6144
    ds_read_b64_tr_b16 a[234:235], v30 offset:7168
    ds_read_b64_tr_b16 a[236:237], v31 offset:6144
    ds_read_b64_tr_b16 a[238:239], v31 offset:7168
    v_cvt_pk_bf16_f32 v35, v38, v39
    v_mfma_f32_32x32x16_bf16 v[64:79], a[100:103], v[180:183], v[64:79]
    s_waitcnt vmcnt(6)
    v_or_b32 v212, 2, v208
    v_mov_b32 v213, v209
    buffer_store_dwordx2 v[212:213], v210, s[24:27], 0 offen sc1
    s_add_u32 s6, s10, s80
    buffer_store_dwordx4 v[32:35], v11, s[52:55], s6 offen sc1
    v_mul_f32 v48, s14, v48
    v_mul_f32 v49, s14, v49
    v_mul_f32 v50, s14, v50
    v_mul_f32 v51, s14, v51
    v_mfma_f32_32x32x16_bf16 v[64:79], a[104:107], v[184:187], v[64:79]
    v_mul_f32 v52, s14, v52
    v_mul_f32 v53, s14, v53
    v_mul_f32 v54, s14, v54
    v_mul_f32 v55, s14, v55
    v_exp_f32 v48, v48
    v_mfma_f32_32x32x16_bf16 v[64:79], a[108:111], v[188:191], v[64:79]
    v_exp_f32 v49, v49
    v_exp_f32 v50, v50
    v_exp_f32 v51, v51
    v_exp_f32 v52, v52
    v_exp_f32 v53, v53
    v_exp_f32 v54, v54
    v_exp_f32 v55, v55
    v_add_f32 v48, 1.0, v48
    v_add_f32 v49, 1.0, v49
    v_add_f32 v50, 1.0, v50
    v_add_f32 v51, 1.0, v51
    v_add_f32 v52, 1.0, v52
    v_add_f32 v53, 1.0, v53
    v_add_f32 v54, 1.0, v54
    v_add_f32 v55, 1.0, v55
    v_rcp_f32 v48, v48
    v_rcp_f32 v49, v49
    v_rcp_f32 v50, v50
    v_rcp_f32 v51, v51
    v_rcp_f32 v52, v52
    v_rcp_f32 v53, v53
    v_rcp_f32 v54, v54
    v_rcp_f32 v55, v55
    v_mul_f32 v48, v48, v56
    v_mul_f32 v49, v49, v57
    v_mul_f32 v50, v50, v58
    v_mul_f32 v51, v51, v59
    v_mul_f32 v52, v52, v60
    v_mul_f32 v53, v53, v61
    v_mul_f32 v54, v54, v62
    v_mul_f32 v55, v55, v63
    v_cvt_pk_bf16_f32 v48, v48, v49
    v_cvt_pk_bf16_f32 v49, v50, v51
    v_cvt_pk_bf16_f32 v50, v52, v53
    v_cvt_pk_bf16_f32 v51, v54, v55
    s_add_u32 s6, s10, s81
    buffer_store_dwordx4 v[48:51], v11, s[52:55], s6 offen sc1
    v_pk_mul_f32 v[64:65], v[64:65], s[14:15]
    v_pk_mul_f32 v[66:67], v[66:67], s[14:15]
    v_pk_mul_f32 v[68:69], v[68:69], s[14:15]
    v_pk_mul_f32 v[70:71], v[70:71], s[14:15]
    v_exp_f32 v64, v64
    v_exp_f32 v65, v65
    v_exp_f32 v66, v66
    v_exp_f32 v67, v67
    v_exp_f32 v68, v68
    v_exp_f32 v69, v69
    v_exp_f32 v70, v70
    v_exp_f32 v71, v71
    v_pk_add_f32 v[64:65], v[64:65], 1.0 op_sel_hi:[1,0]
    v_pk_add_f32 v[66:67], v[66:67], 1.0 op_sel_hi:[1,0]
    v_pk_add_f32 v[68:69], v[68:69], 1.0 op_sel_hi:[1,0]
    v_pk_add_f32 v[70:71], v[70:71], 1.0 op_sel_hi:[1,0]
    v_rcp_f32 v64, v64
    v_rcp_f32 v65, v65
    v_rcp_f32 v66, v66
    v_rcp_f32 v67, v67
    v_rcp_f32 v68, v68
    v_rcp_f32 v69, v69
    v_rcp_f32 v70, v70
    v_rcp_f32 v71, v71
    v_pk_mul_f32 v[64:65], v[64:65], v[72:73]
    v_pk_mul_f32 v[66:67], v[66:67], v[74:75]
    v_pk_mul_f32 v[68:69], v[68:69], v[76:77]
    v_pk_mul_f32 v[70:71], v[70:71], v[78:79]
    v_cvt_pk_bf16_f32 v64, v64, v65
    v_cvt_pk_bf16_f32 v65, v66, v67
    v_cvt_pk_bf16_f32 v66, v68, v69
    v_cvt_pk_bf16_f32 v67, v70, v71
    s_add_u32 s6, s10, s82
    buffer_store_dwordx4 v[64:67], v11, s[52:55], s6 offen sc1
    s_waitcnt vmcnt(8)
    ds_read_b64_tr_b16 a[240:241], v30 offset:0
    ds_read_b64_tr_b16 a[242:243], v30 offset:1024
    ds_read_b64_tr_b16 a[244:245], v31 offset:0
    ds_read_b64_tr_b16 a[246:247], v31 offset:1024
    s_waitcnt vmcnt(6)
    ds_read_b64_tr_b16 a[248:249], v30 offset:2048
    ds_read_b64_tr_b16 a[250:251], v30 offset:3072
    ds_read_b64_tr_b16 a[252:253], v31 offset:2048
    s_waitcnt lgkmcnt(7)
    ds_read_b64_tr_b16 a[254:255], v31 offset:3072
    s_branch gated_mix__sliding_local_dilated__glu_gated_glu__prompt_kernel_p2
gated_mix__sliding_local_dilated__glu_gated_glu__prompt_kernel_att:
    s_and_b32 s5, s3, 1
    s_cmp_eq_u32 s5, 1
    s_cbranch_scc1 gated_mix__sliding_local_dilated__glu_gated_glu__prompt_kernel_att1
    s_nop 1
    s_and_b32 s6, s7, 1
    s_mul_i32 s6, s6, 11
    s_add_u32 s6, s6, s8
    s_lshr_b32 s8, s6, 1
    s_and_b32 s6, s6, 1
    s_andn2_b32 s7, s7, 1
    s_add_u32 s7, s7, s6
    s_lshl_b32 s6, s7, 4
    s_add_u32 s6, s6, s8
    s_lshl_b32 s6, s6, 2
    s_add_u32 s6, s6, s3
    s_lshl_b32 s6, s6, 3
    s_add_u32 s33, s6, 8192
    s_lshr_b32 s9, s3, 1
    v_lshrrev_b32 v4, 3, v1
    s_lshl_b32 s5, s3, 3
    v_add_u32 v4, s5, v4
    v_bfe_u32 v5, v4, 1, 3
    v_and_b32 v6, 7, v1
    v_xor_b32 v5, v5, v6
    v_mul_u32_u24 v4, 1792, v4
    v_lshl_add_u32 v8, v5, 4, v4
    v_lshrrev_b32 v4, 3, v1
    v_bfe_u32 v5, v1, 4, 1
    v_lshlrev_b32 v5, 2, v5
    v_and_b32 v6, 7, v1
    v_xor_b32 v5, v5, v6
    v_mul_u32_u24 v4, 2688, v4
    v_lshl_add_u32 v9, v5, 4, v4
    s_mul_i32 s10, s3, 21504
    s_mul_i32 s6, s7, 112
    s_add_u32 s10, s10, s6
    s_mul_i32 s5, s8, 172032
    s_add_u32 s12, s5, 0
    s_add_u32 s13, s5, 896
    s_add_u32 s14, s5, 57344
    s_add_u32 s15, s5, 58240
    s_add_u32 s38, s5, 114688
    s_add_u32 s39, s5, 115584
    v_bfe_u32 v4, v1, 3, 2
    s_lshl_b32 s6, s3, 2
    s_add_u32 s6, s6, 16
    v_add_u32 v4, s6, v4
    v_and_b32 v5, 7, v4
    v_lshlrev_b32 v5, 1, v5
    v_bfe_u32 v6, v4, 3, 1
    v_sub_u32 v5, v5, v6
    s_mul_i32 s6, s8, 192
    s_sub_u32 s6, s6, 15
    v_add_u32 v5, s6, v5
    v_max_i32 v5, 0, v5
    v_mul_u32_u24 v5, 896, v5
    v_bfe_u32 v4, v4, 1, 3
    v_and_b32 v6, 7, v1
    v_xor_b32 v4, v4, v6
    v_lshl_add_u32 v10, v4, 4, v5
    v_lshlrev_b32 v11, 4, v1
    s_lshr_b32 s5, s4, 1
    v_bfe_u32 v4, v1, 1, 1
    v_lshlrev_b32 v4, 6, v4
    v_xor_b32 v4, 112, v4
    v_lshl_add_u32 v39, v1, 7, v4
    v_mov_b32 v64, 0
    v_mov_b32 v65, 0
    v_mov_b32 v66, 0
    v_mov_b32 v67, 0
    v_lshlrev_b32 v6, 1, v1
    s_waitcnt lgkmcnt(0)
    s_mov_b32 s40, s16
    s_mov_b32 s41, s17
    s_mov_b32 s42, 1835008
    s_mov_b32 s43, 0x00020000
    s_mov_b32 s44, s18
    s_mov_b32 s45, s19
    s_mov_b32 s46, 1204224
    s_mov_b32 s47, 0x00020000
    s_mov_b32 s48, s30
    s_mov_b32 s49, s31
    s_mov_b32 s50, 896
    s_mov_b32 s51, 0x00020000
    s_mov_b32 s22, 0xf7f77f7f
    s_mov_b32 s23, 0xf7f77f7f
    buffer_load_ushort v40, v6, s[48:51], 0 offen
    buffer_load_ushort v41, v6, s[48:51], 0 offen offset:128
    buffer_load_ushort v42, v6, s[48:51], 0 offen offset:256
    buffer_load_ushort v43, v6, s[48:51], 0 offen offset:384
    buffer_load_ushort v44, v6, s[48:51], 0 offen offset:512
    buffer_load_ushort v45, v6, s[48:51], 0 offen offset:640
    buffer_load_ushort v46, v6, s[48:51], 0 offen offset:768
    s_add_u32 m0, s4, 0
    s_add_u32 s35, s10, 0
    s_mov_b64 exec, s[22:23]
    buffer_load_dwordx4 v9, s[44:47], s35 offen lds
    s_mov_b64 exec, -1
    s_add_u32 m0, s4, 8192
    s_add_u32 s35, s10, 896
    buffer_load_dwordx4 v9, s[44:47], s35 offen lds
    s_add_u32 m0, s4, 16384
    s_add_u32 s35, s10, 1792
    buffer_load_dwordx4 v9, s[44:47], s35 offen lds
    s_add_u32 m0, s4, 24576
    s_add_u32 s35, s12, 0
    buffer_load_dwordx4 v8, s[40:43], s35 offen lds
    s_add_u32 m0, s4, 28672
    s_add_u32 s35, s13, 0
    buffer_load_dwordx4 v8, s[40:43], s35 offen lds
    s_add_u32 m0, s4, 32768
    s_add_u32 s35, s14, 0
    buffer_load_dwordx4 v8, s[40:43], s35 offen lds
    s_add_u32 m0, s4, 36864
    s_add_u32 s35, s15, 0
    buffer_load_dwordx4 v8, s[40:43], s35 offen lds
    s_add_u32 m0, s4, 4096
    s_add_u32 s35, s10, 86016
    s_mov_b64 exec, s[22:23]
    buffer_load_dwordx4 v9, s[44:47], s35 offen lds
    s_mov_b64 exec, -1
    s_add_u32 m0, s4, 12288
    s_add_u32 s35, s10, 86912
    buffer_load_dwordx4 v9, s[44:47], s35 offen lds
    s_add_u32 m0, s4, 20480
    s_add_u32 s35, s10, 87808
    buffer_load_dwordx4 v9, s[44:47], s35 offen lds
    s_add_u32 m0, s4, 40960
    s_add_u32 s35, s38, 0
    buffer_load_dwordx4 v8, s[40:43], s35 offen lds
    s_add_u32 m0, s4, 45056
    s_add_u32 s35, s39, 0
    buffer_load_dwordx4 v8, s[40:43], s35 offen lds
    s_add_u32 m0, s5, 49152
    s_mov_b32 s35, 0
    s_mov_b32 exec_hi, 0
    buffer_load_dwordx4 v10, s[40:43], s35 offen lds
    s_mov_b64 exec, -1
    s_mov_b32 s52, s36
    s_mov_b32 s53, s37
    s_mov_b32 s54, 9437184
    s_mov_b32 s55, 0x00020000
    ds_write_b128 v39, v[64:67] offset:0
    ds_write_b128 v39, v[64:67] offset:51200
    v_add_u32 v4, 102400, v39
    ds_write_b128 v4, v[64:67] offset:0
    v_bfe_u32 v4, v2, 1, 3
    v_xor_b32 v4, v4, v3
    v_lshlrev_b32 v5, 7, v2
    v_add_u32 v5, 24576, v5
    v_xor_b32 v12, 0, v4
    v_lshl_add_u32 v12, v12, 4, v5
    v_xor_b32 v13, 2, v4
    v_lshl_add_u32 v13, v13, 4, v5
    v_xor_b32 v14, 4, v4
    v_lshl_add_u32 v14, v14, 4, v5
    v_xor_b32 v15, 6, v4
    v_lshl_add_u32 v15, v15, 4, v5
    v_or_b32 v6, 16, v2
    v_bfe_u32 v4, v6, 1, 3
    v_xor_b32 v4, v4, v3
    v_lshlrev_b32 v5, 7, v6
    v_add_u32 v5, 47104, v5
    v_xor_b32 v24, 0, v4
    v_lshl_add_u32 v24, v24, 4, v5
    v_xor_b32 v25, 2, v4
    v_lshl_add_u32 v25, v25, 4, v5
    v_xor_b32 v26, 4, v4
    v_lshl_add_u32 v26, v26, 4, v5
    v_xor_b32 v27, 6, v4
    v_lshl_add_u32 v27, v27, 4, v5
    s_mul_i32 s6, s9, 56
    v_bfe_u32 v4, v1, 4, 1
    v_lshlrev_b32 v4, 5, v4
    v_and_b32 v5, 3, v1
    v_lshl_add_u32 v4, v5, 3, v4
    v_add_u32 v4, s6, v4
    v_bfe_u32 v5, v1, 3, 1
    v_lshlrev_b32 v5, 6, v5
    v_xor_b32 v4, v4, v5
    v_bfe_u32 v5, v1, 2, 2
    v_lshl_add_u32 v5, v3, 3, v5
    v_lshl_add_u32 v36, v5, 7, v4
    v_add_u32 v16, 51200, v12
    v_add_u32 v28, 51200, v24
    v_add_u32 v17, 51200, v13
    v_add_u32 v29, 51200, v25
    v_add_u32 v18, 51200, v14
    v_add_u32 v30, 51200, v26
    v_add_u32 v19, 51200, v15
    v_add_u32 v31, 51200, v27
    v_add_u32 v37, 51200, v36
    v_add_u32 v20, 102400, v12
    v_add_u32 v32, 102400, v24
    v_add_u32 v21, 102400, v13
    v_add_u32 v33, 102400, v25
    v_add_u32 v22, 102400, v14
    v_add_u32 v34, 102400, v26
    v_add_u32 v23, 102400, v15
    v_add_u32 v35, 102400, v27
    v_add_u32 v38, 102400, v36
    s_waitcnt vmcnt(19)
    ds_write_b16 v39, v40 offset:0
    s_waitcnt vmcnt(18)
    v_add_u32 v4, 51200, v39
    ds_write_b16 v4, v41 offset:0
    s_waitcnt vmcnt(17)
    v_add_u32 v4, 102400, v39
    ds_write_b16 v4, v42 offset:0
    s_waitcnt vmcnt(0) lgkmcnt(0)
    s_barrier
    ds_read_b64_tr_b16 a[0:1], v36 offset:0
    ds_read_b64_tr_b16 a[2:3], v36 offset:512
    ds_read_b128 a[12:15], v12 offset:0
    ds_read_b64_tr_b16 a[4:5], v36 offset:8192
    ds_read_b64_tr_b16 a[6:7], v36 offset:8704
    ds_read_b64_tr_b16 a[8:9], v36 offset:16384
    ds_read_b64_tr_b16 a[10:11], v36 offset:16896
    ds_read_b128 a[16:19], v12 offset:8192
    ds_read_b128 a[20:23], v12 offset:16384
    s_waitcnt lgkmcnt(6)
    v_mfma_f32_32x32x16_bf16 v[96:111], a[0:3], a[12:15], 0
    ds_read_b128 a[24:27], v24 offset:0
    s_add_u32 m0, s4, 51200
    s_add_u32 s35, s10, 172032
    s_waitcnt lgkmcnt(5)
    v_mfma_f32_32x32x16_bf16 v[112:127], a[4:7], a[12:15], 0
    ds_read_b64_tr_b16 a[28:29], v36 offset:2048
    ds_read_b64_tr_b16 a[30:31], v36 offset:2560
    ds_read_b128 a[40:43], v13 offset:0
    s_waitcnt lgkmcnt(6)
    v_mfma_f32_32x32x16_bf16 v[128:143], a[12:15], a[8:11], 0
    ds_read_b64_tr_b16 a[32:33], v36 offset:10240
    ds_read_b64_tr_b16 a[34:35], v36 offset:10752
    s_waitcnt lgkmcnt(6)
    v_mfma_f32_32x32x16_bf16 v[144:159], a[0:3], a[16:19], 0
    ds_read_b64_tr_b16 a[36:37], v36 offset:18432
    ds_read_b64_tr_b16 a[38:39], v36 offset:18944
    v_mfma_f32_32x32x16_bf16 v[160:175], a[4:7], a[16:19], 0
    ds_read_b128 a[44:47], v13 offset:8192
    s_mov_b64 exec, s[22:23]
    buffer_load_dwordx4 v9, s[44:47], s35 offen lds
    s_mov_b64 exec, -1
    v_mfma_f32_32x32x16_bf16 v[176:191], a[16:19], a[8:11], 0
    s_add_u32 m0, s4, 59392
    s_add_u32 s35, s10, 172928
    buffer_load_dwordx4 v9, s[44:47], s35 offen lds
    v_mfma_f32_32x32x16_bf16 v[192:207], a[0:3], a[20:23], 0
    s_add_u32 m0, s4, 67584
    s_add_u32 s35, s10, 173824
    buffer_load_dwordx4 v9, s[44:47], s35 offen lds
    v_mfma_f32_32x32x16_bf16 v[208:223], a[4:7], a[20:23], 0
    ds_read_b128 a[48:51], v13 offset:16384
    s_add_u32 m0, s4, 75776
    s_add_u32 s35, s12, 128
    buffer_load_dwordx4 v8, s[40:43], s35 offen lds
    v_mfma_f32_32x32x16_bf16 v[224:239], a[20:23], a[8:11], 0
    s_add_u32 m0, s4, 79872
    s_add_u32 s35, s13, 128
    buffer_load_dwordx4 v8, s[40:43], s35 offen lds
    s_waitcnt lgkmcnt(2)
    v_mfma_f32_32x32x16_bf16 v[240:255], a[4:7], a[24:27], 0
    s_add_u32 m0, s4, 83968
    s_add_u32 s35, s14, 128
    buffer_load_dwordx4 v8, s[40:43], s35 offen lds
    v_mfma_f32_32x32x16_bf16 v[96:111], a[28:31], a[40:43], v[96:111]
    ds_read_b128 a[52:55], v25 offset:0
    s_add_u32 m0, s4, 88064
    s_add_u32 s35, s15, 128
    buffer_load_dwordx4 v8, s[40:43], s35 offen lds
    v_mfma_f32_32x32x16_bf16 v[112:127], a[32:35], a[40:43], v[112:127]
    ds_read_b64_tr_b16 a[56:57], v36 offset:4096
    ds_read_b64_tr_b16 a[58:59], v36 offset:4608
    ds_read_b128 a[68:71], v14 offset:0
    s_add_u32 m0, s4, 55296
    s_add_u32 s35, s10, 258048
    v_mfma_f32_32x32x16_bf16 v[128:143], a[40:43], a[36:39], v[128:143]
    ds_read_b64_tr_b16 a[60:61], v36 offset:12288
    ds_read_b64_tr_b16 a[62:63], v36 offset:12800
    s_mov_b64 exec, s[22:23]
    buffer_load_dwordx4 v9, s[44:47], s35 offen lds
    s_mov_b64 exec, -1
    s_waitcnt lgkmcnt(6)
    v_mfma_f32_32x32x16_bf16 v[144:159], a[28:31], a[44:47], v[144:159]
    ds_read_b64_tr_b16 a[64:65], v36 offset:20480
    ds_read_b64_tr_b16 a[66:67], v36 offset:20992
    s_add_u32 m0, s4, 63488
    s_add_u32 s35, s10, 258944
    v_mfma_f32_32x32x16_bf16 v[160:175], a[32:35], a[44:47], v[160:175]
    ds_read_b128 a[72:75], v14 offset:8192
    buffer_load_dwordx4 v9, s[44:47], s35 offen lds
    s_add_u32 m0, s4, 71680
    s_add_u32 s35, s10, 259840
    v_mfma_f32_32x32x16_bf16 v[176:191], a[44:47], a[36:39], v[176:191]
    buffer_load_dwordx4 v9, s[44:47], s35 offen lds
    s_add_u32 m0, s4, 92160
    s_add_u32 s35, s38, 128
    v_mfma_f32_32x32x16_bf16 v[192:207], a[28:31], a[48:51], v[192:207]
    buffer_load_dwordx4 v8, s[40:43], s35 offen lds
    s_add_u32 m0, s4, 96256
    s_add_u32 s35, s39, 128
    v_mfma_f32_32x32x16_bf16 v[208:223], a[32:35], a[48:51], v[208:223]
    ds_read_b128 a[76:79], v14 offset:16384
    buffer_load_dwordx4 v8, s[40:43], s35 offen lds
    s_add_u32 m0, s5, 100352
    s_mov_b32 s35, 128
    v_mfma_f32_32x32x16_bf16 v[224:239], a[48:51], a[36:39], v[224:239]
    s_mov_b32 exec_hi, 0
    buffer_load_dwordx4 v10, s[40:43], s35 offen lds
    s_mov_b64 exec, -1
    s_add_u32 m0, s4, 102400
    s_add_u32 s35, s10, 344064
    s_waitcnt lgkmcnt(2)
    v_mfma_f32_32x32x16_bf16 v[240:255], a[32:35], a[52:55], v[240:255]
    s_mov_b64 exec, s[22:23]
    buffer_load_dwordx4 v9, s[44:47], s35 offen lds
    s_mov_b64 exec, -1
    v_mfma_f32_32x32x16_bf16 v[96:111], a[56:59], a[68:71], v[96:111]
    ds_read_b128 a[80:83], v26 offset:0
    s_add_u32 m0, s4, 110592
    s_add_u32 s35, s10, 344960
    buffer_load_dwordx4 v9, s[44:47], s35 offen lds
    v_mfma_f32_32x32x16_bf16 v[112:127], a[60:63], a[68:71], v[112:127]
    ds_read_b64_tr_b16 a[84:85], v36 offset:6144
    ds_read_b64_tr_b16 a[86:87], v36 offset:6656
    ds_read_b128 a[96:99], v15 offset:0
    s_add_u32 m0, s4, 118784
    s_add_u32 s35, s10, 345856
    v_mfma_f32_32x32x16_bf16 v[128:143], a[68:71], a[64:67], v[128:143]
    ds_read_b64_tr_b16 a[88:89], v36 offset:14336
    ds_read_b64_tr_b16 a[90:91], v36 offset:14848
    buffer_load_dwordx4 v9, s[44:47], s35 offen lds
    s_waitcnt lgkmcnt(6)
    v_mfma_f32_32x32x16_bf16 v[144:159], a[56:59], a[72:75], v[144:159]
    ds_read_b64_tr_b16 a[92:93], v36 offset:22528
    ds_read_b64_tr_b16 a[94:95], v36 offset:23040
    s_add_u32 m0, s4, 126976
    s_add_u32 s35, s12, 256
    v_mfma_f32_32x32x16_bf16 v[160:175], a[60:63], a[72:75], v[160:175]
    ds_read_b128 a[100:103], v15 offset:8192
    buffer_load_dwordx4 v8, s[40:43], s35 offen lds
    s_add_u32 m0, s4, 131072
    s_add_u32 s35, s13, 256
    v_mfma_f32_32x32x16_bf16 v[176:191], a[72:75], a[64:67], v[176:191]
    buffer_load_dwordx4 v8, s[40:43], s35 offen lds
    s_add_u32 m0, s4, 135168
    s_add_u32 s35, s14, 256
    v_mfma_f32_32x32x16_bf16 v[192:207], a[56:59], a[76:79], v[192:207]
    buffer_load_dwordx4 v8, s[40:43], s35 offen lds
    s_add_u32 m0, s4, 139264
    s_add_u32 s35, s15, 256
    v_mfma_f32_32x32x16_bf16 v[208:223], a[60:63], a[76:79], v[208:223]
    ds_read_b128 a[104:107], v15 offset:16384
    buffer_load_dwordx4 v8, s[40:43], s35 offen lds
    s_add_u32 m0, s4, 106496
    s_add_u32 s35, s10, 430080
    v_mfma_f32_32x32x16_bf16 v[224:239], a[76:79], a[64:67], v[224:239]
    s_mov_b64 exec, s[22:23]
    buffer_load_dwordx4 v9, s[44:47], s35 offen lds
    s_mov_b64 exec, -1
    s_add_u32 m0, s4, 114688
    s_add_u32 s35, s10, 430976
    s_waitcnt lgkmcnt(2)
    v_mfma_f32_32x32x16_bf16 v[240:255], a[60:63], a[80:83], v[240:255]
    buffer_load_dwordx4 v9, s[44:47], s35 offen lds
    s_add_u32 m0, s4, 122880
    s_add_u32 s35, s10, 431872
    v_mfma_f32_32x32x16_bf16 v[96:111], a[84:87], a[96:99], v[96:111]
    ds_read_b128 a[108:111], v27 offset:0
    buffer_load_dwordx4 v9, s[44:47], s35 offen lds
    s_add_u32 m0, s4, 143360
    s_add_u32 s35, s38, 256
    v_mfma_f32_32x32x16_bf16 v[112:127], a[88:91], a[96:99], v[112:127]
    buffer_load_dwordx4 v8, s[40:43], s35 offen lds
    s_add_u32 m0, s4, 147456
    s_add_u32 s35, s39, 256
    v_mfma_f32_32x32x16_bf16 v[128:143], a[96:99], a[92:95], v[128:143]
    buffer_load_dwordx4 v8, s[40:43], s35 offen lds
    s_add_u32 m0, s5, 151552
    s_mov_b32 s35, 256
    s_waitcnt lgkmcnt(1)
    v_mfma_f32_32x32x16_bf16 v[144:159], a[84:87], a[100:103], v[144:159]
    s_waitcnt vmcnt(12) lgkmcnt(0)
    s_barrier
    ds_read_b64_tr_b16 a[112:113], v37 offset:0
    ds_read_b64_tr_b16 a[114:115], v37 offset:512
    ds_read_b128 a[124:127], v16 offset:0
    v_mfma_f32_32x32x16_bf16 v[160:175], a[88:91], a[100:103], v[160:175]
    ds_read_b64_tr_b16 a[116:117], v37 offset:8192
    ds_read_b64_tr_b16 a[118:119], v37 offset:8704
    ds_read_b64_tr_b16 a[120:121], v37 offset:16384
    v_mfma_f32_32x32x16_bf16 v[176:191], a[100:103], a[92:95], v[176:191]
    ds_read_b64_tr_b16 a[122:123], v37 offset:16896
    ds_read_b128 a[0:3], v16 offset:8192
    s_mov_b32 exec_hi, 0
    buffer_load_dwordx4 v10, s[40:43], s35 offen lds
    s_mov_b64 exec, -1
    v_mfma_f32_32x32x16_bf16 v[192:207], a[84:87], a[104:107], v[192:207]
    s_add_u32 m0, s4, 0
    s_add_u32 s35, s10, 516096
    s_add_u32 s56, s36, 9437184
    s_addc_u32 s57, s37, 0
    s_mov_b32 s59, 0x00020000
    s_lshl_b32 s2, s7, 1
    s_add_u32 s2, s2, s9
    s_cmp_eq_u32 s2, 1
    s_cselect_b32 s58, 8192, 0
    v_mfma_f32_32x32x16_bf16 v[208:223], a[88:91], a[104:107], v[208:223]
    ds_read_b128 a[4:7], v16 offset:16384
    s_mul_i32 s11, s8, 884736
    s_lshl_b32 s2, s2, 11
    s_add_u32 s11, s11, s2
    s_add_u32 s11, s11, 0
    s_mul_i32 s2, s8, 768
    s_add_u32 s2, s2, 0
    v_mfma_f32_32x32x16_bf16 v[224:239], a[104:107], a[92:95], v[224:239]
    s_mov_b64 exec, s[22:23]
    buffer_load_dwordx4 v9, s[44:47], s35 offen lds
    s_mov_b64 exec, -1
    s_add_u32 m0, s4, 8192
    s_add_u32 s35, s10, 516992
    v_mfma_f32_32x32x16_bf16 v[240:255], a[88:91], a[108:111], v[240:255]
    s_mov_b32 s60, 0xff
    s_mov_b32 s61, 0xff0
    s_mov_b32 s62, 0x1fe
    s_mov_b32 s63, 0x1fe0
    s_mov_b32 s64, 0x3fc
    s_mov_b32 s65, 0x3fc0
    s_waitcnt lgkmcnt(1)
    v_mfma_f32_32x32x16_bf16 v[96:111], a[112:115], a[124:127], v[96:111]
    ds_read_b128 a[8:11], v28 offset:0
    s_mov_b32 s66, 0x7f8
    s_mov_b32 s67, 0x7f80
    s_mov_b32 s68, 0xff00
    s_mov_b32 s69, 0xff000
    v_mfma_f32_32x32x16_bf16 v[112:127], a[116:119], a[124:127], v[112:127]
    ds_read_b64_tr_b16 a[12:13], v37 offset:2048
    ds_read_b64_tr_b16 a[14:15], v37 offset:2560
    ds_read_b128 a[24:27], v17 offset:0
    buffer_load_dwordx4 v9, s[44:47], s35 offen lds
    v_mfma_f32_32x32x16_bf16 v[128:143], a[124:127], a[120:123], v[128:143]
    ds_read_b64_tr_b16 a[16:17], v37 offset:10240
    ds_read_b64_tr_b16 a[18:19], v37 offset:10752
    s_add_u32 m0, s4, 16384
    s_add_u32 s35, s10, 517888
    s_mov_b32 s70, 0x1fe00
    s_mov_b32 s71, 0x1fe000
    v_mfma_f32_32x32x16_bf16 v[144:159], a[112:115], a[0:3], v[144:159]
    ds_read_b64_tr_b16 a[20:21], v37 offset:18432
    ds_read_b64_tr_b16 a[22:23], v37 offset:18944
    s_mov_b32 s72, 0x3fc00
    s_mov_b32 s73, 0x3fc000
    s_mov_b32 s74, 0x7f800
    s_mov_b32 s75, 0x7f8000
    v_mfma_f32_32x32x16_bf16 v[160:175], a[116:119], a[0:3], v[160:175]
    ds_read_b128 a[28:31], v17 offset:8192
    buffer_load_dwordx4 v9, s[44:47], s35 offen lds
    s_add_u32 m0, s4, 24576
    s_add_u32 s35, s12, 384
    v_mfma_f32_32x32x16_bf16 v[176:191], a[0:3], a[120:123], v[176:191]
    s_mov_b32 s76, 0xff0000
    s_mov_b32 s77, 0xff00000
    s_mov_b32 s78, 0x1fe0000
    s_mov_b32 s79, 0x1fe00000
    s_mov_b32 s80, 0x3fc0000
    s_mov_b32 s81, 0x3fc00000
    s_waitcnt lgkmcnt(8)
    v_mfma_f32_32x32x16_bf16 v[192:207], a[112:115], a[4:7], v[192:207]
    s_mov_b32 s82, 0x7f80000
    s_mov_b32 s83, 0x7f800000
    s_mov_b32 s84, 0xff000000
    s_mov_b32 s85, 0xf0000000
    v_mfma_f32_32x32x16_bf16 v[208:223], a[116:119], a[4:7], v[208:223]
    ds_read_b128 a[32:35], v17 offset:16384
    buffer_load_dwordx4 v8, s[40:43], s35 offen lds
    s_add_u32 m0, s4, 28672
    s_add_u32 s35, s13, 384
    v_mfma_f32_32x32x16_bf16 v[224:239], a[4:7], a[120:123], v[224:239]
    s_mov_b32 s86, 0xfe000000
    s_mov_b32 s87, 0xe0000000
    s_mov_b32 s88, 0xfc000000
    s_mov_b32 s89, 0xc0000000
    s_mov_b32 s90, 0xf8000000
    s_mov_b32 s91, 0x80000000
    v_mfma_f32_32x32x16_bf16 v[240:255], a[116:119], a[8:11], v[240:255]
    s_cmp_eq_u32 s8, 0
    s_cselect_b64 s[26:27], 0, -1
    s_mov_b32 s24, 0xffffffff
    s_mov_b32 s25, 0x0
    v_mov_b32 v51, 0xff800000
    v_mov_b32 v50, 0x3fb8aa3b
    s_waitcnt lgkmcnt(1)
    v_mfma_f32_32x32x16_bf16 v[96:111], a[12:15], a[24:27], v[96:111]
    ds_read_b128 a[36:39], v29 offset:0
    buffer_load_dwordx4 v8, s[40:43], s35 offen lds
    v_mov_b32 v62, 0xffff
    v_mfma_f32_32x32x16_bf16 v[112:127], a[16:19], a[24:27], v[112:127]
    ds_read_b64_tr_b16 a[40:41], v37 offset:4096
    ds_read_b64_tr_b16 a[42:43], v37 offset:4608
    ds_read_b128 a[52:55], v18 offset:0
    s_add_u32 m0, s4, 32768
    s_add_u32 s35, s14, 384
    v_mov_b32 v63, 0xffff0000
    v_mfma_f32_32x32x16_bf16 v[128:143], a[24:27], a[20:23], v[128:143]
    ds_read_b64_tr_b16 a[44:45], v37 offset:12288
    ds_read_b64_tr_b16 a[46:47], v37 offset:12800
    v_cndmask_b32 v52, 0, v62, s[60:61]
    v_cndmask_b32 v68, 0, v63, s[62:63]
    v_or_b32 v52, v52, v68
    v_cndmask_b32 v53, 0, v62, s[64:65]
    v_mfma_f32_32x32x16_bf16 v[144:159], a[12:15], a[28:31], v[144:159]
    ds_read_b64_tr_b16 a[48:49], v37 offset:20480
    ds_read_b64_tr_b16 a[50:51], v37 offset:20992
    buffer_load_dwordx4 v8, s[40:43], s35 offen lds
    v_cndmask_b32 v68, 0, v63, s[66:67]
    v_mfma_f32_32x32x16_bf16 v[160:175], a[16:19], a[28:31], v[160:175]
    ds_read_b128 a[56:59], v18 offset:8192
    s_add_u32 m0, s4, 36864
    s_add_u32 s35, s15, 384
    v_or_b32 v53, v53, v68
    v_cndmask_b32 v54, 0, v62, s[68:69]
    v_cndmask_b32 v68, 0, v63, s[70:71]
    v_mfma_f32_32x32x16_bf16 v[176:191], a[28:31], a[20:23], v[176:191]
    v_or_b32 v54, v54, v68
    v_cndmask_b32 v55, 0, v62, s[72:73]
    v_cndmask_b32 v68, 0, v63, s[74:75]
    v_or_b32 v55, v55, v68
    v_cndmask_b32 v56, 0, v62, s[76:77]
    v_cndmask_b32 v68, 0, v63, s[78:79]
    s_waitcnt lgkmcnt(8)
    v_mfma_f32_32x32x16_bf16 v[192:207], a[12:15], a[32:35], v[192:207]
    buffer_load_dwordx4 v8, s[40:43], s35 offen lds
    s_add_u32 m0, s4, 4096
    s_add_u32 s35, s10, 602112
    v_mfma_f32_32x32x16_bf16 v[208:223], a[16:19], a[32:35], v[208:223]
    ds_read_b128 a[60:63], v18 offset:16384
    v_or_b32 v56, v56, v68
    v_cndmask_b32 v57, 0, v62, s[80:81]
    v_cndmask_b32 v68, 0, v63, s[82:83]
    v_or_b32 v57, v57, v68
    v_cndmask_b32 v58, 0, v62, s[84:85]
    v_mfma_f32_32x32x16_bf16 v[224:239], a[32:35], a[20:23], v[224:239]
    v_cndmask_b32 v68, 0, v63, s[86:87]
    v_or_b32 v58, v58, v68
    v_cndmask_b32 v59, 0, v62, s[88:89]
    v_cndmask_b32 v68, 0, v63, s[90:91]
    v_or_b32 v59, v59, v68
    v_or3_b32 v60, v52, v54, v56
    v_mfma_f32_32x32x16_bf16 v[240:255], a[16:19], a[36:39], v[240:255]
    s_mov_b64 exec, s[22:23]
    buffer_load_dwordx4 v9, s[44:47], s35 offen lds
    s_mov_b64 exec, -1
    s_add_u32 m0, s4, 12288
    s_add_u32 s35, s10, 603008
    s_waitcnt lgkmcnt(1)
    v_mfma_f32_32x32x16_bf16 v[96:111], a[40:43], a[52:55], v[96:111]
    ds_read_b128 a[64:67], v30 offset:0
    v_or_b32 v60, v60, v58
    v_not_b32 v60, v60
    v_or3_b32 v61, v53, v55, v57
    v_or_b32 v61, v61, v59
    v_mfma_f32_32x32x16_bf16 v[112:127], a[44:47], a[52:55], v[112:127]
    ds_read_b64_tr_b16 a[68:69], v37 offset:6144
    ds_read_b64_tr_b16 a[70:71], v37 offset:6656
    ds_read_b128 a[80:83], v19 offset:0
    v_not_b32 v61, v61
    v_lshlrev_b32 v47, 2, v2
    v_cndmask_b32 v47, v47, v63, s[24:25]
    v_mfma_f32_32x32x16_bf16 v[128:143], a[52:55], a[48:51], v[128:143]
    ds_read_b64_tr_b16 a[72:73], v37 offset:14336
    ds_read_b64_tr_b16 a[74:75], v37 offset:14848
    buffer_load_dwordx4 v9, s[44:47], s35 offen lds
    v_mfma_f32_32x32x16_bf16 v[144:159], a[40:43], a[56:59], v[144:159]
    ds_read_b64_tr_b16 a[76:77], v37 offset:22528
    ds_read_b64_tr_b16 a[78:79], v37 offset:23040
    s_add_u32 m0, s4, 20480
    s_add_u32 s35, s10, 603904
    v_mfma_f32_32x32x16_bf16 v[160:175], a[44:47], a[56:59], v[160:175]
    ds_read_b128 a[84:87], v19 offset:8192
    s_lshl_b32 s6, s9, 11
    s_add_u32 s6, s6, 153600
    v_add_u32 v48, s6, v11
    v_mfma_f32_32x32x16_bf16 v[176:191], a[56:59], a[48:51], v[176:191]
    buffer_load_dwordx4 v9, s[44:47], s35 offen lds
    s_add_u32 m0, s4, 40960
    s_add_u32 s35, s38, 384
    s_waitcnt lgkmcnt(8)
    v_mfma_f32_32x32x16_bf16 v[192:207], a[40:43], a[60:63], v[192:207]
    s_lshl_b32 s6, s9, 9
    s_add_u32 s6, s6, 157696
    v_lshl_add_u32 v49, v1, 3, s6
    v_mfma_f32_32x32x16_bf16 v[208:223], a[44:47], a[60:63], v[208:223]
    ds_read_b128 a[88:91], v19 offset:16384
    s_mov_b32 s48, s28
    s_mov_b32 s49, s29
    s_mov_b32 s50, 1605632
    s_mov_b32 s51, 0x00020000
    s_mul_i32 s34, s3, 12288
    s_add_u32 s34, s34, 51200
    v_lshrrev_b32 v4, 3, v1
    v_bfe_u32 v5, v1, 4, 1
    v_lshlrev_b32 v5, 2, v5
    v_and_b32 v6, 7, v1
    v_xor_b32 v5, v5, v6
    v_mul_u32_u24 v4, 896, v4
    v_lshl_add_u32 v40, v5, 4, v4
    v_mfma_f32_32x32x16_bf16 v[224:239], a[60:63], a[48:51], v[224:239]
    buffer_load_dwordx4 v8, s[40:43], s35 offen lds
    s_add_u32 m0, s4, 45056
    s_add_u32 s35, s39, 384
    v_mfma_f32_32x32x16_bf16 v[240:255], a[44:47], a[64:67], v[240:255]
    v_bfe_u32 v4, v1, 4, 1
    v_lshlrev_b32 v4, 5, v4
    v_and_b32 v5, 3, v1
    v_lshl_add_u32 v4, v5, 3, v4
    v_bfe_u32 v5, v1, 3, 1
    v_lshl_add_u32 v4, v5, 6, v4
    v_bfe_u32 v5, v1, 2, 2
    v_lshl_add_u32 v5, v3, 2, v5
    v_lshl_add_u32 v4, v5, 7, v4
    v_add_u32 v41, s34, v4
    v_xor_b32 v42, 64, v41
    s_waitcnt lgkmcnt(1)
    v_mfma_f32_32x32x16_bf16 v[96:111], a[68:71], a[80:83], v[96:111]
    ds_read_b128 a[92:95], v31 offset:0
    v_mfma_f32_32x32x16_bf16 v[112:127], a[72:75], a[80:83], v[112:127]
    buffer_load_dwordx4 v8, s[40:43], s35 offen lds
    s_add_u32 m0, s5, 49152
    s_mov_b32 s35, 384
    v_mfma_f32_32x32x16_bf16 v[128:143], a[80:83], a[76:79], v[128:143]
    v_mfma_f32_32x32x16_bf16 v[144:159], a[68:71], a[84:87], v[144:159]
    s_waitcnt vmcnt(12) lgkmcnt(0)
    s_barrier
    ds_read_b64_tr_b16 a[96:97], v38 offset:0
    ds_read_b64_tr_b16 a[98:99], v38 offset:512
    ds_read_b128 a[108:111], v20 offset:0
    v_mfma_f32_32x32x16_bf16 v[160:175], a[72:75], a[84:87], v[160:175]
    ds_read_b64_tr_b16 a[100:101], v38 offset:8192
    ds_read_b64_tr_b16 a[102:103], v38 offset:8704
    ds_read_b64_tr_b16 a[104:105], v38 offset:16384
    v_mfma_f32_32x32x16_bf16 v[176:191], a[84:87], a[76:79], v[176:191]
    ds_read_b64_tr_b16 a[106:107], v38 offset:16896
    ds_read_b128 a[112:115], v20 offset:8192
    s_mov_b32 exec_hi, 0
    buffer_load_dwordx4 v10, s[40:43], s35 offen lds
    s_mov_b64 exec, -1
    v_mfma_f32_32x32x16_bf16 v[192:207], a[68:71], a[88:91], v[192:207]
    ds_write_b16 v39, v43 offset:0
    s_add_u32 m0, s4, 51200
    s_add_u32 s35, s10, 688128
    v_mfma_f32_32x32x16_bf16 v[208:223], a[72:75], a[88:91], v[208:223]
    ds_read_b128 a[116:119], v20 offset:16384
    v_mfma_f32_32x32x16_bf16 v[224:239], a[88:91], a[76:79], v[224:239]
    s_mov_b64 exec, s[22:23]
    buffer_load_dwordx4 v9, s[44:47], s35 offen lds
    s_mov_b64 exec, -1
    s_add_u32 m0, s4, 59392
    s_add_u32 s35, s10, 689024
    v_mfma_f32_32x32x16_bf16 v[240:255], a[72:75], a[92:95], v[240:255]
    s_waitcnt lgkmcnt(2)
    v_mfma_f32_32x32x16_bf16 v[96:111], a[96:99], a[108:111], v[96:111]
    ds_read_b128 a[120:123], v32 offset:0
    v_mfma_f32_32x32x16_bf16 v[112:127], a[100:103], a[108:111], v[112:127]
    ds_read_b64_tr_b16 a[124:125], v38 offset:2048
    ds_read_b64_tr_b16 a[126:127], v38 offset:2560
    ds_read_b128 a[8:11], v21 offset:0
    buffer_load_dwordx4 v9, s[44:47], s35 offen lds
    v_mfma_f32_32x32x16_bf16 v[128:143], a[108:111], a[104:107], v[128:143]
    ds_read_b64_tr_b16 a[0:1], v38 offset:10240
    ds_read_b64_tr_b16 a[2:3], v38 offset:10752
    s_add_u32 m0, s4, 67584
    s_add_u32 s35, s10, 689920
    v_mfma_f32_32x32x16_bf16 v[144:159], a[96:99], a[112:115], v[144:159]
    ds_read_b64_tr_b16 a[4:5], v38 offset:18432
    ds_read_b64_tr_b16 a[6:7], v38 offset:18944
    v_mfma_f32_32x32x16_bf16 v[160:175], a[100:103], a[112:115], v[160:175]
    ds_read_b128 a[12:15], v21 offset:8192
    buffer_load_dwordx4 v9, s[44:47], s35 offen lds
    s_add_u32 m0, s4, 75776
    s_add_u32 s35, s12, 512
    v_mfma_f32_32x32x16_bf16 v[176:191], a[112:115], a[104:107], v[176:191]
    s_waitcnt lgkmcnt(8)
    v_mfma_f32_32x32x16_bf16 v[192:207], a[96:99], a[116:119], v[192:207]
    v_mfma_f32_32x32x16_bf16 v[208:223], a[100:103], a[116:119], v[208:223]
    ds_read_b128 a[16:19], v21 offset:16384
    buffer_load_dwordx4 v8, s[40:43], s35 offen lds
    s_add_u32 m0, s4, 79872
    s_add_u32 s35, s13, 512
    v_mfma_f32_32x32x16_bf16 v[224:239], a[116:119], a[104:107], v[224:239]
    v_mfma_f32_32x32x16_bf16 v[240:255], a[100:103], a[120:123], v[240:255]
    s_waitcnt lgkmcnt(1)
    v_mfma_f32_32x32x16_bf16 v[96:111], a[124:127], a[8:11], v[96:111]
    ds_read_b128 a[20:23], v33 offset:0
    buffer_load_dwordx4 v8, s[40:43], s35 offen lds
    v_mfma_f32_32x32x16_bf16 v[112:127], a[0:3], a[8:11], v[112:127]
    ds_read_b64_tr_b16 a[24:25], v38 offset:4096
    ds_read_b64_tr_b16 a[26:27], v38 offset:4608
    ds_read_b128 a[36:39], v22 offset:0
    s_add_u32 m0, s4, 83968
    s_add_u32 s35, s14, 512
    v_mfma_f32_32x32x16_bf16 v[128:143], a[8:11], a[4:7], v[128:143]
    ds_read_b64_tr_b16 a[28:29], v38 offset:12288
    ds_read_b64_tr_b16 a[30:31], v38 offset:12800
    v_mfma_f32_32x32x16_bf16 v[144:159], a[124:127], a[12:15], v[144:159]
    ds_read_b64_tr_b16 a[32:33], v38 offset:20480
    ds_read_b64_tr_b16 a[34:35], v38 offset:20992
    buffer_load_dwordx4 v8, s[40:43], s35 offen lds
    v_mfma_f32_32x32x16_bf16 v[160:175], a[0:3], a[12:15], v[160:175]
    ds_read_b128 a[40:43], v22 offset:8192
    s_add_u32 m0, s4, 88064
    s_add_u32 s35, s15, 512
    v_mfma_f32_32x32x16_bf16 v[176:191], a[12:15], a[4:7], v[176:191]
    s_waitcnt lgkmcnt(8)
    v_mfma_f32_32x32x16_bf16 v[192:207], a[124:127], a[16:19], v[192:207]
    buffer_load_dwordx4 v8, s[40:43], s35 offen lds
    s_add_u32 m0, s4, 55296
    s_add_u32 s35, s10, 774144
    v_mfma_f32_32x32x16_bf16 v[208:223], a[0:3], a[16:19], v[208:223]
    ds_read_b128 a[44:47], v22 offset:16384
    v_mfma_f32_32x32x16_bf16 v[224:239], a[16:19], a[4:7], v[224:239]
    v_mfma_f32_32x32x16_bf16 v[240:255], a[0:3], a[20:23], v[240:255]
    s_mov_b64 exec, s[22:23]
    buffer_load_dwordx4 v9, s[44:47], s35 offen lds
    s_mov_b64 exec, -1
    s_add_u32 m0, s4, 63488
    s_add_u32 s35, s10, 775040
    s_waitcnt lgkmcnt(1)
    v_mfma_f32_32x32x16_bf16 v[96:111], a[24:27], a[36:39], v[96:111]
    ds_read_b128 a[48:51], v34 offset:0
    v_mfma_f32_32x32x16_bf16 v[112:127], a[28:31], a[36:39], v[112:127]
    ds_read_b64_tr_b16 a[52:53], v38 offset:6144
    ds_read_b64_tr_b16 a[54:55], v38 offset:6656
    ds_read_b128 a[64:67], v23 offset:0
    v_mfma_f32_32x32x16_bf16 v[128:143], a[36:39], a[32:35], v[128:143]
    ds_read_b64_tr_b16 a[56:57], v38 offset:14336
    ds_read_b64_tr_b16 a[58:59], v38 offset:14848
    buffer_load_dwordx4 v9, s[44:47], s35 offen lds
    v_mfma_f32_32x32x16_bf16 v[144:159], a[24:27], a[40:43], v[144:159]
    ds_read_b64_tr_b16 a[60:61], v38 offset:22528
    ds_read_b64_tr_b16 a[62:63], v38 offset:23040
    s_add_u32 m0, s4, 71680
    s_add_u32 s35, s10, 775936
    v_mfma_f32_32x32x16_bf16 v[160:175], a[28:31], a[40:43], v[160:175]
    ds_read_b128 a[68:71], v23 offset:8192
    v_mfma_f32_32x32x16_bf16 v[176:191], a[40:43], a[32:35], v[176:191]
    buffer_load_dwordx4 v9, s[44:47], s35 offen lds
    s_add_u32 m0, s4, 92160
    s_add_u32 s35, s38, 512
    s_waitcnt lgkmcnt(8)
    v_mfma_f32_32x32x16_bf16 v[192:207], a[24:27], a[44:47], v[192:207]
    v_mfma_f32_32x32x16_bf16 v[208:223], a[28:31], a[44:47], v[208:223]
    ds_read_b128 a[72:75], v23 offset:16384
    v_mfma_f32_32x32x16_bf16 v[224:239], a[44:47], a[32:35], v[224:239]
    buffer_load_dwordx4 v8, s[40:43], s35 offen lds
    s_add_u32 m0, s4, 96256
    s_add_u32 s35, s39, 512
    v_mfma_f32_32x32x16_bf16 v[240:255], a[28:31], a[48:51], v[240:255]
    s_waitcnt lgkmcnt(1)
    v_mfma_f32_32x32x16_bf16 v[96:111], a[52:55], a[64:67], v[96:111]
    ds_read_b128 a[76:79], v35 offset:0
    v_mfma_f32_32x32x16_bf16 v[112:127], a[56:59], a[64:67], v[112:127]
    buffer_load_dwordx4 v8, s[40:43], s35 offen lds
    s_add_u32 m0, s5, 100352
    s_mov_b32 s35, 512
    v_mfma_f32_32x32x16_bf16 v[128:143], a[64:67], a[60:63], v[128:143]
    v_mfma_f32_32x32x16_bf16 v[144:159], a[52:55], a[68:71], v[144:159]
    s_waitcnt vmcnt(12) lgkmcnt(0)
    s_barrier
    ds_read_b64_tr_b16 a[80:81], v36 offset:0
    ds_read_b64_tr_b16 a[82:83], v36 offset:512
    ds_read_b128 a[92:95], v12 offset:0
    v_mfma_f32_32x32x16_bf16 v[160:175], a[56:59], a[68:71], v[160:175]
    ds_read_b64_tr_b16 a[84:85], v36 offset:8192
    ds_read_b64_tr_b16 a[86:87], v36 offset:8704
    ds_read_b64_tr_b16 a[88:89], v36 offset:16384
    v_mfma_f32_32x32x16_bf16 v[176:191], a[68:71], a[60:63], v[176:191]
    ds_read_b64_tr_b16 a[90:91], v36 offset:16896
    ds_read_b128 a[96:99], v12 offset:8192
    s_mov_b32 exec_hi, 0
    buffer_load_dwordx4 v10, s[40:43], s35 offen lds
    s_mov_b64 exec, -1
    v_mfma_f32_32x32x16_bf16 v[192:207], a[52:55], a[72:75], v[192:207]
    v_add_u32 v4, 51200, v39
    ds_write_b16 v4, v44 offset:0
    s_add_u32 m0, s4, 102400
    s_add_u32 s35, s10, 860160
    v_mfma_f32_32x32x16_bf16 v[208:223], a[56:59], a[72:75], v[208:223]
    ds_read_b128 a[100:103], v12 offset:16384
    v_mfma_f32_32x32x16_bf16 v[224:239], a[72:75], a[60:63], v[224:239]
    s_mov_b64 exec, s[22:23]
    buffer_load_dwordx4 v9, s[44:47], s35 offen lds
    s_mov_b64 exec, -1
    s_add_u32 m0, s4, 110592
    s_add_u32 s35, s10, 861056
    v_mfma_f32_32x32x16_bf16 v[240:255], a[56:59], a[76:79], v[240:255]
    s_waitcnt lgkmcnt(2)
    v_mfma_f32_32x32x16_bf16 v[96:111], a[80:83], a[92:95], v[96:111]
    ds_read_b128 a[104:107], v24 offset:0
    v_mfma_f32_32x32x16_bf16 v[112:127], a[84:87], a[92:95], v[112:127]
    ds_read_b64_tr_b16 a[108:109], v36 offset:2048
    ds_read_b64_tr_b16 a[110:111], v36 offset:2560
    ds_read_b128 a[120:123], v13 offset:0
    buffer_load_dwordx4 v9, s[44:47], s35 offen lds
    v_mfma_f32_32x32x16_bf16 v[128:143], a[92:95], a[88:91], v[128:143]
    ds_read_b64_tr_b16 a[112:113], v36 offset:10240
    ds_read_b64_tr_b16 a[114:115], v36 offset:10752
    s_add_u32 m0, s4, 118784
    s_add_u32 s35, s10, 861952
    v_mfma_f32_32x32x16_bf16 v[144:159], a[80:83], a[96:99], v[144:159]
    ds_read_b64_tr_b16 a[116:117], v36 offset:18432
    ds_read_b64_tr_b16 a[118:119], v36 offset:18944
    v_mfma_f32_32x32x16_bf16 v[160:175], a[84:87], a[96:99], v[160:175]
    ds_read_b128 a[124:127], v13 offset:8192
    buffer_load_dwordx4 v9, s[44:47], s35 offen lds
    s_add_u32 m0, s4, 126976
    s_add_u32 s35, s12, 640
    v_mfma_f32_32x32x16_bf16 v[176:191], a[96:99], a[88:91], v[176:191]
    s_waitcnt lgkmcnt(8)
    v_mfma_f32_32x32x16_bf16 v[192:207], a[80:83], a[100:103], v[192:207]
    v_mfma_f32_32x32x16_bf16 v[208:223], a[84:87], a[100:103], v[208:223]
    ds_read_b128 a[0:3], v13 offset:16384
    buffer_load_dwordx4 v8, s[40:43], s35 offen lds
    s_add_u32 m0, s4, 131072
    s_add_u32 s35, s13, 640
    v_mfma_f32_32x32x16_bf16 v[224:239], a[100:103], a[88:91], v[224:239]
    v_mfma_f32_32x32x16_bf16 v[240:255], a[84:87], a[104:107], v[240:255]
    s_waitcnt lgkmcnt(1)
    v_mfma_f32_32x32x16_bf16 v[96:111], a[108:111], a[120:123], v[96:111]
    ds_read_b128 a[4:7], v25 offset:0
    buffer_load_dwordx4 v8, s[40:43], s35 offen lds
    v_mfma_f32_32x32x16_bf16 v[112:127], a[112:115], a[120:123], v[112:127]
    ds_read_b64_tr_b16 a[8:9], v36 offset:4096
    ds_read_b64_tr_b16 a[10:11], v36 offset:4608
    ds_read_b128 a[20:23], v14 offset:0
    s_add_u32 m0, s4, 135168
    s_add_u32 s35, s14, 640
    v_mfma_f32_32x32x16_bf16 v[128:143], a[120:123], a[116:119], v[128:143]
    ds_read_b64_tr_b16 a[12:13], v36 offset:12288
    ds_read_b64_tr_b16 a[14:15], v36 offset:12800
    v_mfma_f32_32x32x16_bf16 v[144:159], a[108:111], a[124:127], v[144:159]
    ds_read_b64_tr_b16 a[16:17], v36 offset:20480
    ds_read_b64_tr_b16 a[18:19], v36 offset:20992
    buffer_load_dwordx4 v8, s[40:43], s35 offen lds
    v_mfma_f32_32x32x16_bf16 v[160:175], a[112:115], a[124:127], v[160:175]
    ds_read_b128 a[24:27], v14 offset:8192
    s_add_u32 m0, s4, 139264
    s_add_u32 s35, s15, 640
    v_mfma_f32_32x32x16_bf16 v[176:191], a[124:127], a[116:119], v[176:191]
    s_waitcnt lgkmcnt(8)
    v_mfma_f32_32x32x16_bf16 v[192:207], a[108:111], a[0:3], v[192:207]
    buffer_load_dwordx4 v8, s[40:43], s35 offen lds
    s_add_u32 m0, s4, 106496
    s_add_u32 s35, s10, 946176
    v_mfma_f32_32x32x16_bf16 v[208:223], a[112:115], a[0:3], v[208:223]
    ds_read_b128 a[28:31], v14 offset:16384
    v_mfma_f32_32x32x16_bf16 v[224:239], a[0:3], a[116:119], v[224:239]
    v_mfma_f32_32x32x16_bf16 v[240:255], a[112:115], a[4:7], v[240:255]
    s_mov_b64 exec, s[22:23]
    buffer_load_dwordx4 v9, s[44:47], s35 offen lds
    s_mov_b64 exec, -1
    s_add_u32 m0, s4, 114688
    s_add_u32 s35, s10, 947072
    s_waitcnt lgkmcnt(1)
    v_mfma_f32_32x32x16_bf16 v[96:111], a[8:11], a[20:23], v[96:111]
    ds_read_b128 a[32:35], v26 offset:0
    v_mfma_f32_32x32x16_bf16 v[112:127], a[12:15], a[20:23], v[112:127]
    ds_read_b64_tr_b16 a[36:37], v36 offset:6144
    ds_read_b64_tr_b16 a[38:39], v36 offset:6656
    ds_read_b128 a[48:51], v15 offset:0
    v_mfma_f32_32x32x16_bf16 v[128:143], a[20:23], a[16:19], v[128:143]
    ds_read_b64_tr_b16 a[40:41], v36 offset:14336
    ds_read_b64_tr_b16 a[42:43], v36 offset:14848
    buffer_load_dwordx4 v9, s[44:47], s35 offen lds
    v_mfma_f32_32x32x16_bf16 v[144:159], a[8:11], a[24:27], v[144:159]
    ds_read_b64_tr_b16 a[44:45], v36 offset:22528
    ds_read_b64_tr_b16 a[46:47], v36 offset:23040
    s_add_u32 m0, s4, 122880
    s_add_u32 s35, s10, 947968
    v_mfma_f32_32x32x16_bf16 v[160:175], a[12:15], a[24:27], v[160:175]
    ds_read_b128 a[52:55], v15 offset:8192
    v_mfma_f32_32x32x16_bf16 v[176:191], a[24:27], a[16:19], v[176:191]
    buffer_load_dwordx4 v9, s[44:47], s35 offen lds
    s_add_u32 m0, s4, 143360
    s_add_u32 s35, s38, 640
    s_waitcnt lgkmcnt(8)
    v_mfma_f32_32x32x16_bf16 v[192:207], a[8:11], a[28:31], v[192:207]
    v_mfma_f32_32x32x16_bf16 v[208:223], a[12:15], a[28:31], v[208:223]
    ds_read_b128 a[56:59], v15 offset:16384
    v_mfma_f32_32x32x16_bf16 v[224:239], a[28:31], a[16:19], v[224:239]
    buffer_load_dwordx4 v8, s[40:43], s35 offen lds
    s_add_u32 m0, s4, 147456
    s_add_u32 s35, s39, 640
    v_mfma_f32_32x32x16_bf16 v[240:255], a[12:15], a[32:35], v[240:255]
    s_waitcnt lgkmcnt(1)
    v_mfma_f32_32x32x16_bf16 v[96:111], a[36:39], a[48:51], v[96:111]
    ds_read_b128 a[60:63], v27 offset:0
    v_mfma_f32_32x32x16_bf16 v[112:127], a[40:43], a[48:51], v[112:127]
    buffer_load_dwordx4 v8, s[40:43], s35 offen lds
    s_add_u32 m0, s5, 151552
    s_mov_b32 s35, 640
    v_mfma_f32_32x32x16_bf16 v[128:143], a[48:51], a[44:47], v[128:143]
    v_mfma_f32_32x32x16_bf16 v[144:159], a[36:39], a[52:55], v[144:159]
    s_waitcnt vmcnt(12) lgkmcnt(0)
    s_barrier
    ds_read_b64_tr_b16 a[64:65], v37 offset:0
    ds_read_b64_tr_b16 a[66:67], v37 offset:512
    ds_read_b128 a[76:79], v16 offset:0
    v_mfma_f32_32x32x16_bf16 v[160:175], a[40:43], a[52:55], v[160:175]
    ds_read_b64_tr_b16 a[68:69], v37 offset:8192
    ds_read_b64_tr_b16 a[70:71], v37 offset:8704
    ds_read_b64_tr_b16 a[72:73], v37 offset:16384
    v_mfma_f32_32x32x16_bf16 v[176:191], a[52:55], a[44:47], v[176:191]
    ds_read_b64_tr_b16 a[74:75], v37 offset:16896
    ds_read_b128 a[80:83], v16 offset:8192
    s_mov_b32 exec_hi, 0
    buffer_load_dwordx4 v10, s[40:43], s35 offen lds
    s_mov_b64 exec, -1
    v_mfma_f32_32x32x16_bf16 v[192:207], a[36:39], a[56:59], v[192:207]
    v_add_u32 v4, 102400, v39
    ds_write_b16 v4, v45 offset:0
    s_add_u32 m0, s4, 0
    s_add_u32 s35, s10, 1032192
    v_mfma_f32_32x32x16_bf16 v[208:223], a[40:43], a[56:59], v[208:223]
    ds_read_b128 a[84:87], v16 offset:16384
    v_mfma_f32_32x32x16_bf16 v[224:239], a[56:59], a[44:47], v[224:239]
    s_mov_b64 exec, s[22:23]
    buffer_load_dwordx4 v9, s[44:47], s35 offen lds
    s_mov_b64 exec, -1
    s_add_u32 m0, s4, 8192
    s_add_u32 s35, s10, 1033088
    v_mfma_f32_32x32x16_bf16 v[240:255], a[40:43], a[60:63], v[240:255]
    s_waitcnt lgkmcnt(2)
    v_mfma_f32_32x32x16_bf16 v[96:111], a[64:67], a[76:79], v[96:111]
    ds_read_b128 a[88:91], v28 offset:0
    v_mfma_f32_32x32x16_bf16 v[112:127], a[68:71], a[76:79], v[112:127]
    ds_read_b64_tr_b16 a[92:93], v37 offset:2048
    ds_read_b64_tr_b16 a[94:95], v37 offset:2560
    ds_read_b128 a[104:107], v17 offset:0
    buffer_load_dwordx4 v9, s[44:47], s35 offen lds
    v_mfma_f32_32x32x16_bf16 v[128:143], a[76:79], a[72:75], v[128:143]
    ds_read_b64_tr_b16 a[96:97], v37 offset:10240
    ds_read_b64_tr_b16 a[98:99], v37 offset:10752
    s_add_u32 m0, s4, 16384
    s_add_u32 s35, s10, 1033984
    v_mfma_f32_32x32x16_bf16 v[144:159], a[64:67], a[80:83], v[144:159]
    ds_read_b64_tr_b16 a[100:101], v37 offset:18432
    ds_read_b64_tr_b16 a[102:103], v37 offset:18944
    v_mfma_f32_32x32x16_bf16 v[160:175], a[68:71], a[80:83], v[160:175]
    ds_read_b128 a[108:111], v17 offset:8192
    buffer_load_dwordx4 v9, s[44:47], s35 offen lds
    s_add_u32 m0, s4, 24576
    s_add_u32 s35, s12, 768
    v_mfma_f32_32x32x16_bf16 v[176:191], a[80:83], a[72:75], v[176:191]
    s_waitcnt lgkmcnt(8)
    v_mfma_f32_32x32x16_bf16 v[192:207], a[64:67], a[84:87], v[192:207]
    v_mfma_f32_32x32x16_bf16 v[208:223], a[68:71], a[84:87], v[208:223]
    ds_read_b128 a[112:115], v17 offset:16384
    buffer_load_dwordx4 v8, s[40:43], s35 offen lds
    s_add_u32 m0, s4, 28672
    s_add_u32 s35, s13, 768
    v_mfma_f32_32x32x16_bf16 v[224:239], a[84:87], a[72:75], v[224:239]
    v_mfma_f32_32x32x16_bf16 v[240:255], a[68:71], a[88:91], v[240:255]
    s_waitcnt lgkmcnt(1)
    v_mfma_f32_32x32x16_bf16 v[96:111], a[92:95], a[104:107], v[96:111]
    ds_read_b128 a[116:119], v29 offset:0
    buffer_load_dwordx4 v8, s[40:43], s35 offen lds
    v_mfma_f32_32x32x16_bf16 v[112:127], a[96:99], a[104:107], v[112:127]
    ds_read_b64_tr_b16 a[120:121], v37 offset:4096
    ds_read_b64_tr_b16 a[122:123], v37 offset:4608
    ds_read_b128 a[4:7], v18 offset:0
    s_add_u32 m0, s4, 32768
    s_add_u32 s35, s14, 768
    v_mfma_f32_32x32x16_bf16 v[128:143], a[104:107], a[100:103], v[128:143]
    ds_read_b64_tr_b16 a[124:125], v37 offset:12288
    ds_read_b64_tr_b16 a[126:127], v37 offset:12800
    v_mfma_f32_32x32x16_bf16 v[144:159], a[92:95], a[108:111], v[144:159]
    ds_read_b64_tr_b16 a[0:1], v37 offset:20480
    ds_read_b64_tr_b16 a[2:3], v37 offset:20992
    buffer_load_dwordx4 v8, s[40:43], s35 offen lds
    v_mfma_f32_32x32x16_bf16 v[160:175], a[96:99], a[108:111], v[160:175]
    ds_read_b128 a[8:11], v18 offset:8192
    s_add_u32 m0, s4, 36864
    s_add_u32 s35, s15, 768
    v_mfma_f32_32x32x16_bf16 v[176:191], a[108:111], a[100:103], v[176:191]
    s_waitcnt lgkmcnt(8)
    v_mfma_f32_32x32x16_bf16 v[192:207], a[92:95], a[112:115], v[192:207]
    buffer_load_dwordx4 v8, s[40:43], s35 offen lds
    s_add_u32 m0, s4, 4096
    s_add_u32 s35, s10, 1118208
    v_mfma_f32_32x32x16_bf16 v[208:223], a[96:99], a[112:115], v[208:223]
    ds_read_b128 a[12:15], v18 offset:16384
    v_mfma_f32_32x32x16_bf16 v[224:239], a[112:115], a[100:103], v[224:239]
    v_mfma_f32_32x32x16_bf16 v[240:255], a[96:99], a[116:119], v[240:255]
    s_mov_b64 exec, s[22:23]
    buffer_load_dwordx4 v9, s[44:47], s35 offen lds
    s_mov_b64 exec, -1
    s_add_u32 m0, s4, 12288
    s_add_u32 s35, s10, 1119104
    s_waitcnt lgkmcnt(1)
    v_mfma_f32_32x32x16_bf16 v[96:111], a[120:123], a[4:7], v[96:111]
    ds_read_b128 a[16:19], v30 offset:0
    v_mfma_f32_32x32x16_bf16 v[112:127], a[124:127], a[4:7], v[112:127]
    ds_read_b64_tr_b16 a[20:21], v37 offset:6144
    ds_read_b64_tr_b16 a[22:23], v37 offset:6656
    ds_read_b128 a[32:35], v19 offset:0
    v_mfma_f32_32x32x16_bf16 v[128:143], a[4:7], a[0:3], v[128:143]
    ds_read_b64_tr_b16 a[24:25], v37 offset:14336
    ds_read_b64_tr_b16 a[26:27], v37 offset:14848
    buffer_load_dwordx4 v9, s[44:47], s35 offen lds
    v_mfma_f32_32x32x16_bf16 v[144:159], a[120:123], a[8:11], v[144:159]
    ds_read_b64_tr_b16 a[28:29], v37 offset:22528
    ds_read_b64_tr_b16 a[30:31], v37 offset:23040
    s_add_u32 m0, s4, 20480
    s_add_u32 s35, s10, 1120000
    v_mfma_f32_32x32x16_bf16 v[160:175], a[124:127], a[8:11], v[160:175]
    ds_read_b128 a[36:39], v19 offset:8192
    v_mfma_f32_32x32x16_bf16 v[176:191], a[8:11], a[0:3], v[176:191]
    buffer_load_dwordx4 v9, s[44:47], s35 offen lds
    s_add_u32 m0, s4, 40960
    s_add_u32 s35, s38, 768
    s_waitcnt lgkmcnt(8)
    v_mfma_f32_32x32x16_bf16 v[192:207], a[120:123], a[12:15], v[192:207]
    v_mfma_f32_32x32x16_bf16 v[208:223], a[124:127], a[12:15], v[208:223]
    ds_read_b128 a[40:43], v19 offset:16384
    v_mfma_f32_32x32x16_bf16 v[224:239], a[12:15], a[0:3], v[224:239]
    buffer_load_dwordx4 v8, s[40:43], s35 offen lds
    s_add_u32 m0, s4, 45056
    s_add_u32 s35, s39, 768
    v_mfma_f32_32x32x16_bf16 v[240:255], a[124:127], a[16:19], v[240:255]
    s_waitcnt lgkmcnt(1)
    v_mfma_f32_32x32x16_bf16 v[96:111], a[20:23], a[32:35], v[96:111]
    ds_read_b128 a[44:47], v31 offset:0
    v_mfma_f32_32x32x16_bf16 v[112:127], a[24:27], a[32:35], v[112:127]
    buffer_load_dwordx4 v8, s[40:43], s35 offen lds
    s_add_u32 m0, s5, 49152
    s_mov_b32 s35, 768
    v_mfma_f32_32x32x16_bf16 v[128:143], a[32:35], a[28:31], v[128:143]
    v_mfma_f32_32x32x16_bf16 v[144:159], a[20:23], a[36:39], v[144:159]
    s_waitcnt vmcnt(12) lgkmcnt(0)
    s_barrier
    ds_read_b64_tr_b16 a[48:49], v38 offset:0
    ds_read_b64_tr_b16 a[50:51], v38 offset:512
    ds_read_b128 a[56:59], v20 offset:0
    v_mfma_f32_32x32x16_bf16 v[160:175], a[24:27], a[36:39], v[160:175]
    ds_read_b64_tr_b16 a[52:53], v38 offset:8192
    ds_read_b64_tr_b16 a[54:55], v38 offset:8704
    ds_read_b128 a[60:63], v20 offset:8192
    v_mfma_f32_32x32x16_bf16 v[176:191], a[36:39], a[28:31], v[176:191]
    ds_read_b128 a[64:67], v20 offset:16384
    s_mov_b32 exec_hi, 0
    buffer_load_dwordx4 v10, s[40:43], s35 offen lds
    s_mov_b64 exec, -1
    v_mfma_f32_32x32x16_bf16 v[192:207], a[20:23], a[40:43], v[192:207]
    ds_write_b16 v39, v46 offset:0
    s_add_u32 s95, s94, 0
    s_and_b32 s95, s95, 3
    s_sub_i32 s95, s97, s95
    s_add_i32 s35, s95, 7
    s_cmp_lt_i32 s95, 0
    s_cselect_b32 s95, s35, s95
    s_mul_i32 s95, s95, 57344
    s_add_u32 s95, s95, s32
    s_add_u32 m0, s34, 0
    s_add_u32 s35, s95, 0
    buffer_load_dwordx4 v40, s[48:51], s35 offen lds
    s_add_u32 m0, s34, 1024
    s_add_u32 s35, s95, 7168
    buffer_load_dwordx4 v40, s[48:51], s35 offen lds
    v_mfma_f32_32x32x16_bf16 v[208:223], a[24:27], a[40:43], v[208:223]
    ds_read_b128 a[68:71], v32 offset:0
    s_add_u32 m0, s34, 2048
    s_add_u32 s35, s95, 14336
    buffer_load_dwordx4 v40, s[48:51], s35 offen lds
    s_add_u32 m0, s34, 3072
    s_add_u32 s35, s95, 21504
    buffer_load_dwordx4 v40, s[48:51], s35 offen lds
    v_mfma_f32_32x32x16_bf16 v[224:239], a[40:43], a[28:31], v[224:239]
    ds_read_b64_tr_b16 a[72:73], v38 offset:2048
    ds_read_b64_tr_b16 a[74:75], v38 offset:2560
    ds_read_b128 a[80:83], v21 offset:0
    v_mfma_f32_32x32x16_bf16 v[240:255], a[24:27], a[44:47], v[240:255]
    ds_read_b64_tr_b16 a[76:77], v38 offset:10240
    s_add_u32 m0, s34, 4096
    s_add_u32 s35, s95, 28672
    buffer_load_dwordx4 v40, s[48:51], s35 offen lds
    s_add_u32 m0, s34, 5120
    s_add_u32 s35, s95, 35840
    buffer_load_dwordx4 v40, s[48:51], s35 offen lds
    s_waitcnt lgkmcnt(7)
    v_mfma_f32_32x32x16_bf16 v[96:111], a[48:51], a[56:59], v[96:111]
    ds_read_b64_tr_b16 a[78:79], v38 offset:10752
    ds_read_b128 a[84:87], v21 offset:8192
    v_mfma_f32_32x32x16_bf16 v[112:127], a[52:55], a[56:59], v[112:127]
    s_add_u32 m0, s34, 6144
    s_add_u32 s35, s95, 43008
    buffer_load_dwordx4 v40, s[48:51], s35 offen lds
    s_add_u32 m0, s34, 7168
    s_add_u32 s35, s95, 50176
    buffer_load_dwordx4 v40, s[48:51], s35 offen lds
    v_mfma_f32_32x32x16_bf16 v[144:159], a[48:51], a[60:63], v[144:159]
    ds_read_b128 a[88:91], v21 offset:16384
    s_add_u32 s95, s94, 1
    s_and_b32 s95, s95, 3
    s_sub_i32 s95, s97, s95
    s_add_i32 s35, s95, 7
    s_cmp_lt_i32 s95, 0
    s_cselect_b32 s95, s35, s95
    s_mul_i32 s95, s95, 57344
    s_add_u32 s95, s95, s32
    s_add_u32 m0, s34, 8192
    s_add_u32 s35, s95, 0
    buffer_load_dwordx4 v40, s[48:51], s35 offen lds
    s_add_u32 m0, s34, 9216
    s_add_u32 s35, s95, 7168
    buffer_load_dwordx4 v40, s[48:51], s35 offen lds
    v_mfma_f32_32x32x16_bf16 v[160:175], a[52:55], a[60:63], v[160:175]
    s_add_u32 m0, s34, 10240
    s_add_u32 s35, s95, 14336
    buffer_load_dwordx4 v40, s[48:51], s35 offen lds
    s_add_u32 m0, s34, 11264
    s_add_u32 s35, s95, 21504
    buffer_load_dwordx4 v40, s[48:51], s35 offen lds
    s_waitcnt lgkmcnt(4)
    v_mfma_f32_32x32x16_bf16 v[192:207], a[48:51], a[64:67], v[192:207]
    ds_read_b128 a[92:95], v33 offset:0
    v_mfma_f32_32x32x16_bf16 v[208:223], a[52:55], a[64:67], v[208:223]
    ds_read_b64_tr_b16 a[96:97], v38 offset:4096
    ds_read_b64_tr_b16 a[98:99], v38 offset:4608
    ds_read_b128 a[104:107], v22 offset:0
    v_mfma_f32_32x32x16_bf16 v[240:255], a[52:55], a[68:71], v[240:255]
    ds_read_b64_tr_b16 a[100:101], v38 offset:12288
    ds_read_b64_tr_b16 a[102:103], v38 offset:12800
    v_mfma_f32_32x32x16_bf16 v[96:111], a[72:75], a[80:83], v[96:111]
    ds_read_b128 a[108:111], v22 offset:8192
    s_waitcnt lgkmcnt(7)
    v_mfma_f32_32x32x16_bf16 v[112:127], a[76:79], a[80:83], v[112:127]
    v_mfma_f32_32x32x16_bf16 v[144:159], a[72:75], a[84:87], v[144:159]
    ds_read_b128 a[112:115], v22 offset:16384
    v_mfma_f32_32x32x16_bf16 v[160:175], a[76:79], a[84:87], v[160:175]
    v_mfma_f32_32x32x16_bf16 v[192:207], a[72:75], a[88:91], v[192:207]
    ds_read_b128 a[116:119], v34 offset:0
    v_mfma_f32_32x32x16_bf16 v[208:223], a[76:79], a[88:91], v[208:223]
    ds_read_b64_tr_b16 a[120:121], v38 offset:6144
    ds_read_b64_tr_b16 a[122:123], v38 offset:6656
    ds_read_b128 a[0:3], v23 offset:0
    s_waitcnt lgkmcnt(5)
    v_mfma_f32_32x32x16_bf16 v[240:255], a[76:79], a[92:95], v[240:255]
    ds_read_b64_tr_b16 a[124:125], v38 offset:14336
    ds_read_b64_tr_b16 a[126:127], v38 offset:14848
    v_mfma_f32_32x32x16_bf16 v[96:111], a[96:99], a[104:107], v[96:111]
    ds_read_b128 a[4:7], v23 offset:8192
    v_mfma_f32_32x32x16_bf16 v[112:127], a[100:103], a[104:107], v[112:127]
    v_mfma_f32_32x32x16_bf16 v[144:159], a[96:99], a[108:111], v[144:159]
    ds_read_b128 a[8:11], v23 offset:16384
    v_mfma_f32_32x32x16_bf16 v[160:175], a[100:103], a[108:111], v[160:175]
    s_waitcnt lgkmcnt(4)
    v_mfma_f32_32x32x16_bf16 v[192:207], a[96:99], a[112:115], v[192:207]
    ds_read_b128 a[12:15], v35 offset:0
    v_mfma_f32_32x32x16_bf16 v[208:223], a[100:103], a[112:115], v[208:223]
    v_mfma_f32_32x32x16_bf16 v[240:255], a[100:103], a[116:119], v[240:255]
    v_mfma_f32_32x32x16_bf16 v[96:111], a[120:123], a[0:3], v[96:111]
    s_waitcnt vmcnt(12) lgkmcnt(0)
    s_barrier
    ds_read_b64_tr_b16 a[16:17], v36 offset:0
    ds_read_b64_tr_b16 a[18:19], v36 offset:512
    ds_read_b128 a[24:27], v12 offset:0
    v_mfma_f32_32x32x16_bf16 v[112:127], a[124:127], a[0:3], v[112:127]
    ds_read_b64_tr_b16 a[20:21], v36 offset:8192
    ds_read_b64_tr_b16 a[22:23], v36 offset:8704
    ds_read_b128 a[28:31], v12 offset:8192
    v_mfma_f32_32x32x16_bf16 v[144:159], a[120:123], a[4:7], v[144:159]
    ds_read_b128 a[32:35], v12 offset:16384
    v_mfma_f32_32x32x16_bf16 v[160:175], a[124:127], a[4:7], v[160:175]
    v_mfma_f32_32x32x16_bf16 v[192:207], a[120:123], a[8:11], v[192:207]
    ds_read_b128 a[36:39], v24 offset:0
    v_mfma_f32_32x32x16_bf16 v[208:223], a[124:127], a[8:11], v[208:223]
    ds_read_b64_tr_b16 a[40:41], v36 offset:2048
    ds_read_b64_tr_b16 a[42:43], v36 offset:2560
    ds_read_b128 a[48:51], v13 offset:0
    v_mfma_f32_32x32x16_bf16 v[240:255], a[124:127], a[12:15], v[240:255]
    ds_read_b64_tr_b16 a[44:45], v36 offset:10240
    ds_read_b64_tr_b16 a[46:47], v36 offset:10752
    s_waitcnt vmcnt(10)
    ds_read_b64_tr_b16 a[144:145], v41 offset:0
    ds_read_b64_tr_b16 a[146:147], v41 offset:1024
    s_waitcnt lgkmcnt(7)
    ds_read_b64_tr_b16 a[148:149], v42 offset:0
    ds_read_b64_tr_b16 a[150:151], v42 offset:1024
    v_mfma_f32_32x32x16_bf16 v[96:111], a[16:19], a[24:27], v[96:111]
    ds_read_b128 a[52:55], v13 offset:8192
    s_waitcnt vmcnt(8)
    ds_read_b64_tr_b16 a[152:153], v41 offset:2048
    ds_read_b64_tr_b16 a[154:155], v41 offset:3072
    ds_read_b64_tr_b16 a[156:157], v42 offset:2048
    ds_read_b64_tr_b16 a[158:159], v42 offset:3072
    v_mfma_f32_32x32x16_bf16 v[112:127], a[20:23], a[24:27], v[112:127]
    s_waitcnt vmcnt(6)
    ds_read_b64_tr_b16 a[160:161], v41 offset:4096
    s_waitcnt lgkmcnt(7)
    ds_read_b64_tr_b16 a[162:163], v41 offset:5120
    ds_read_b64_tr_b16 a[164:165], v42 offset:4096
    ds_read_b64_tr_b16 a[166:167], v42 offset:5120
    v_mfma_f32_32x32x16_bf16 v[144:159], a[16:19], a[28:31], v[144:159]
    ds_read_b128 a[56:59], v13 offset:16384
    v_mfma_f32_32x32x16_bf16 v[160:175], a[20:23], a[28:31], v[160:175]
    s_waitcnt vmcnt(4)
    ds_read_b64_tr_b16 a[168:169], v41 offset:6144
    ds_read_b64_tr_b16 a[170:171], v41 offset:7168
    ds_read_b64_tr_b16 a[172:173], v42 offset:6144
    ds_read_b64_tr_b16 a[174:175], v42 offset:7168
    v_mfma_f32_32x32x16_bf16 v[192:207], a[16:19], a[32:35], v[192:207]
    s_waitcnt vmcnt(2)
    s_waitcnt lgkmcnt(7)
    ds_read_b64_tr_b16 a[176:177], v41 offset:8192
    ds_read_b64_tr_b16 a[178:179], v41 offset:9216
    ds_read_b64_tr_b16 a[180:181], v42 offset:8192
    ds_read_b64_tr_b16 a[182:183], v42 offset:9216
    v_mfma_f32_32x32x16_bf16 v[208:223], a[20:23], a[32:35], v[208:223]
    ds_read_b128 a[60:63], v25 offset:0
    ds_read_b64_tr_b16 a[64:65], v36 offset:4096
    s_waitcnt vmcnt(0)
    ds_read_b64_tr_b16 a[184:185], v41 offset:10240
    ds_read_b64_tr_b16 a[186:187], v41 offset:11264
    s_waitcnt lgkmcnt(7)
    ds_read_b64_tr_b16 a[188:189], v42 offset:10240
    ds_read_b64_tr_b16 a[190:191], v42 offset:11264
    v_mfma_f32_32x32x16_bf16 v[240:255], a[20:23], a[36:39], v[240:255]
    ds_read_b64_tr_b16 a[66:67], v36 offset:4608
    ds_read_b128 a[72:75], v14 offset:0
    ds_read_b64_tr_b16 a[68:69], v36 offset:12288
    v_mfma_f32_32x32x16_bf16 v[96:111], a[40:43], a[48:51], v[96:111]
    ds_read_b64_tr_b16 a[70:71], v36 offset:12800
    s_add_u32 m0, s34, 0
    s_add_u32 s35, s95, 28672
    buffer_load_dwordx4 v40, s[48:51], s35 offen lds
    s_add_u32 m0, s34, 1024
    s_add_u32 s35, s95, 35840
    buffer_load_dwordx4 v40, s[48:51], s35 offen lds
    v_mfma_f32_32x32x16_bf16 v[112:127], a[44:47], a[48:51], v[112:127]
    s_add_u32 m0, s34, 2048
    s_add_u32 s35, s95, 43008
    buffer_load_dwordx4 v40, s[48:51], s35 offen lds
    s_add_u32 m0, s34, 3072
    s_add_u32 s35, s95, 50176
    buffer_load_dwordx4 v40, s[48:51], s35 offen lds
    v_mfma_f32_32x32x16_bf16 v[144:159], a[40:43], a[52:55], v[144:159]
    s_add_u32 s95, s94, 2
    s_and_b32 s95, s95, 3
    s_sub_i32 s95, s97, s95
    s_add_i32 s35, s95, 7
    s_cmp_lt_i32 s95, 0
    s_cselect_b32 s95, s35, s95
    s_mul_i32 s95, s95, 57344
    s_add_u32 s95, s95, s32
    s_add_u32 m0, s34, 4096
    s_add_u32 s35, s95, 0
    buffer_load_dwordx4 v40, s[48:51], s35 offen lds
    s_add_u32 m0, s34, 5120
    s_add_u32 s35, s95, 7168
    buffer_load_dwordx4 v40, s[48:51], s35 offen lds
    v_mfma_f32_32x32x16_bf16 v[160:175], a[44:47], a[52:55], v[160:175]
    s_add_u32 m0, s34, 6144
    s_add_u32 s35, s95, 14336
    buffer_load_dwordx4 v40, s[48:51], s35 offen lds
    s_add_u32 m0, s34, 7168
    s_add_u32 s35, s95, 21504
    buffer_load_dwordx4 v40, s[48:51], s35 offen lds
    v_mfma_f32_32x32x16_bf16 v[192:207], a[40:43], a[56:59], v[192:207]
    v_mfma_f32_32x32x16_bf16 v[208:223], a[44:47], a[56:59], v[208:223]
    ds_read_b128 a[76:79], v14 offset:8192
    s_waitcnt lgkmcnt(1)
    v_mfma_f32_32x32x16_bf16 v[240:255], a[44:47], a[60:63], v[240:255]
    ds_read_b128 a[80:83], v14 offset:16384
    ds_read_b128 a[84:87], v26 offset:0
    ds_read_b64_tr_b16 a[88:89], v36 offset:6144
    v_mfma_f32_32x32x16_bf16 v[96:111], a[64:67], a[72:75], v[96:111]
    ds_read_b64_tr_b16 a[90:91], v36 offset:6656
    ds_read_b128 a[96:99], v15 offset:0
    ds_read_b64_tr_b16 a[92:93], v36 offset:14336
    v_mfma_f32_32x32x16_bf16 v[112:127], a[68:71], a[72:75], v[112:127]
    ds_read_b64_tr_b16 a[94:95], v36 offset:14848
    ds_read_b128 a[100:103], v15 offset:8192
    s_add_u32 m0, s34, 8192
    s_add_u32 s35, s95, 28672
    buffer_load_dwordx4 v40, s[48:51], s35 offen lds
    s_add_u32 m0, s34, 9216
    s_add_u32 s35, s95, 35840
    buffer_load_dwordx4 v40, s[48:51], s35 offen lds
    s_waitcnt lgkmcnt(8)
    v_mfma_f32_32x32x16_bf16 v[144:159], a[64:67], a[76:79], v[144:159]
    ds_read_b128 a[104:107], v15 offset:16384
    s_add_u32 m0, s34, 10240
    s_add_u32 s35, s95, 43008
    buffer_load_dwordx4 v40, s[48:51], s35 offen lds
    s_add_u32 m0, s34, 11264
    s_add_u32 s35, s95, 50176
    buffer_load_dwordx4 v40, s[48:51], s35 offen lds
    v_mfma_f32_32x32x16_bf16 v[160:175], a[68:71], a[76:79], v[160:175]
    s_waitcnt lgkmcnt(4)
    v_mfma_f32_32x32x16_bf16 v[192:207], a[64:67], a[80:83], v[192:207]
    ds_read_b128 a[108:111], v27 offset:0
    v_mfma_f32_32x32x16_bf16 v[208:223], a[68:71], a[80:83], v[208:223]
    ds_read_b64_tr_b16 a[112:113], v38 offset:16384
    ds_read_b64_tr_b16 a[114:115], v38 offset:16896
    ds_read_b128 a[116:119], v20 offset:0
    v_mfma_f32_32x32x16_bf16 v[240:255], a[68:71], a[84:87], v[240:255]
    ds_read_b128 a[120:123], v20 offset:8192
    v_mfma_f32_32x32x16_bf16 v[96:111], a[88:91], a[96:99], v[96:111]
    ds_read_b128 a[124:127], v20 offset:16384
    s_waitcnt lgkmcnt(6)
    v_mfma_f32_32x32x16_bf16 v[112:127], a[92:95], a[96:99], v[112:127]
    ds_read_b64_tr_b16 a[0:1], v38 offset:18432
    ds_read_b64_tr_b16 a[2:3], v38 offset:18944
    ds_read_b128 a[4:7], v21 offset:0
    v_mfma_f32_32x32x16_bf16 v[144:159], a[88:91], a[100:103], v[144:159]
    ds_read_b128 a[8:11], v21 offset:8192
    v_mfma_f32_32x32x16_bf16 v[160:175], a[92:95], a[100:103], v[160:175]
    ds_read_b128 a[12:15], v21 offset:16384
    v_mfma_f32_32x32x16_bf16 v[192:207], a[88:91], a[104:107], v[192:207]
    ds_read_b64_tr_b16 a[16:17], v38 offset:20480
    ds_read_b64_tr_b16 a[18:19], v38 offset:20992
    v_mfma_f32_32x32x16_bf16 v[208:223], a[92:95], a[104:107], v[208:223]
    s_waitcnt lgkmcnt(7)
    v_mfma_f32_32x32x16_bf16 v[240:255], a[92:95], a[108:111], v[240:255]
    ds_read_b128 a[20:23], v22 offset:0
    ds_read_b128 a[24:27], v22 offset:8192
    ds_read_b128 a[28:31], v22 offset:16384
    v_mfma_f32_32x32x16_bf16 v[128:143], a[116:119], a[112:115], v[128:143]
    ds_read_b64_tr_b16 a[32:33], v38 offset:22528
    ds_read_b64_tr_b16 a[34:35], v38 offset:23040
    ds_read_b128 a[36:39], v23 offset:0
    v_mfma_f32_32x32x16_bf16 v[176:191], a[120:123], a[112:115], v[176:191]
    buffer_store_dword v156, v47, s[56:59], s2 offen offset:256 sc1
    v_cvt_pk_bf16_f32 v144, v144, v145
    v_cvt_pk_bf16_f32 v145, v146, v147
    v_cvt_pk_bf16_f32 v146, v148, v149
    v_mfma_f32_32x32x16_bf16 v[224:239], a[124:127], a[112:115], v[224:239]
    v_cvt_pk_bf16_f32 v147, v150, v151
    v_cvt_pk_bf16_f32 v148, v152, v153
    v_cvt_pk_bf16_f32 v149, v154, v155
    v_cvt_pk_bf16_f32 v150, v156, v157
    v_cvt_pk_bf16_f32 v151, v158, v159
    v_cvt_pk_bf16_f32 v160, v160, v161
    s_waitcnt lgkmcnt(5)
    v_mfma_f32_32x32x16_bf16 v[128:143], a[4:7], a[0:3], v[128:143]
    ds_read_b128 a[40:43], v23 offset:8192
    ds_read_b128 a[44:47], v23 offset:16384
    ds_read_b64_tr_b16 a[48:49], v36 offset:16384
    v_cvt_pk_bf16_f32 v161, v162, v163
    v_cvt_pk_bf16_f32 v162, v164, v165
    v_mfma_f32_32x32x16_bf16 v[176:191], a[8:11], a[0:3], v[176:191]
    ds_read_b64_tr_b16 a[50:51], v36 offset:16896
    ds_read_b128 a[52:55], v12 offset:0
    ds_read_b128 a[56:59], v12 offset:8192
    v_cvt_pk_bf16_f32 v163, v166, v167
    v_cvt_pk_bf16_f32 v164, v168, v169
    v_cvt_pk_bf16_f32 v165, v170, v171
    v_mfma_f32_32x32x16_bf16 v[224:239], a[12:15], a[0:3], v[224:239]
    ds_read_b128 a[60:63], v12 offset:16384
    v_cvt_pk_bf16_f32 v166, v172, v173
    v_cvt_pk_bf16_f32 v167, v174, v175
    v_cndmask_b32 v166, 0, v166, s[24:25]
    v_cndmask_b32 v167, 0, v167, s[24:25]
    v_cvt_pk_bf16_f32 v112, v112, v113
    v_mfma_f32_32x32x16_bf16 v[128:143], a[20:23], a[16:19], v[128:143]
    ds_read_b64_tr_b16 a[64:65], v36 offset:18432
    v_cvt_pk_bf16_f32 v113, v114, v115
    v_cvt_pk_bf16_f32 v114, v116, v117
    v_cvt_pk_bf16_f32 v115, v118, v119
    v_cvt_pk_bf16_f32 v116, v120, v121
    v_cvt_pk_bf16_f32 v117, v122, v123
    s_waitcnt lgkmcnt(7)
    v_mfma_f32_32x32x16_bf16 v[176:191], a[24:27], a[16:19], v[176:191]
    ds_read_b64_tr_b16 a[66:67], v36 offset:18944
    ds_read_b128 a[68:71], v13 offset:0
    ds_read_b128 a[72:75], v13 offset:8192
    v_cvt_pk_bf16_f32 v118, v124, v125
    v_cvt_pk_bf16_f32 v119, v126, v127
    v_mfma_f32_32x32x16_bf16 v[224:239], a[28:31], a[16:19], v[224:239]
    ds_read_b128 a[76:79], v13 offset:16384
    v_cndmask_b32 v118, 0, v118, s[24:25]
    v_cndmask_b32 v119, 0, v119, s[24:25]
    v_mfma_f32_32x32x16_bf16 v[64:79], v[160:163], v[144:147], 0
    v_mfma_f32_32x32x16_bf16 v[128:143], a[36:39], a[32:35], v[128:143]
    ds_read_b64_tr_b16 a[80:81], v36 offset:20480
    ds_read_b64_tr_b16 a[82:83], v36 offset:20992
    s_waitcnt vmcnt(11)
    ds_read_b64_tr_b16 a[192:193], v41 offset:0
    ds_read_b64_tr_b16 a[194:195], v41 offset:1024
    s_waitcnt lgkmcnt(7)
    ds_read_b64_tr_b16 a[196:197], v42 offset:0
    ds_read_b64_tr_b16 a[198:199], v42 offset:1024
    v_mfma_f32_32x32x16_bf16 v[80:95], v[112:115], v[144:147], 0
    v_mfma_f32_32x32x16_bf16 v[176:191], a[40:43], a[32:35], v[176:191]
    ds_read_b128 a[84:87], v14 offset:0
    ds_read_b128 a[88:91], v14 offset:8192
    s_waitcnt vmcnt(9)
    ds_read_b64_tr_b16 a[200:201], v41 offset:2048
    ds_read_b64_tr_b16 a[202:203], v41 offset:3072
    ds_read_b64_tr_b16 a[204:205], v42 offset:2048
    ds_read_b64_tr_b16 a[206:207], v42 offset:3072
    v_mfma_f32_32x32x16_bf16 v[64:79], v[164:167], v[148:151], v[64:79]
    v_mfma_f32_32x32x16_bf16 v[224:239], a[44:47], a[32:35], v[224:239]
    s_waitcnt vmcnt(7)
    s_waitcnt lgkmcnt(7)
    ds_read_b64_tr_b16 a[208:209], v41 offset:4096
    ds_read_b64_tr_b16 a[210:211], v41 offset:5120
    ds_read_b64_tr_b16 a[212:213], v42 offset:4096
    ds_read_b64_tr_b16 a[214:215], v42 offset:5120
    v_mfma_f32_32x32x16_bf16 v[80:95], v[116:119], v[148:151], v[80:95]
    v_mfma_f32_32x32x16_bf16 v[128:143], a[52:55], a[48:51], v[128:143]
    ds_read_b128 a[92:95], v14 offset:16384
    ds_read_b64_tr_b16 a[96:97], v36 offset:22528
    s_waitcnt vmcnt(5)
    ds_read_b64_tr_b16 a[216:217], v41 offset:6144
    ds_read_b64_tr_b16 a[218:219], v41 offset:7168
    s_waitcnt lgkmcnt(7)
    ds_read_b64_tr_b16 a[220:221], v42 offset:6144
    ds_read_b64_tr_b16 a[222:223], v42 offset:7168
    v_mfma_f32_32x32x16_bf16 v[176:191], a[56:59], a[48:51], v[176:191]
    ds_read_b64_tr_b16 a[98:99], v36 offset:23040
    ds_read_b128 a[100:103], v15 offset:0
    ds_read_b128 a[104:107], v15 offset:8192
    buffer_store_dword v204, v47, s[56:59], s2 offen offset:512 sc1
    v_mfma_f32_32x32x16_bf16 v[224:239], a[60:63], a[48:51], v[224:239]
    ds_read_b128 a[108:111], v15 offset:16384
    s_add_u32 s95, s94, 3
    s_and_b32 s95, s95, 3
    s_sub_i32 s95, s97, s95
    s_add_i32 s35, s95, 7
    s_cmp_lt_i32 s95, 0
    s_cselect_b32 s95, s35, s95
    s_mul_i32 s95, s95, 57344
    s_add_u32 s95, s95, s32
    s_add_u32 m0, s34, 0
    s_add_u32 s35, s95, 0
    buffer_load_dwordx4 v40, s[48:51], s35 offen lds
    s_add_u32 m0, s34, 1024
    s_add_u32 s35, s95, 7168
    buffer_load_dwordx4 v40, s[48:51], s35 offen lds
    v_mfma_f32_32x32x16_bf16 v[128:143], a[68:71], a[64:67], v[128:143]
    s_add_u32 m0, s34, 2048
    s_add_u32 s35, s95, 14336
    buffer_load_dwordx4 v40, s[48:51], s35 offen lds
    s_add_u32 m0, s34, 3072
    s_add_u32 s35, s95, 21504
    buffer_load_dwordx4 v40, s[48:51], s35 offen lds
    v_mfma_f32_32x32x16_bf16 v[176:191], a[72:75], a[64:67], v[176:191]
    v_cvt_pk_bf16_f32 v192, v192, v193
    v_cvt_pk_bf16_f32 v193, v194, v195
    v_cvt_pk_bf16_f32 v194, v196, v197
    v_cvt_pk_bf16_f32 v195, v198, v199
    v_cvt_pk_bf16_f32 v196, v200, v201
    v_cvt_pk_bf16_f32 v197, v202, v203
    v_mfma_f32_32x32x16_bf16 v[224:239], a[76:79], a[64:67], v[224:239]
    s_waitcnt vmcnt(8)
    ds_read_b64_tr_b16 a[224:225], v41 offset:8192
    ds_read_b64_tr_b16 a[226:227], v41 offset:9216
    s_waitcnt lgkmcnt(7)
    ds_read_b64_tr_b16 a[228:229], v42 offset:8192
    ds_read_b64_tr_b16 a[230:231], v42 offset:9216
    v_cvt_pk_bf16_f32 v198, v204, v205
    v_cndmask_b32 v122, v92, v64, s[60:61]
    v_mfma_f32_32x32x16_bf16 v[128:143], a[84:87], a[80:83], v[128:143]
    s_waitcnt vmcnt(6)
    ds_read_b64_tr_b16 a[232:233], v41 offset:10240
    ds_read_b64_tr_b16 a[234:235], v41 offset:11264
    ds_read_b64_tr_b16 a[236:237], v42 offset:10240
    ds_read_b64_tr_b16 a[238:239], v42 offset:11264
    v_cndmask_b32 v123, v93, v65, s[62:63]
    v_cndmask_b32 v124, v94, v66, s[64:65]
    v_mfma_f32_32x32x16_bf16 v[176:191], a[88:91], a[80:83], v[176:191]
    v_cndmask_b32 v125, v95, v67, s[66:67]
    v_cndmask_b32 v122, v122, v68, s[68:69]
    v_cndmask_b32 v123, v123, v69, s[70:71]
    v_cndmask_b32 v124, v124, v70, s[72:73]
    v_cndmask_b32 v125, v125, v71, s[74:75]
    v_cndmask_b32 v122, v122, v72, s[76:77]
    v_mfma_f32_32x32x16_bf16 v[224:239], a[92:95], a[80:83], v[224:239]
    v_cndmask_b32 v123, v123, v73, s[78:79]
    v_cndmask_b32 v124, v124, v74, s[80:81]
    v_cndmask_b32 v125, v125, v75, s[82:83]
    v_cndmask_b32 v122, v122, v76, s[84:85]
    v_cndmask_b32 v123, v123, v77, s[86:87]
    v_cndmask_b32 v124, v124, v78, s[88:89]
    s_waitcnt lgkmcnt(8)
    v_mfma_f32_32x32x16_bf16 v[128:143], a[100:103], a[96:99], v[128:143]
    v_cndmask_b32 v125, v125, v79, s[90:91]
    v_cvt_pk_bf16_f32 v62, v122, v123
    v_cvt_pk_bf16_f32 v63, v124, v125
    v_lshlrev_b32 v122, 16, v62
    v_and_b32 v123, 0xffff0000, v62
    v_mfma_f32_32x32x16_bf16 v[176:191], a[104:107], a[96:99], v[176:191]
    v_lshlrev_b32 v124, 16, v63
    v_and_b32 v125, 0xffff0000, v63
    v_mul_f32 v122, 0x3e41848f, v122
    v_mul_f32 v123, 0x3e41848f, v123
    v_mul_f32 v124, 0x3e41848f, v124
    v_mul_f32 v125, 0x3e41848f, v125
    v_mfma_f32_32x32x16_bf16 v[224:239], a[108:111], a[96:99], v[224:239]
    v_cvt_pk_bf16_f32 v62, v122, v123
    v_cvt_pk_bf16_f32 v63, v124, v125
    v_lshlrev_b32 v122, 16, v62
    v_and_b32 v123, 0xffff0000, v62
    v_lshlrev_b32 v124, 16, v63
    v_and_b32 v125, 0xffff0000, v63
    v_max3_f32 v126, v122, v123, v124
    v_max_f32 v126, v126, v125
    v_mov_b32 v127, v126
    s_nop 1
    v_permlane32_swap_b32 v126, v127
    v_max_f32 v126, v126, v127
    v_mul_f32 v126, v126, v50
    v_fma_f32 v122, v122, v50, -v126
    v_fma_f32 v123, v123, v50, -v126
    v_fma_f32 v124, v124, v50, -v126
    v_fma_f32 v125, v125, v50, -v126
    v_exp_f32 v122, v122
    v_exp_f32 v123, v123
    v_exp_f32 v124, v124
    v_exp_f32 v125, v125
    v_add_f32 v126, v122, v123
    v_add_f32 v127, v124, v125
    v_add_f32 v126, v126, v127
    v_mov_b32 v127, v126
    s_nop 1
    v_permlane32_swap_b32 v126, v127
    v_add_f32 v126, v126, v127
    v_rcp_f32 v126, v126
    s_nop 0
    v_mul_f32 v122, v122, v126
    v_mul_f32 v123, v123, v126
    v_mul_f32 v124, v124, v126
    v_mul_f32 v125, v125, v126
    v_cvt_pk_bf16_f32 v62, v122, v123
    v_cvt_pk_bf16_f32 v63, v124, v125
    v_and_b32 v152, v62, v52
    v_and_b32 v153, v63, v53
    v_and_b32 v154, v62, v54
    v_and_b32 v155, v63, v55
    v_and_b32 v156, v62, v56
    v_and_b32 v157, v63, v57
    v_and_b32 v158, v62, v58
    v_and_b32 v159, v63, v59
    v_and_b32 v168, v62, v60
    v_and_b32 v169, v63, v61
    v_cvt_pk_bf16_f32 v199, v206, v207
    v_cvt_pk_bf16_f32 v208, v208, v209
    v_cvt_pk_bf16_f32 v209, v210, v211
    v_cvt_pk_bf16_f32 v210, v212, v213
    v_cvt_pk_bf16_f32 v211, v214, v215
    v_cvt_pk_bf16_f32 v212, v216, v217
    v_cvt_pk_bf16_f32 v213, v218, v219
    v_cvt_pk_bf16_f32 v214, v220, v221
    v_cvt_pk_bf16_f32 v215, v222, v223
    v_cndmask_b32 v214, 0, v214, s[24:25]
    v_cndmask_b32 v215, 0, v215, s[24:25]
    v_cvt_pk_bf16_f32 v240, v240, v241
    v_cvt_pk_bf16_f32 v241, v242, v243
    v_cvt_pk_bf16_f32 v242, v244, v245
    v_cvt_pk_bf16_f32 v243, v246, v247
    v_cvt_pk_bf16_f32 v244, v248, v249
    v_cvt_pk_bf16_f32 v245, v250, v251
    v_cvt_pk_bf16_f32 v246, v252, v253
    v_cvt_pk_bf16_f32 v247, v254, v255
    v_cndmask_b32 v246, 0, v246, s[24:25]
    v_cndmask_b32 v247, 0, v247, s[24:25]
    ds_write_b128 v48, v[240:243] offset:0
    ds_write_b128 v48, v[244:247] offset:1024
    v_mfma_f32_32x32x16_bf16 v[64:79], v[208:211], v[192:195], 0
    v_mfma_f32_32x32x16_bf16 v[80:95], v[160:163], v[192:195], 0
    v_mfma_f32_32x32x16_bf16 v[64:79], v[212:215], v[196:199], v[64:79]
    v_mfma_f32_32x32x16_bf16 v[80:95], v[164:167], v[196:199], v[80:95]
    buffer_store_dword v108, v47, s[56:59], s2 offen sc1
    v_cvt_pk_bf16_f32 v96, v96, v97
    v_cvt_pk_bf16_f32 v97, v98, v99
    v_cvt_pk_bf16_f32 v98, v100, v101
    v_cvt_pk_bf16_f32 v99, v102, v103
    v_cvt_pk_bf16_f32 v100, v104, v105
    v_cvt_pk_bf16_f32 v101, v106, v107
    v_cvt_pk_bf16_f32 v102, v108, v109
    v_cvt_pk_bf16_f32 v103, v110, v111
    s_waitcnt lgkmcnt(0)
    s_barrier
    s_nop 0
    v_cndmask_b32 v122, v92, v64, s[60:61]
    v_cndmask_b32 v123, v93, v65, s[62:63]
    v_cndmask_b32 v124, v94, v66, s[64:65]
    v_cndmask_b32 v125, v95, v67, s[66:67]
    v_cndmask_b32 v122, v122, v68, s[68:69]
    v_cndmask_b32 v123, v123, v69, s[70:71]
    v_cndmask_b32 v124, v124, v70, s[72:73]
    v_cndmask_b32 v125, v125, v71, s[74:75]
    v_cndmask_b32 v122, v122, v72, s[76:77]
    v_cndmask_b32 v123, v123, v73, s[78:79]
    v_cndmask_b32 v124, v124, v74, s[80:81]
    v_cndmask_b32 v125, v125, v75, s[82:83]
    v_cndmask_b32 v122, v122, v76, s[84:85]
    v_cndmask_b32 v123, v123, v77, s[86:87]
    v_cndmask_b32 v124, v124, v78, s[88:89]
    v_cndmask_b32 v125, v125, v79, s[90:91]
    v_cvt_pk_bf16_f32 v62, v122, v123
    v_cvt_pk_bf16_f32 v63, v124, v125
    v_lshlrev_b32 v122, 16, v62
    v_and_b32 v123, 0xffff0000, v62
    v_lshlrev_b32 v124, 16, v63
    v_and_b32 v125, 0xffff0000, v63
    v_mul_f32 v122, 0x3e41848f, v122
    v_mul_f32 v123, 0x3e41848f, v123
    v_mul_f32 v124, 0x3e41848f, v124
    v_mul_f32 v125, 0x3e41848f, v125
    v_cvt_pk_bf16_f32 v62, v122, v123
    v_cvt_pk_bf16_f32 v63, v124, v125
    v_lshlrev_b32 v122, 16, v62
    v_and_b32 v123, 0xffff0000, v62
    v_lshlrev_b32 v124, 16, v63
    v_and_b32 v125, 0xffff0000, v63
    v_max3_f32 v126, v122, v123, v124
    v_max_f32 v126, v126, v125
    v_mov_b32 v127, v126
    s_nop 1
    v_permlane32_swap_b32 v126, v127
    v_max_f32 v126, v126, v127
    v_mul_f32 v126, v126, v50
    v_fma_f32 v122, v122, v50, -v126
    v_fma_f32 v123, v123, v50, -v126
    v_fma_f32 v124, v124, v50, -v126
    v_fma_f32 v125, v125, v50, -v126
    v_exp_f32 v122, v122
    v_exp_f32 v123, v123
    v_exp_f32 v124, v124
    v_exp_f32 v125, v125
    v_add_f32 v126, v122, v123
    v_add_f32 v127, v124, v125
    v_add_f32 v126, v126, v127
    v_mov_b32 v127, v126
    s_nop 1
    v_permlane32_swap_b32 v126, v127
    v_add_f32 v126, v126, v127
    v_rcp_f32 v126, v126
    s_nop 0
    v_mul_f32 v122, v122, v126
    v_mul_f32 v123, v123, v126
    v_mul_f32 v124, v124, v126
    v_mul_f32 v125, v125, v126
    v_cvt_pk_bf16_f32 v62, v122, v123
    v_cvt_pk_bf16_f32 v63, v124, v125
    v_and_b32 v200, v62, v52
    v_and_b32 v201, v63, v53
    v_and_b32 v202, v62, v54
    v_and_b32 v203, v63, v55
    v_and_b32 v204, v62, v56
    v_and_b32 v205, v63, v57
    v_and_b32 v206, v62, v58
    v_and_b32 v207, v63, v59
    v_and_b32 v216, v62, v60
    v_and_b32 v217, v63, v61
    v_mfma_f32_32x32x16_bf16 v[64:79], v[112:115], v[96:99], 0
    v_mfma_f32_32x32x16_bf16 v[80:95], v[240:243], v[96:99], 0
    v_mfma_f32_32x32x16_bf16 v[64:79], v[116:119], v[100:103], v[64:79]
    v_mfma_f32_32x32x16_bf16 v[80:95], v[244:247], v[100:103], v[80:95]
    s_nop 11
    v_cndmask_b32 v92, v51, v92, s[26:27]
    v_cndmask_b32 v93, v51, v93, s[26:27]
    v_cndmask_b32 v94, v51, v94, s[26:27]
    v_cndmask_b32 v95, v51, v95, s[26:27]
    v_cndmask_b32 v122, v92, v64, s[60:61]
    v_cndmask_b32 v123, v93, v65, s[62:63]
    v_cndmask_b32 v124, v94, v66, s[64:65]
    v_cndmask_b32 v125, v95, v67, s[66:67]
    v_cndmask_b32 v122, v122, v68, s[68:69]
    v_cndmask_b32 v123, v123, v69, s[70:71]
    v_cndmask_b32 v124, v124, v70, s[72:73]
    v_cndmask_b32 v125, v125, v71, s[74:75]
    v_cndmask_b32 v122, v122, v72, s[76:77]
    v_cndmask_b32 v123, v123, v73, s[78:79]
    v_cndmask_b32 v124, v124, v74, s[80:81]
    v_cndmask_b32 v125, v125, v75, s[82:83]
    v_cndmask_b32 v122, v122, v76, s[84:85]
    v_cndmask_b32 v123, v123, v77, s[86:87]
    v_cndmask_b32 v124, v124, v78, s[88:89]
    v_cndmask_b32 v125, v125, v79, s[90:91]
    v_cvt_pk_bf16_f32 v62, v122, v123
    v_cvt_pk_bf16_f32 v63, v124, v125
    v_lshlrev_b32 v122, 16, v62
    v_and_b32 v123, 0xffff0000, v62
    v_lshlrev_b32 v124, 16, v63
    v_and_b32 v125, 0xffff0000, v63
    v_mul_f32 v122, 0x3e41848f, v122
    v_mul_f32 v123, 0x3e41848f, v123
    v_mul_f32 v124, 0x3e41848f, v124
    v_mul_f32 v125, 0x3e41848f, v125
    v_cvt_pk_bf16_f32 v62, v122, v123
    v_cvt_pk_bf16_f32 v63, v124, v125
    v_lshlrev_b32 v122, 16, v62
    v_and_b32 v123, 0xffff0000, v62
    v_lshlrev_b32 v124, 16, v63
    v_and_b32 v125, 0xffff0000, v63
    v_max3_f32 v126, v122, v123, v124
    v_max_f32 v126, v126, v125
    v_mov_b32 v127, v126
    s_nop 1
    v_permlane32_swap_b32 v126, v127
    v_max_f32 v126, v126, v127
    v_mul_f32 v126, v126, v50
    v_fma_f32 v122, v122, v50, -v126
    v_fma_f32 v123, v123, v50, -v126
    v_fma_f32 v124, v124, v50, -v126
    v_fma_f32 v125, v125, v50, -v126
    v_exp_f32 v122, v122
    v_exp_f32 v123, v123
    v_exp_f32 v124, v124
    v_exp_f32 v125, v125
    v_add_f32 v126, v122, v123
    v_add_f32 v127, v124, v125
    v_add_f32 v126, v126, v127
    v_mov_b32 v127, v126
    s_nop 1
    v_permlane32_swap_b32 v126, v127
    v_add_f32 v126, v126, v127
    v_rcp_f32 v126, v126
    s_nop 0
    v_mul_f32 v122, v122, v126
    v_mul_f32 v123, v123, v126
    v_mul_f32 v124, v124, v126
    v_mul_f32 v125, v125, v126
    v_cvt_pk_bf16_f32 v62, v122, v123
    v_cvt_pk_bf16_f32 v63, v124, v125
    v_and_b32 v104, v62, v52
    v_and_b32 v105, v63, v53
    v_and_b32 v106, v62, v54
    v_and_b32 v107, v63, v55
    v_and_b32 v108, v62, v56
    v_and_b32 v109, v63, v57
    v_and_b32 v110, v62, v58
    v_and_b32 v111, v63, v59
    v_and_b32 v120, v62, v60
    v_and_b32 v121, v63, v61
    v_cvt_pk_bf16_f32 v176, v176, v177
    v_cvt_pk_bf16_f32 v177, v178, v179
    v_cvt_pk_bf16_f32 v178, v180, v181
    v_cvt_pk_bf16_f32 v179, v182, v183
    v_cvt_pk_bf16_f32 v180, v184, v185
    v_cvt_pk_bf16_f32 v181, v186, v187
    v_cvt_pk_bf16_f32 v182, v188, v189
    v_cvt_pk_bf16_f32 v183, v190, v191
    v_cvt_pk_bf16_f32 v128, v128, v129
    v_cvt_pk_bf16_f32 v129, v130, v131
    v_cvt_pk_bf16_f32 v130, v132, v133
    v_cvt_pk_bf16_f32 v131, v134, v135
    v_cvt_pk_bf16_f32 v132, v136, v137
    v_cvt_pk_bf16_f32 v133, v138, v139
    v_cvt_pk_bf16_f32 v134, v140, v141
    v_cvt_pk_bf16_f32 v135, v142, v143
    v_mfma_f32_32x32x16_bf16 v[64:79], v[176:179], v[152:155], 0
    v_mfma_f32_32x32x16_bf16 v[64:79], v[180:183], v[156:159], v[64:79]
    v_mfma_f32_32x32x8_bf16 v[64:79], v[134:135], v[168:169], v[64:79]
    s_barrier
    ds_read_b64 a[136:137], v49 offset:0
    v_cvt_pk_bf16_f32 v224, v224, v225
    v_cvt_pk_bf16_f32 v225, v226, v227
    v_cvt_pk_bf16_f32 v226, v228, v229
    v_cvt_pk_bf16_f32 v227, v230, v231
    v_cvt_pk_bf16_f32 v228, v232, v233
    v_cvt_pk_bf16_f32 v229, v234, v235
    v_cvt_pk_bf16_f32 v230, v236, v237
    v_cvt_pk_bf16_f32 v231, v238, v239
    v_mfma_f32_32x32x16_bf16 v[80:95], v[224:227], v[200:203], 0
    s_nop 0
    v_mfma_f32_32x32x16_bf16 v[80:95], v[228:231], v[204:207], v[80:95]
    v_mfma_f32_32x32x8_bf16 v[80:95], v[182:183], v[216:217], v[80:95]
    v_cvt_pk_bf16_f32 v64, v64, v65
    v_cvt_pk_bf16_f32 v65, v66, v67
    v_cvt_pk_bf16_f32 v66, v68, v69
    v_cvt_pk_bf16_f32 v67, v70, v71
    v_cvt_pk_bf16_f32 v68, v72, v73
    v_cvt_pk_bf16_f32 v69, v74, v75
    v_cvt_pk_bf16_f32 v70, v76, v77
    v_cvt_pk_bf16_f32 v71, v78, v79
    v_cndmask_b32 v70, 0, v70, s[24:25]
    v_cndmask_b32 v71, 0, v71, s[24:25]
    s_add_u32 s6, s11, 294912
    buffer_store_dwordx4 v[64:67], v11, s[52:55], s6 offen sc1
    buffer_store_dwordx4 v[68:71], v11, s[52:55], s6 offen offset:1024 sc1
    s_waitcnt lgkmcnt(0)
    v_mfma_f32_32x32x16_bf16 v[208:223], v[128:131], v[104:107], 0
    v_mfma_f32_32x32x16_bf16 v[208:223], v[132:135], v[108:111], v[208:223]
    v_mfma_f32_32x32x8_bf16 v[208:223], a[136:137], v[120:121], v[208:223]
    v_cvt_pk_bf16_f32 v80, v80, v81
    v_cvt_pk_bf16_f32 v81, v82, v83
    v_cvt_pk_bf16_f32 v82, v84, v85
    v_cvt_pk_bf16_f32 v83, v86, v87
    v_cvt_pk_bf16_f32 v84, v88, v89
    v_cvt_pk_bf16_f32 v85, v90, v91
    v_cvt_pk_bf16_f32 v86, v92, v93
    v_cvt_pk_bf16_f32 v87, v94, v95
    v_cndmask_b32 v86, 0, v86, s[24:25]
    v_cndmask_b32 v87, 0, v87, s[24:25]
    s_add_u32 s6, s11, 589824
    buffer_store_dwordx4 v[80:83], v11, s[52:55], s6 offen sc1
    buffer_store_dwordx4 v[84:87], v11, s[52:55], s6 offen offset:1024 sc1
    v_cvt_pk_bf16_f32 v208, v208, v209
    v_cvt_pk_bf16_f32 v209, v210, v211
    v_cvt_pk_bf16_f32 v210, v212, v213
    v_cvt_pk_bf16_f32 v211, v214, v215
    v_cvt_pk_bf16_f32 v212, v216, v217
    v_cvt_pk_bf16_f32 v213, v218, v219
    v_cvt_pk_bf16_f32 v214, v220, v221
    v_cvt_pk_bf16_f32 v215, v222, v223
    v_cndmask_b32 v214, 0, v214, s[24:25]
    v_cndmask_b32 v215, 0, v215, s[24:25]
    s_add_u32 s6, s11, 0
    buffer_store_dwordx4 v[208:211], v11, s[52:55], s6 offen sc1
    buffer_store_dwordx4 v[212:215], v11, s[52:55], s6 offen offset:1024 sc1
    s_waitcnt vmcnt(9)
    ds_read_b64_tr_b16 a[240:241], v41 offset:0
    ds_read_b64_tr_b16 a[242:243], v41 offset:1024
    ds_read_b64_tr_b16 a[244:245], v42 offset:0
    ds_read_b64_tr_b16 a[246:247], v42 offset:1024
    s_waitcnt vmcnt(7)
    ds_read_b64_tr_b16 a[248:249], v41 offset:2048
    ds_read_b64_tr_b16 a[250:251], v41 offset:3072
    ds_read_b64_tr_b16 a[252:253], v42 offset:2048
    ds_read_b64_tr_b16 a[254:255], v42 offset:3072
    s_branch gated_mix__sliding_local_dilated__glu_gated_glu__prompt_kernel_p2
gated_mix__sliding_local_dilated__glu_gated_glu__prompt_kernel_att1:
    s_nop 1
    s_and_b32 s6, s7, 1
    s_mul_i32 s6, s6, 11
    s_add_u32 s6, s6, s8
    s_lshr_b32 s8, s6, 1
    s_and_b32 s6, s6, 1
    s_andn2_b32 s7, s7, 1
    s_add_u32 s7, s7, s6
    s_lshl_b32 s6, s7, 4
    s_add_u32 s6, s6, s8
    s_lshl_b32 s6, s6, 2
    s_add_u32 s6, s6, s3
    s_lshl_b32 s6, s6, 3
    s_add_u32 s33, s6, 8192
    s_lshr_b32 s9, s3, 1
    v_lshrrev_b32 v4, 3, v1
    s_lshl_b32 s5, s3, 3
    v_add_u32 v4, s5, v4
    v_bfe_u32 v5, v4, 1, 3
    v_and_b32 v6, 7, v1
    v_xor_b32 v5, v5, v6
    v_mul_u32_u24 v4, 1792, v4
    v_lshl_add_u32 v8, v5, 4, v4
    v_lshrrev_b32 v4, 3, v1
    v_bfe_u32 v5, v1, 4, 1
    v_lshlrev_b32 v5, 2, v5
    v_and_b32 v6, 7, v1
    v_xor_b32 v5, v5, v6
    v_mul_u32_u24 v4, 2688, v4
    v_lshl_add_u32 v9, v5, 4, v4
    s_mul_i32 s10, s3, 21504
    s_mul_i32 s6, s7, 112
    s_add_u32 s10, s10, s6
    s_mul_i32 s5, s8, 172032
    s_add_u32 s12, s5, 0
    s_add_u32 s13, s5, 896
    s_add_u32 s14, s5, 57344
    s_add_u32 s15, s5, 58240
    s_add_u32 s38, s5, 114688
    s_add_u32 s39, s5, 115584
    v_bfe_u32 v4, v1, 3, 2
    s_lshl_b32 s6, s3, 2
    s_add_u32 s6, s6, 16
    v_add_u32 v4, s6, v4
    v_and_b32 v5, 7, v4
    v_lshlrev_b32 v5, 1, v5
    v_bfe_u32 v6, v4, 3, 1
    v_sub_u32 v5, v5, v6
    s_mul_i32 s6, s8, 192
    s_sub_u32 s6, s6, 15
    v_add_u32 v5, s6, v5
    v_max_i32 v5, 0, v5
    v_mul_u32_u24 v5, 896, v5
    v_bfe_u32 v4, v4, 1, 3
    v_and_b32 v6, 7, v1
    v_xor_b32 v4, v4, v6
    v_lshl_add_u32 v10, v4, 4, v5
    v_lshlrev_b32 v11, 4, v1
    s_lshr_b32 s5, s4, 1
    v_bfe_u32 v4, v1, 1, 1
    v_lshlrev_b32 v4, 6, v4
    v_xor_b32 v4, 112, v4
    v_lshl_add_u32 v39, v1, 7, v4
    v_mov_b32 v64, 0
    v_mov_b32 v65, 0
    v_mov_b32 v66, 0
    v_mov_b32 v67, 0
    v_lshlrev_b32 v6, 1, v1
    s_waitcnt lgkmcnt(0)
    s_mov_b32 s40, s16
    s_mov_b32 s41, s17
    s_mov_b32 s42, 1835008
    s_mov_b32 s43, 0x00020000
    s_mov_b32 s44, s18
    s_mov_b32 s45, s19
    s_mov_b32 s46, 1204224
    s_mov_b32 s47, 0x00020000
    s_mov_b32 s48, s30
    s_mov_b32 s49, s31
    s_mov_b32 s50, 896
    s_mov_b32 s51, 0x00020000
    s_mov_b32 s22, 0xf7f77f7f
    s_mov_b32 s23, 0xf7f77f7f
    buffer_load_ushort v40, v6, s[48:51], 0 offen
    buffer_load_ushort v41, v6, s[48:51], 0 offen offset:128
    buffer_load_ushort v42, v6, s[48:51], 0 offen offset:256
    buffer_load_ushort v43, v6, s[48:51], 0 offen offset:384
    buffer_load_ushort v44, v6, s[48:51], 0 offen offset:512
    buffer_load_ushort v45, v6, s[48:51], 0 offen offset:640
    buffer_load_ushort v46, v6, s[48:51], 0 offen offset:768
    s_add_u32 m0, s4, 0
    s_add_u32 s35, s10, 0
    s_mov_b64 exec, s[22:23]
    buffer_load_dwordx4 v9, s[44:47], s35 offen lds
    s_mov_b64 exec, -1
    s_add_u32 m0, s4, 8192
    s_add_u32 s35, s10, 896
    buffer_load_dwordx4 v9, s[44:47], s35 offen lds
    s_add_u32 m0, s4, 16384
    s_add_u32 s35, s10, 1792
    buffer_load_dwordx4 v9, s[44:47], s35 offen lds
    s_add_u32 m0, s4, 24576
    s_add_u32 s35, s12, 0
    buffer_load_dwordx4 v8, s[40:43], s35 offen lds
    s_add_u32 m0, s4, 28672
    s_add_u32 s35, s13, 0
    buffer_load_dwordx4 v8, s[40:43], s35 offen lds
    s_add_u32 m0, s4, 32768
    s_add_u32 s35, s14, 0
    buffer_load_dwordx4 v8, s[40:43], s35 offen lds
    s_add_u32 m0, s4, 36864
    s_add_u32 s35, s15, 0
    buffer_load_dwordx4 v8, s[40:43], s35 offen lds
    s_add_u32 m0, s4, 4096
    s_add_u32 s35, s10, 86016
    s_mov_b64 exec, s[22:23]
    buffer_load_dwordx4 v9, s[44:47], s35 offen lds
    s_mov_b64 exec, -1
    s_add_u32 m0, s4, 12288
    s_add_u32 s35, s10, 86912
    buffer_load_dwordx4 v9, s[44:47], s35 offen lds
    s_add_u32 m0, s4, 20480
    s_add_u32 s35, s10, 87808
    buffer_load_dwordx4 v9, s[44:47], s35 offen lds
    s_add_u32 m0, s4, 40960
    s_add_u32 s35, s38, 0
    buffer_load_dwordx4 v8, s[40:43], s35 offen lds
    s_add_u32 m0, s4, 45056
    s_add_u32 s35, s39, 0
    buffer_load_dwordx4 v8, s[40:43], s35 offen lds
    s_add_u32 m0, s5, 49152
    s_mov_b32 s35, 0
    s_mov_b32 exec_hi, 0
    buffer_load_dwordx4 v10, s[40:43], s35 offen lds
    s_mov_b64 exec, -1
    s_mov_b32 s52, s36
    s_mov_b32 s53, s37
    s_mov_b32 s54, 9437184
    s_mov_b32 s55, 0x00020000
    ds_write_b128 v39, v[64:67] offset:0
    ds_write_b128 v39, v[64:67] offset:51200
    v_add_u32 v4, 102400, v39
    ds_write_b128 v4, v[64:67] offset:0
    v_bfe_u32 v4, v2, 1, 3
    v_xor_b32 v4, v4, v3
    v_lshlrev_b32 v5, 7, v2
    v_add_u32 v5, 28672, v5
    v_xor_b32 v12, 0, v4
    v_lshl_add_u32 v12, v12, 4, v5
    v_xor_b32 v13, 2, v4
    v_lshl_add_u32 v13, v13, 4, v5
    v_xor_b32 v14, 4, v4
    v_lshl_add_u32 v14, v14, 4, v5
    v_xor_b32 v15, 6, v4
    v_lshl_add_u32 v15, v15, 4, v5
    v_or_b32 v6, 16, v2
    v_bfe_u32 v4, v6, 1, 3
    v_xor_b32 v4, v4, v3
    v_lshlrev_b32 v5, 7, v6
    v_add_u32 v5, 47104, v5
    v_xor_b32 v24, 0, v4
    v_lshl_add_u32 v24, v24, 4, v5
    v_xor_b32 v25, 2, v4
    v_lshl_add_u32 v25, v25, 4, v5
    v_xor_b32 v26, 4, v4
    v_lshl_add_u32 v26, v26, 4, v5
    v_xor_b32 v27, 6, v4
    v_lshl_add_u32 v27, v27, 4, v5
    s_mul_i32 s6, s9, 56
    v_bfe_u32 v4, v1, 4, 1
    v_lshlrev_b32 v4, 5, v4
    v_and_b32 v5, 3, v1
    v_lshl_add_u32 v4, v5, 3, v4
    v_add_u32 v4, s6, v4
    v_bfe_u32 v5, v1, 3, 1
    v_lshlrev_b32 v5, 6, v5
    v_xor_b32 v4, v4, v5
    v_bfe_u32 v5, v1, 2, 2
    v_lshl_add_u32 v5, v3, 3, v5
    v_lshl_add_u32 v36, v5, 7, v4
    v_add_u32 v16, 51200, v12
    v_add_u32 v28, 51200, v24
    v_add_u32 v17, 51200, v13
    v_add_u32 v29, 51200, v25
    v_add_u32 v18, 51200, v14
    v_add_u32 v30, 51200, v26
    v_add_u32 v19, 51200, v15
    v_add_u32 v31, 51200, v27
    v_add_u32 v37, 51200, v36
    v_add_u32 v20, 102400, v12
    v_add_u32 v32, 102400, v24
    v_add_u32 v21, 102400, v13
    v_add_u32 v33, 102400, v25
    v_add_u32 v22, 102400, v14
    v_add_u32 v34, 102400, v26
    v_add_u32 v23, 102400, v15
    v_add_u32 v35, 102400, v27
    v_add_u32 v38, 102400, v36
    s_waitcnt vmcnt(19)
    ds_write_b16 v39, v40 offset:0
    s_waitcnt vmcnt(18)
    v_add_u32 v4, 51200, v39
    ds_write_b16 v4, v41 offset:0
    s_waitcnt vmcnt(17)
    v_add_u32 v4, 102400, v39
    ds_write_b16 v4, v42 offset:0
    s_waitcnt vmcnt(0) lgkmcnt(0)
    s_barrier
    ds_read_b64_tr_b16 a[0:1], v36 offset:0
    ds_read_b64_tr_b16 a[2:3], v36 offset:512
    ds_read_b128 a[12:15], v12 offset:0
    ds_read_b64_tr_b16 a[4:5], v36 offset:8192
    ds_read_b64_tr_b16 a[6:7], v36 offset:8704
    ds_read_b64_tr_b16 a[8:9], v36 offset:16384
    ds_read_b64_tr_b16 a[10:11], v36 offset:16896
    ds_read_b128 a[16:19], v12 offset:8192
    ds_read_b128 a[20:23], v12 offset:16384
    s_waitcnt lgkmcnt(6)
    v_mfma_f32_32x32x16_bf16 v[96:111], a[0:3], a[12:15], 0
    ds_read_b128 a[24:27], v24 offset:0
    s_add_u32 m0, s4, 51200
    s_add_u32 s35, s10, 172032
    s_waitcnt lgkmcnt(5)
    v_mfma_f32_32x32x16_bf16 v[112:127], a[4:7], a[12:15], 0
    ds_read_b64_tr_b16 a[28:29], v36 offset:2048
    ds_read_b64_tr_b16 a[30:31], v36 offset:2560
    ds_read_b128 a[40:43], v13 offset:0
    s_waitcnt lgkmcnt(6)
    v_mfma_f32_32x32x16_bf16 v[128:143], a[12:15], a[8:11], 0
    ds_read_b64_tr_b16 a[32:33], v36 offset:10240
    ds_read_b64_tr_b16 a[34:35], v36 offset:10752
    s_waitcnt lgkmcnt(6)
    v_mfma_f32_32x32x16_bf16 v[144:159], a[0:3], a[16:19], 0
    ds_read_b64_tr_b16 a[36:37], v36 offset:18432
    ds_read_b64_tr_b16 a[38:39], v36 offset:18944
    v_mfma_f32_32x32x16_bf16 v[160:175], a[4:7], a[16:19], 0
    ds_read_b128 a[44:47], v13 offset:8192
    s_mov_b64 exec, s[22:23]
    buffer_load_dwordx4 v9, s[44:47], s35 offen lds
    s_mov_b64 exec, -1
    v_mfma_f32_32x32x16_bf16 v[176:191], a[16:19], a[8:11], 0
    s_add_u32 m0, s4, 59392
    s_add_u32 s35, s10, 172928
    buffer_load_dwordx4 v9, s[44:47], s35 offen lds
    v_mfma_f32_32x32x16_bf16 v[192:207], a[0:3], a[20:23], 0
    s_add_u32 m0, s4, 67584
    s_add_u32 s35, s10, 173824
    buffer_load_dwordx4 v9, s[44:47], s35 offen lds
    v_mfma_f32_32x32x16_bf16 v[208:223], a[4:7], a[20:23], 0
    ds_read_b128 a[48:51], v13 offset:16384
    s_add_u32 m0, s4, 75776
    s_add_u32 s35, s12, 128
    buffer_load_dwordx4 v8, s[40:43], s35 offen lds
    v_mfma_f32_32x32x16_bf16 v[224:239], a[20:23], a[8:11], 0
    s_add_u32 m0, s4, 79872
    s_add_u32 s35, s13, 128
    buffer_load_dwordx4 v8, s[40:43], s35 offen lds
    s_waitcnt lgkmcnt(2)
    v_mfma_f32_32x32x16_bf16 v[240:255], a[24:27], a[8:11], 0
    s_add_u32 m0, s4, 83968
    s_add_u32 s35, s14, 128
    buffer_load_dwordx4 v8, s[40:43], s35 offen lds
    v_mfma_f32_32x32x16_bf16 v[96:111], a[28:31], a[40:43], v[96:111]
    ds_read_b128 a[52:55], v25 offset:0
    s_add_u32 m0, s4, 88064
    s_add_u32 s35, s15, 128
    buffer_load_dwordx4 v8, s[40:43], s35 offen lds
    v_mfma_f32_32x32x16_bf16 v[112:127], a[32:35], a[40:43], v[112:127]
    ds_read_b64_tr_b16 a[56:57], v36 offset:4096
    ds_read_b64_tr_b16 a[58:59], v36 offset:4608
    ds_read_b128 a[68:71], v14 offset:0
    s_add_u32 m0, s4, 55296
    s_add_u32 s35, s10, 258048
    v_mfma_f32_32x32x16_bf16 v[128:143], a[40:43], a[36:39], v[128:143]
    ds_read_b64_tr_b16 a[60:61], v36 offset:12288
    ds_read_b64_tr_b16 a[62:63], v36 offset:12800
    s_mov_b64 exec, s[22:23]
    buffer_load_dwordx4 v9, s[44:47], s35 offen lds
    s_mov_b64 exec, -1
    s_waitcnt lgkmcnt(6)
    v_mfma_f32_32x32x16_bf16 v[144:159], a[28:31], a[44:47], v[144:159]
    ds_read_b64_tr_b16 a[64:65], v36 offset:20480
    ds_read_b64_tr_b16 a[66:67], v36 offset:20992
    s_add_u32 m0, s4, 63488
    s_add_u32 s35, s10, 258944
    v_mfma_f32_32x32x16_bf16 v[160:175], a[32:35], a[44:47], v[160:175]
    ds_read_b128 a[72:75], v14 offset:8192
    buffer_load_dwordx4 v9, s[44:47], s35 offen lds
    s_add_u32 m0, s4, 71680
    s_add_u32 s35, s10, 259840
    v_mfma_f32_32x32x16_bf16 v[176:191], a[44:47], a[36:39], v[176:191]
    buffer_load_dwordx4 v9, s[44:47], s35 offen lds
    s_add_u32 m0, s4, 92160
    s_add_u32 s35, s38, 128
    v_mfma_f32_32x32x16_bf16 v[192:207], a[28:31], a[48:51], v[192:207]
    buffer_load_dwordx4 v8, s[40:43], s35 offen lds
    s_add_u32 m0, s4, 96256
    s_add_u32 s35, s39, 128
    v_mfma_f32_32x32x16_bf16 v[208:223], a[32:35], a[48:51], v[208:223]
    ds_read_b128 a[76:79], v14 offset:16384
    buffer_load_dwordx4 v8, s[40:43], s35 offen lds
    s_add_u32 m0, s5, 100352
    s_mov_b32 s35, 128
    v_mfma_f32_32x32x16_bf16 v[224:239], a[48:51], a[36:39], v[224:239]
    s_mov_b32 exec_hi, 0
    buffer_load_dwordx4 v10, s[40:43], s35 offen lds
    s_mov_b64 exec, -1
    s_add_u32 m0, s4, 102400
    s_add_u32 s35, s10, 344064
    s_waitcnt lgkmcnt(2)
    v_mfma_f32_32x32x16_bf16 v[240:255], a[52:55], a[36:39], v[240:255]
    s_mov_b64 exec, s[22:23]
    buffer_load_dwordx4 v9, s[44:47], s35 offen lds
    s_mov_b64 exec, -1
    v_mfma_f32_32x32x16_bf16 v[96:111], a[56:59], a[68:71], v[96:111]
    ds_read_b128 a[80:83], v26 offset:0
    s_add_u32 m0, s4, 110592
    s_add_u32 s35, s10, 344960
    buffer_load_dwordx4 v9, s[44:47], s35 offen lds
    v_mfma_f32_32x32x16_bf16 v[112:127], a[60:63], a[68:71], v[112:127]
    ds_read_b64_tr_b16 a[84:85], v36 offset:6144
    ds_read_b64_tr_b16 a[86:87], v36 offset:6656
    ds_read_b128 a[96:99], v15 offset:0
    s_add_u32 m0, s4, 118784
    s_add_u32 s35, s10, 345856
    v_mfma_f32_32x32x16_bf16 v[128:143], a[68:71], a[64:67], v[128:143]
    ds_read_b64_tr_b16 a[88:89], v36 offset:14336
    ds_read_b64_tr_b16 a[90:91], v36 offset:14848
    buffer_load_dwordx4 v9, s[44:47], s35 offen lds
    s_waitcnt lgkmcnt(6)
    v_mfma_f32_32x32x16_bf16 v[144:159], a[56:59], a[72:75], v[144:159]
    ds_read_b64_tr_b16 a[92:93], v36 offset:22528
    ds_read_b64_tr_b16 a[94:95], v36 offset:23040
    s_add_u32 m0, s4, 126976
    s_add_u32 s35, s12, 256
    v_mfma_f32_32x32x16_bf16 v[160:175], a[60:63], a[72:75], v[160:175]
    ds_read_b128 a[100:103], v15 offset:8192
    buffer_load_dwordx4 v8, s[40:43], s35 offen lds
    s_add_u32 m0, s4, 131072
    s_add_u32 s35, s13, 256
    v_mfma_f32_32x32x16_bf16 v[176:191], a[72:75], a[64:67], v[176:191]
    buffer_load_dwordx4 v8, s[40:43], s35 offen lds
    s_add_u32 m0, s4, 135168
    s_add_u32 s35, s14, 256
    v_mfma_f32_32x32x16_bf16 v[192:207], a[56:59], a[76:79], v[192:207]
    buffer_load_dwordx4 v8, s[40:43], s35 offen lds
    s_add_u32 m0, s4, 139264
    s_add_u32 s35, s15, 256
    v_mfma_f32_32x32x16_bf16 v[208:223], a[60:63], a[76:79], v[208:223]
    ds_read_b128 a[104:107], v15 offset:16384
    buffer_load_dwordx4 v8, s[40:43], s35 offen lds
    s_add_u32 m0, s4, 106496
    s_add_u32 s35, s10, 430080
    v_mfma_f32_32x32x16_bf16 v[224:239], a[76:79], a[64:67], v[224:239]
    s_mov_b64 exec, s[22:23]
    buffer_load_dwordx4 v9, s[44:47], s35 offen lds
    s_mov_b64 exec, -1
    s_add_u32 m0, s4, 114688
    s_add_u32 s35, s10, 430976
    s_waitcnt lgkmcnt(2)
    v_mfma_f32_32x32x16_bf16 v[240:255], a[80:83], a[64:67], v[240:255]
    buffer_load_dwordx4 v9, s[44:47], s35 offen lds
    s_add_u32 m0, s4, 122880
    s_add_u32 s35, s10, 431872
    v_mfma_f32_32x32x16_bf16 v[96:111], a[84:87], a[96:99], v[96:111]
    ds_read_b128 a[108:111], v27 offset:0
    buffer_load_dwordx4 v9, s[44:47], s35 offen lds
    s_add_u32 m0, s4, 143360
    s_add_u32 s35, s38, 256
    v_mfma_f32_32x32x16_bf16 v[112:127], a[88:91], a[96:99], v[112:127]
    buffer_load_dwordx4 v8, s[40:43], s35 offen lds
    s_add_u32 m0, s4, 147456
    s_add_u32 s35, s39, 256
    v_mfma_f32_32x32x16_bf16 v[128:143], a[96:99], a[92:95], v[128:143]
    buffer_load_dwordx4 v8, s[40:43], s35 offen lds
    s_add_u32 m0, s5, 151552
    s_mov_b32 s35, 256
    s_waitcnt lgkmcnt(1)
    v_mfma_f32_32x32x16_bf16 v[144:159], a[84:87], a[100:103], v[144:159]
    s_waitcnt vmcnt(12) lgkmcnt(0)
    s_barrier
    ds_read_b64_tr_b16 a[112:113], v37 offset:0
    ds_read_b64_tr_b16 a[114:115], v37 offset:512
    ds_read_b128 a[124:127], v16 offset:0
    v_mfma_f32_32x32x16_bf16 v[160:175], a[88:91], a[100:103], v[160:175]
    ds_read_b64_tr_b16 a[116:117], v37 offset:8192
    ds_read_b64_tr_b16 a[118:119], v37 offset:8704
    ds_read_b64_tr_b16 a[120:121], v37 offset:16384
    v_mfma_f32_32x32x16_bf16 v[176:191], a[100:103], a[92:95], v[176:191]
    ds_read_b64_tr_b16 a[122:123], v37 offset:16896
    ds_read_b128 a[0:3], v16 offset:8192
    s_mov_b32 exec_hi, 0
    buffer_load_dwordx4 v10, s[40:43], s35 offen lds
    s_mov_b64 exec, -1
    v_mfma_f32_32x32x16_bf16 v[192:207], a[84:87], a[104:107], v[192:207]
    s_add_u32 m0, s4, 0
    s_add_u32 s35, s10, 516096
    s_add_u32 s56, s36, 9437184
    s_addc_u32 s57, s37, 0
    s_mov_b32 s59, 0x00020000
    s_lshl_b32 s2, s7, 1
    s_add_u32 s2, s2, s9
    s_cmp_eq_u32 s2, 1
    s_cselect_b32 s58, 8192, 0
    v_mfma_f32_32x32x16_bf16 v[208:223], a[88:91], a[104:107], v[208:223]
    ds_read_b128 a[4:7], v16 offset:16384
    s_mul_i32 s11, s8, 884736
    s_lshl_b32 s2, s2, 11
    s_add_u32 s11, s11, s2
    s_add_u32 s11, s11, 147456
    s_mul_i32 s2, s8, 768
    s_add_u32 s2, s2, 128
    v_mfma_f32_32x32x16_bf16 v[224:239], a[104:107], a[92:95], v[224:239]
    s_mov_b64 exec, s[22:23]
    buffer_load_dwordx4 v9, s[44:47], s35 offen lds
    s_mov_b64 exec, -1
    s_add_u32 m0, s4, 8192
    s_add_u32 s35, s10, 516992
    v_mfma_f32_32x32x16_bf16 v[240:255], a[108:111], a[92:95], v[240:255]
    s_mov_b32 s60, 0xff
    s_mov_b32 s61, 0xff0
    s_mov_b32 s62, 0x1fe
    s_mov_b32 s63, 0x1fe0
    s_mov_b32 s64, 0x3fc
    s_mov_b32 s65, 0x3fc0
    s_waitcnt lgkmcnt(1)
    v_mfma_f32_32x32x16_bf16 v[96:111], a[112:115], a[124:127], v[96:111]
    ds_read_b128 a[8:11], v28 offset:0
    s_mov_b32 s66, 0x7f8
    s_mov_b32 s67, 0x7f80
    s_mov_b32 s68, 0xff00
    s_mov_b32 s69, 0xff000
    v_mfma_f32_32x32x16_bf16 v[112:127], a[116:119], a[124:127], v[112:127]
    ds_read_b64_tr_b16 a[12:13], v37 offset:2048
    ds_read_b64_tr_b16 a[14:15], v37 offset:2560
    ds_read_b128 a[24:27], v17 offset:0
    buffer_load_dwordx4 v9, s[44:47], s35 offen lds
    v_mfma_f32_32x32x16_bf16 v[128:143], a[124:127], a[120:123], v[128:143]
    ds_read_b64_tr_b16 a[16:17], v37 offset:10240
    ds_read_b64_tr_b16 a[18:19], v37 offset:10752
    s_add_u32 m0, s4, 16384
    s_add_u32 s35, s10, 517888
    s_mov_b32 s70, 0x1fe00
    s_mov_b32 s71, 0x1fe000
    v_mfma_f32_32x32x16_bf16 v[144:159], a[112:115], a[0:3], v[144:159]
    ds_read_b64_tr_b16 a[20:21], v37 offset:18432
    ds_read_b64_tr_b16 a[22:23], v37 offset:18944
    s_mov_b32 s72, 0x3fc00
    s_mov_b32 s73, 0x3fc000
    s_mov_b32 s74, 0x7f800
    s_mov_b32 s75, 0x7f8000
    v_mfma_f32_32x32x16_bf16 v[160:175], a[116:119], a[0:3], v[160:175]
    ds_read_b128 a[28:31], v17 offset:8192
    buffer_load_dwordx4 v9, s[44:47], s35 offen lds
    s_add_u32 m0, s4, 24576
    s_add_u32 s35, s12, 384
    v_mfma_f32_32x32x16_bf16 v[176:191], a[0:3], a[120:123], v[176:191]
    s_mov_b32 s76, 0xff0000
    s_mov_b32 s77, 0xff00000
    s_mov_b32 s78, 0x1fe0000
    s_mov_b32 s79, 0x1fe00000
    s_mov_b32 s80, 0x3fc0000
    s_mov_b32 s81, 0x3fc00000
    s_waitcnt lgkmcnt(8)
    v_mfma_f32_32x32x16_bf16 v[192:207], a[112:115], a[4:7], v[192:207]
    s_mov_b32 s82, 0x7f80000
    s_mov_b32 s83, 0x7f800000
    s_mov_b32 s84, 0xff000000
    s_mov_b32 s85, 0xf0000000
    v_mfma_f32_32x32x16_bf16 v[208:223], a[116:119], a[4:7], v[208:223]
    ds_read_b128 a[32:35], v17 offset:16384
    buffer_load_dwordx4 v8, s[40:43], s35 offen lds
    s_add_u32 m0, s4, 28672
    s_add_u32 s35, s13, 384
    v_mfma_f32_32x32x16_bf16 v[224:239], a[4:7], a[120:123], v[224:239]
    s_mov_b32 s86, 0xfe000000
    s_mov_b32 s87, 0xe0000000
    s_mov_b32 s88, 0xfc000000
    s_mov_b32 s89, 0xc0000000
    s_mov_b32 s90, 0xf8000000
    s_mov_b32 s91, 0x80000000
    v_mfma_f32_32x32x16_bf16 v[240:255], a[8:11], a[120:123], v[240:255]
    s_cmp_eq_u32 s8, 0
    s_cselect_b64 s[26:27], 0, -1
    s_mov_b32 s24, 0xffffffff
    s_mov_b32 s25, 0x0
    v_mov_b32 v51, 0xff800000
    v_mov_b32 v50, 0x3fb8aa3b
    s_waitcnt lgkmcnt(1)
    v_mfma_f32_32x32x16_bf16 v[96:111], a[12:15], a[24:27], v[96:111]
    ds_read_b128 a[36:39], v29 offset:0
    buffer_load_dwordx4 v8, s[40:43], s35 offen lds
    v_mov_b32 v62, 0xffff
    v_mfma_f32_32x32x16_bf16 v[112:127], a[16:19], a[24:27], v[112:127]
    ds_read_b64_tr_b16 a[40:41], v37 offset:4096
    ds_read_b64_tr_b16 a[42:43], v37 offset:4608
    ds_read_b128 a[52:55], v18 offset:0
    s_add_u32 m0, s4, 32768
    s_add_u32 s35, s14, 384
    v_mov_b32 v63, 0xffff0000
    v_mfma_f32_32x32x16_bf16 v[128:143], a[24:27], a[20:23], v[128:143]
    ds_read_b64_tr_b16 a[44:45], v37 offset:12288
    ds_read_b64_tr_b16 a[46:47], v37 offset:12800
    v_cndmask_b32 v52, 0, v62, s[60:61]
    v_cndmask_b32 v68, 0, v63, s[62:63]
    v_or_b32 v52, v52, v68
    v_cndmask_b32 v53, 0, v62, s[64:65]
    v_mfma_f32_32x32x16_bf16 v[144:159], a[12:15], a[28:31], v[144:159]
    ds_read_b64_tr_b16 a[48:49], v37 offset:20480
    ds_read_b64_tr_b16 a[50:51], v37 offset:20992
    buffer_load_dwordx4 v8, s[40:43], s35 offen lds
    v_cndmask_b32 v68, 0, v63, s[66:67]
    v_mfma_f32_32x32x16_bf16 v[160:175], a[16:19], a[28:31], v[160:175]
    ds_read_b128 a[56:59], v18 offset:8192
    s_add_u32 m0, s4, 36864
    s_add_u32 s35, s15, 384
    v_or_b32 v53, v53, v68
    v_cndmask_b32 v54, 0, v62, s[68:69]
    v_cndmask_b32 v68, 0, v63, s[70:71]
    v_mfma_f32_32x32x16_bf16 v[176:191], a[28:31], a[20:23], v[176:191]
    v_or_b32 v54, v54, v68
    v_cndmask_b32 v55, 0, v62, s[72:73]
    v_cndmask_b32 v68, 0, v63, s[74:75]
    v_or_b32 v55, v55, v68
    v_cndmask_b32 v56, 0, v62, s[76:77]
    v_cndmask_b32 v68, 0, v63, s[78:79]
    s_waitcnt lgkmcnt(8)
    v_mfma_f32_32x32x16_bf16 v[192:207], a[12:15], a[32:35], v[192:207]
    buffer_load_dwordx4 v8, s[40:43], s35 offen lds
    s_add_u32 m0, s4, 4096
    s_add_u32 s35, s10, 602112
    v_mfma_f32_32x32x16_bf16 v[208:223], a[16:19], a[32:35], v[208:223]
    ds_read_b128 a[60:63], v18 offset:16384
    v_or_b32 v56, v56, v68
    v_cndmask_b32 v57, 0, v62, s[80:81]
    v_cndmask_b32 v68, 0, v63, s[82:83]
    v_or_b32 v57, v57, v68
    v_cndmask_b32 v58, 0, v62, s[84:85]
    v_mfma_f32_32x32x16_bf16 v[224:239], a[32:35], a[20:23], v[224:239]
    v_cndmask_b32 v68, 0, v63, s[86:87]
    v_or_b32 v58, v58, v68
    v_cndmask_b32 v59, 0, v62, s[88:89]
    v_cndmask_b32 v68, 0, v63, s[90:91]
    v_or_b32 v59, v59, v68
    v_or3_b32 v60, v52, v54, v56
    v_mfma_f32_32x32x16_bf16 v[240:255], a[36:39], a[20:23], v[240:255]
    s_mov_b64 exec, s[22:23]
    buffer_load_dwordx4 v9, s[44:47], s35 offen lds
    s_mov_b64 exec, -1
    s_add_u32 m0, s4, 12288
    s_add_u32 s35, s10, 603008
    s_waitcnt lgkmcnt(1)
    v_mfma_f32_32x32x16_bf16 v[96:111], a[40:43], a[52:55], v[96:111]
    ds_read_b128 a[64:67], v30 offset:0
    v_or_b32 v60, v60, v58
    v_not_b32 v60, v60
    v_or3_b32 v61, v53, v55, v57
    v_or_b32 v61, v61, v59
    v_mfma_f32_32x32x16_bf16 v[112:127], a[44:47], a[52:55], v[112:127]
    ds_read_b64_tr_b16 a[68:69], v37 offset:6144
    ds_read_b64_tr_b16 a[70:71], v37 offset:6656
    ds_read_b128 a[80:83], v19 offset:0
    v_not_b32 v61, v61
    v_lshlrev_b32 v47, 2, v2
    v_cndmask_b32 v47, v47, v63, s[24:25]
    v_mfma_f32_32x32x16_bf16 v[128:143], a[52:55], a[48:51], v[128:143]
    ds_read_b64_tr_b16 a[72:73], v37 offset:14336
    ds_read_b64_tr_b16 a[74:75], v37 offset:14848
    buffer_load_dwordx4 v9, s[44:47], s35 offen lds
    v_mfma_f32_32x32x16_bf16 v[144:159], a[40:43], a[56:59], v[144:159]
    ds_read_b64_tr_b16 a[76:77], v37 offset:22528
    ds_read_b64_tr_b16 a[78:79], v37 offset:23040
    s_add_u32 m0, s4, 20480
    s_add_u32 s35, s10, 603904
    v_mfma_f32_32x32x16_bf16 v[160:175], a[44:47], a[56:59], v[160:175]
    ds_read_b128 a[84:87], v19 offset:8192
    s_lshl_b32 s6, s9, 11
    s_add_u32 s6, s6, 153600
    v_add_u32 v48, s6, v11
    v_mfma_f32_32x32x16_bf16 v[176:191], a[56:59], a[48:51], v[176:191]
    buffer_load_dwordx4 v9, s[44:47], s35 offen lds
    s_add_u32 m0, s4, 40960
    s_add_u32 s35, s38, 384
    s_waitcnt lgkmcnt(8)
    v_mfma_f32_32x32x16_bf16 v[192:207], a[40:43], a[60:63], v[192:207]
    s_lshl_b32 s6, s9, 9
    s_add_u32 s6, s6, 157696
    v_lshl_add_u32 v49, v1, 3, s6
    v_mfma_f32_32x32x16_bf16 v[208:223], a[44:47], a[60:63], v[208:223]
    ds_read_b128 a[88:91], v19 offset:16384
    s_mov_b32 s48, s28
    s_mov_b32 s49, s29
    s_mov_b32 s50, 1605632
    s_mov_b32 s51, 0x00020000
    s_mul_i32 s34, s3, 12288
    s_add_u32 s34, s34, 51200
    v_lshrrev_b32 v4, 3, v1
    v_bfe_u32 v5, v1, 4, 1
    v_lshlrev_b32 v5, 2, v5
    v_and_b32 v6, 7, v1
    v_xor_b32 v5, v5, v6
    v_mul_u32_u24 v4, 896, v4
    v_lshl_add_u32 v40, v5, 4, v4
    v_mfma_f32_32x32x16_bf16 v[224:239], a[60:63], a[48:51], v[224:239]
    buffer_load_dwordx4 v8, s[40:43], s35 offen lds
    s_add_u32 m0, s4, 45056
    s_add_u32 s35, s39, 384
    v_mfma_f32_32x32x16_bf16 v[240:255], a[64:67], a[48:51], v[240:255]
    v_bfe_u32 v4, v1, 4, 1
    v_lshlrev_b32 v4, 5, v4
    v_and_b32 v5, 3, v1
    v_lshl_add_u32 v4, v5, 3, v4
    v_bfe_u32 v5, v1, 3, 1
    v_lshl_add_u32 v4, v5, 6, v4
    v_bfe_u32 v5, v1, 2, 2
    v_lshl_add_u32 v5, v3, 2, v5
    v_lshl_add_u32 v4, v5, 7, v4
    v_add_u32 v41, s34, v4
    v_xor_b32 v42, 64, v41
    s_waitcnt lgkmcnt(1)
    v_mfma_f32_32x32x16_bf16 v[96:111], a[68:71], a[80:83], v[96:111]
    ds_read_b128 a[92:95], v31 offset:0
    v_mfma_f32_32x32x16_bf16 v[112:127], a[72:75], a[80:83], v[112:127]
    buffer_load_dwordx4 v8, s[40:43], s35 offen lds
    s_add_u32 m0, s5, 49152
    s_mov_b32 s35, 384
    v_mfma_f32_32x32x16_bf16 v[128:143], a[80:83], a[76:79], v[128:143]
    v_mfma_f32_32x32x16_bf16 v[144:159], a[68:71], a[84:87], v[144:159]
    s_waitcnt vmcnt(12) lgkmcnt(0)
    s_barrier
    ds_read_b64_tr_b16 a[96:97], v38 offset:0
    ds_read_b64_tr_b16 a[98:99], v38 offset:512
    ds_read_b128 a[108:111], v20 offset:0
    v_mfma_f32_32x32x16_bf16 v[160:175], a[72:75], a[84:87], v[160:175]
    ds_read_b64_tr_b16 a[100:101], v38 offset:8192
    ds_read_b64_tr_b16 a[102:103], v38 offset:8704
    ds_read_b64_tr_b16 a[104:105], v38 offset:16384
    v_mfma_f32_32x32x16_bf16 v[176:191], a[84:87], a[76:79], v[176:191]
    ds_read_b64_tr_b16 a[106:107], v38 offset:16896
    ds_read_b128 a[112:115], v20 offset:8192
    s_mov_b32 exec_hi, 0
    buffer_load_dwordx4 v10, s[40:43], s35 offen lds
    s_mov_b64 exec, -1
    v_mfma_f32_32x32x16_bf16 v[192:207], a[68:71], a[88:91], v[192:207]
    ds_write_b16 v39, v43 offset:0
    s_add_u32 m0, s4, 51200
    s_add_u32 s35, s10, 688128
    v_mfma_f32_32x32x16_bf16 v[208:223], a[72:75], a[88:91], v[208:223]
    ds_read_b128 a[116:119], v20 offset:16384
    v_mfma_f32_32x32x16_bf16 v[224:239], a[88:91], a[76:79], v[224:239]
    s_mov_b64 exec, s[22:23]
    buffer_load_dwordx4 v9, s[44:47], s35 offen lds
    s_mov_b64 exec, -1
    s_add_u32 m0, s4, 59392
    s_add_u32 s35, s10, 689024
    v_mfma_f32_32x32x16_bf16 v[240:255], a[92:95], a[76:79], v[240:255]
    s_waitcnt lgkmcnt(2)
    v_mfma_f32_32x32x16_bf16 v[96:111], a[96:99], a[108:111], v[96:111]
    ds_read_b128 a[120:123], v32 offset:0
    v_mfma_f32_32x32x16_bf16 v[112:127], a[100:103], a[108:111], v[112:127]
    ds_read_b64_tr_b16 a[124:125], v38 offset:2048
    ds_read_b64_tr_b16 a[126:127], v38 offset:2560
    ds_read_b128 a[8:11], v21 offset:0
    buffer_load_dwordx4 v9, s[44:47], s35 offen lds
    v_mfma_f32_32x32x16_bf16 v[128:143], a[108:111], a[104:107], v[128:143]
    ds_read_b64_tr_b16 a[0:1], v38 offset:10240
    ds_read_b64_tr_b16 a[2:3], v38 offset:10752
    s_add_u32 m0, s4, 67584
    s_add_u32 s35, s10, 689920
    v_mfma_f32_32x32x16_bf16 v[144:159], a[96:99], a[112:115], v[144:159]
    ds_read_b64_tr_b16 a[4:5], v38 offset:18432
    ds_read_b64_tr_b16 a[6:7], v38 offset:18944
    v_mfma_f32_32x32x16_bf16 v[160:175], a[100:103], a[112:115], v[160:175]
    ds_read_b128 a[12:15], v21 offset:8192
    buffer_load_dwordx4 v9, s[44:47], s35 offen lds
    s_add_u32 m0, s4, 75776
    s_add_u32 s35, s12, 512
    v_mfma_f32_32x32x16_bf16 v[176:191], a[112:115], a[104:107], v[176:191]
    s_waitcnt lgkmcnt(8)
    v_mfma_f32_32x32x16_bf16 v[192:207], a[96:99], a[116:119], v[192:207]
    v_mfma_f32_32x32x16_bf16 v[208:223], a[100:103], a[116:119], v[208:223]
    ds_read_b128 a[16:19], v21 offset:16384
    buffer_load_dwordx4 v8, s[40:43], s35 offen lds
    s_add_u32 m0, s4, 79872
    s_add_u32 s35, s13, 512
    v_mfma_f32_32x32x16_bf16 v[224:239], a[116:119], a[104:107], v[224:239]
    v_mfma_f32_32x32x16_bf16 v[240:255], a[120:123], a[104:107], v[240:255]
    s_waitcnt lgkmcnt(1)
    v_mfma_f32_32x32x16_bf16 v[96:111], a[124:127], a[8:11], v[96:111]
    ds_read_b128 a[20:23], v33 offset:0
    buffer_load_dwordx4 v8, s[40:43], s35 offen lds
    v_mfma_f32_32x32x16_bf16 v[112:127], a[0:3], a[8:11], v[112:127]
    ds_read_b64_tr_b16 a[24:25], v38 offset:4096
    ds_read_b64_tr_b16 a[26:27], v38 offset:4608
    ds_read_b128 a[36:39], v22 offset:0
    s_add_u32 m0, s4, 83968
    s_add_u32 s35, s14, 512
    v_mfma_f32_32x32x16_bf16 v[128:143], a[8:11], a[4:7], v[128:143]
    ds_read_b64_tr_b16 a[28:29], v38 offset:12288
    ds_read_b64_tr_b16 a[30:31], v38 offset:12800
    v_mfma_f32_32x32x16_bf16 v[144:159], a[124:127], a[12:15], v[144:159]
    ds_read_b64_tr_b16 a[32:33], v38 offset:20480
    ds_read_b64_tr_b16 a[34:35], v38 offset:20992
    buffer_load_dwordx4 v8, s[40:43], s35 offen lds
    v_mfma_f32_32x32x16_bf16 v[160:175], a[0:3], a[12:15], v[160:175]
    ds_read_b128 a[40:43], v22 offset:8192
    s_add_u32 m0, s4, 88064
    s_add_u32 s35, s15, 512
    v_mfma_f32_32x32x16_bf16 v[176:191], a[12:15], a[4:7], v[176:191]
    s_waitcnt lgkmcnt(8)
    v_mfma_f32_32x32x16_bf16 v[192:207], a[124:127], a[16:19], v[192:207]
    buffer_load_dwordx4 v8, s[40:43], s35 offen lds
    s_add_u32 m0, s4, 55296
    s_add_u32 s35, s10, 774144
    v_mfma_f32_32x32x16_bf16 v[208:223], a[0:3], a[16:19], v[208:223]
    ds_read_b128 a[44:47], v22 offset:16384
    v_mfma_f32_32x32x16_bf16 v[224:239], a[16:19], a[4:7], v[224:239]
    v_mfma_f32_32x32x16_bf16 v[240:255], a[20:23], a[4:7], v[240:255]
    s_mov_b64 exec, s[22:23]
    buffer_load_dwordx4 v9, s[44:47], s35 offen lds
    s_mov_b64 exec, -1
    s_add_u32 m0, s4, 63488
    s_add_u32 s35, s10, 775040
    s_waitcnt lgkmcnt(1)
    v_mfma_f32_32x32x16_bf16 v[96:111], a[24:27], a[36:39], v[96:111]
    ds_read_b128 a[48:51], v34 offset:0
    v_mfma_f32_32x32x16_bf16 v[112:127], a[28:31], a[36:39], v[112:127]
    ds_read_b64_tr_b16 a[52:53], v38 offset:6144
    ds_read_b64_tr_b16 a[54:55], v38 offset:6656
    ds_read_b128 a[64:67], v23 offset:0
    v_mfma_f32_32x32x16_bf16 v[128:143], a[36:39], a[32:35], v[128:143]
    ds_read_b64_tr_b16 a[56:57], v38 offset:14336
    ds_read_b64_tr_b16 a[58:59], v38 offset:14848
    buffer_load_dwordx4 v9, s[44:47], s35 offen lds
    v_mfma_f32_32x32x16_bf16 v[144:159], a[24:27], a[40:43], v[144:159]
    ds_read_b64_tr_b16 a[60:61], v38 offset:22528
    ds_read_b64_tr_b16 a[62:63], v38 offset:23040
    s_add_u32 m0, s4, 71680
    s_add_u32 s35, s10, 775936
    v_mfma_f32_32x32x16_bf16 v[160:175], a[28:31], a[40:43], v[160:175]
    ds_read_b128 a[68:71], v23 offset:8192
    v_mfma_f32_32x32x16_bf16 v[176:191], a[40:43], a[32:35], v[176:191]
    buffer_load_dwordx4 v9, s[44:47], s35 offen lds
    s_add_u32 m0, s4, 92160
    s_add_u32 s35, s38, 512
    s_waitcnt lgkmcnt(8)
    v_mfma_f32_32x32x16_bf16 v[192:207], a[24:27], a[44:47], v[192:207]
    v_mfma_f32_32x32x16_bf16 v[208:223], a[28:31], a[44:47], v[208:223]
    ds_read_b128 a[72:75], v23 offset:16384
    v_mfma_f32_32x32x16_bf16 v[224:239], a[44:47], a[32:35], v[224:239]
    buffer_load_dwordx4 v8, s[40:43], s35 offen lds
    s_add_u32 m0, s4, 96256
    s_add_u32 s35, s39, 512
    v_mfma_f32_32x32x16_bf16 v[240:255], a[48:51], a[32:35], v[240:255]
    s_waitcnt lgkmcnt(1)
    v_mfma_f32_32x32x16_bf16 v[96:111], a[52:55], a[64:67], v[96:111]
    ds_read_b128 a[76:79], v35 offset:0
    v_mfma_f32_32x32x16_bf16 v[112:127], a[56:59], a[64:67], v[112:127]
    buffer_load_dwordx4 v8, s[40:43], s35 offen lds
    s_add_u32 m0, s5, 100352
    s_mov_b32 s35, 512
    v_mfma_f32_32x32x16_bf16 v[128:143], a[64:67], a[60:63], v[128:143]
    v_mfma_f32_32x32x16_bf16 v[144:159], a[52:55], a[68:71], v[144:159]
    s_waitcnt vmcnt(12) lgkmcnt(0)
    s_barrier
    ds_read_b64_tr_b16 a[80:81], v36 offset:0
    ds_read_b64_tr_b16 a[82:83], v36 offset:512
    ds_read_b128 a[92:95], v12 offset:0
    v_mfma_f32_32x32x16_bf16 v[160:175], a[56:59], a[68:71], v[160:175]
    ds_read_b64_tr_b16 a[84:85], v36 offset:8192
    ds_read_b64_tr_b16 a[86:87], v36 offset:8704
    ds_read_b64_tr_b16 a[88:89], v36 offset:16384
    v_mfma_f32_32x32x16_bf16 v[176:191], a[68:71], a[60:63], v[176:191]
    ds_read_b64_tr_b16 a[90:91], v36 offset:16896
    ds_read_b128 a[96:99], v12 offset:8192
    s_mov_b32 exec_hi, 0
    buffer_load_dwordx4 v10, s[40:43], s35 offen lds
    s_mov_b64 exec, -1
    v_mfma_f32_32x32x16_bf16 v[192:207], a[52:55], a[72:75], v[192:207]
    v_add_u32 v4, 51200, v39
    ds_write_b16 v4, v44 offset:0
    s_add_u32 m0, s4, 102400
    s_add_u32 s35, s10, 860160
    v_mfma_f32_32x32x16_bf16 v[208:223], a[56:59], a[72:75], v[208:223]
    ds_read_b128 a[100:103], v12 offset:16384
    v_mfma_f32_32x32x16_bf16 v[224:239], a[72:75], a[60:63], v[224:239]
    s_mov_b64 exec, s[22:23]
    buffer_load_dwordx4 v9, s[44:47], s35 offen lds
    s_mov_b64 exec, -1
    s_add_u32 m0, s4, 110592
    s_add_u32 s35, s10, 861056
    v_mfma_f32_32x32x16_bf16 v[240:255], a[76:79], a[60:63], v[240:255]
    s_waitcnt lgkmcnt(2)
    v_mfma_f32_32x32x16_bf16 v[96:111], a[80:83], a[92:95], v[96:111]
    ds_read_b128 a[104:107], v24 offset:0
    v_mfma_f32_32x32x16_bf16 v[112:127], a[84:87], a[92:95], v[112:127]
    ds_read_b64_tr_b16 a[108:109], v36 offset:2048
    ds_read_b64_tr_b16 a[110:111], v36 offset:2560
    ds_read_b128 a[120:123], v13 offset:0
    buffer_load_dwordx4 v9, s[44:47], s35 offen lds
    v_mfma_f32_32x32x16_bf16 v[128:143], a[92:95], a[88:91], v[128:143]
    ds_read_b64_tr_b16 a[112:113], v36 offset:10240
    ds_read_b64_tr_b16 a[114:115], v36 offset:10752
    s_add_u32 m0, s4, 118784
    s_add_u32 s35, s10, 861952
    v_mfma_f32_32x32x16_bf16 v[144:159], a[80:83], a[96:99], v[144:159]
    ds_read_b64_tr_b16 a[116:117], v36 offset:18432
    ds_read_b64_tr_b16 a[118:119], v36 offset:18944
    v_mfma_f32_32x32x16_bf16 v[160:175], a[84:87], a[96:99], v[160:175]
    ds_read_b128 a[124:127], v13 offset:8192
    buffer_load_dwordx4 v9, s[44:47], s35 offen lds
    s_add_u32 m0, s4, 126976
    s_add_u32 s35, s12, 640
    v_mfma_f32_32x32x16_bf16 v[176:191], a[96:99], a[88:91], v[176:191]
    s_waitcnt lgkmcnt(8)
    v_mfma_f32_32x32x16_bf16 v[192:207], a[80:83], a[100:103], v[192:207]
    v_mfma_f32_32x32x16_bf16 v[208:223], a[84:87], a[100:103], v[208:223]
    ds_read_b128 a[0:3], v13 offset:16384
    buffer_load_dwordx4 v8, s[40:43], s35 offen lds
    s_add_u32 m0, s4, 131072
    s_add_u32 s35, s13, 640
    v_mfma_f32_32x32x16_bf16 v[224:239], a[100:103], a[88:91], v[224:239]
    v_mfma_f32_32x32x16_bf16 v[240:255], a[104:107], a[88:91], v[240:255]
    s_waitcnt lgkmcnt(1)
    v_mfma_f32_32x32x16_bf16 v[96:111], a[108:111], a[120:123], v[96:111]
    ds_read_b128 a[4:7], v25 offset:0
    buffer_load_dwordx4 v8, s[40:43], s35 offen lds
    v_mfma_f32_32x32x16_bf16 v[112:127], a[112:115], a[120:123], v[112:127]
    ds_read_b64_tr_b16 a[8:9], v36 offset:4096
    ds_read_b64_tr_b16 a[10:11], v36 offset:4608
    ds_read_b128 a[20:23], v14 offset:0
    s_add_u32 m0, s4, 135168
    s_add_u32 s35, s14, 640
    v_mfma_f32_32x32x16_bf16 v[128:143], a[120:123], a[116:119], v[128:143]
    ds_read_b64_tr_b16 a[12:13], v36 offset:12288
    ds_read_b64_tr_b16 a[14:15], v36 offset:12800
    v_mfma_f32_32x32x16_bf16 v[144:159], a[108:111], a[124:127], v[144:159]
    ds_read_b64_tr_b16 a[16:17], v36 offset:20480
    ds_read_b64_tr_b16 a[18:19], v36 offset:20992
    buffer_load_dwordx4 v8, s[40:43], s35 offen lds
    v_mfma_f32_32x32x16_bf16 v[160:175], a[112:115], a[124:127], v[160:175]
    ds_read_b128 a[24:27], v14 offset:8192
    s_add_u32 m0, s4, 139264
    s_add_u32 s35, s15, 640
    v_mfma_f32_32x32x16_bf16 v[176:191], a[124:127], a[116:119], v[176:191]
    s_waitcnt lgkmcnt(8)
    v_mfma_f32_32x32x16_bf16 v[192:207], a[108:111], a[0:3], v[192:207]
    buffer_load_dwordx4 v8, s[40:43], s35 offen lds
    s_add_u32 m0, s4, 106496
    s_add_u32 s35, s10, 946176
    v_mfma_f32_32x32x16_bf16 v[208:223], a[112:115], a[0:3], v[208:223]
    ds_read_b128 a[28:31], v14 offset:16384
    v_mfma_f32_32x32x16_bf16 v[224:239], a[0:3], a[116:119], v[224:239]
    v_mfma_f32_32x32x16_bf16 v[240:255], a[4:7], a[116:119], v[240:255]
    s_mov_b64 exec, s[22:23]
    buffer_load_dwordx4 v9, s[44:47], s35 offen lds
    s_mov_b64 exec, -1
    s_add_u32 m0, s4, 114688
    s_add_u32 s35, s10, 947072
    s_waitcnt lgkmcnt(1)
    v_mfma_f32_32x32x16_bf16 v[96:111], a[8:11], a[20:23], v[96:111]
    ds_read_b128 a[32:35], v26 offset:0
    v_mfma_f32_32x32x16_bf16 v[112:127], a[12:15], a[20:23], v[112:127]
    ds_read_b64_tr_b16 a[36:37], v36 offset:6144
    ds_read_b64_tr_b16 a[38:39], v36 offset:6656
    ds_read_b128 a[48:51], v15 offset:0
    v_mfma_f32_32x32x16_bf16 v[128:143], a[20:23], a[16:19], v[128:143]
    ds_read_b64_tr_b16 a[40:41], v36 offset:14336
    ds_read_b64_tr_b16 a[42:43], v36 offset:14848
    buffer_load_dwordx4 v9, s[44:47], s35 offen lds
    v_mfma_f32_32x32x16_bf16 v[144:159], a[8:11], a[24:27], v[144:159]
    ds_read_b64_tr_b16 a[44:45], v36 offset:22528
    ds_read_b64_tr_b16 a[46:47], v36 offset:23040
    s_add_u32 m0, s4, 122880
    s_add_u32 s35, s10, 947968
    v_mfma_f32_32x32x16_bf16 v[160:175], a[12:15], a[24:27], v[160:175]
    ds_read_b128 a[52:55], v15 offset:8192
    v_mfma_f32_32x32x16_bf16 v[176:191], a[24:27], a[16:19], v[176:191]
    buffer_load_dwordx4 v9, s[44:47], s35 offen lds
    s_add_u32 m0, s4, 143360
    s_add_u32 s35, s38, 640
    s_waitcnt lgkmcnt(8)
    v_mfma_f32_32x32x16_bf16 v[192:207], a[8:11], a[28:31], v[192:207]
    v_mfma_f32_32x32x16_bf16 v[208:223], a[12:15], a[28:31], v[208:223]
    ds_read_b128 a[56:59], v15 offset:16384
    v_mfma_f32_32x32x16_bf16 v[224:239], a[28:31], a[16:19], v[224:239]
    buffer_load_dwordx4 v8, s[40:43], s35 offen lds
    s_add_u32 m0, s4, 147456
    s_add_u32 s35, s39, 640
    v_mfma_f32_32x32x16_bf16 v[240:255], a[32:35], a[16:19], v[240:255]
    s_waitcnt lgkmcnt(1)
    v_mfma_f32_32x32x16_bf16 v[96:111], a[36:39], a[48:51], v[96:111]
    ds_read_b128 a[60:63], v27 offset:0
    v_mfma_f32_32x32x16_bf16 v[112:127], a[40:43], a[48:51], v[112:127]
    buffer_load_dwordx4 v8, s[40:43], s35 offen lds
    s_add_u32 m0, s5, 151552
    s_mov_b32 s35, 640
    v_mfma_f32_32x32x16_bf16 v[128:143], a[48:51], a[44:47], v[128:143]
    v_mfma_f32_32x32x16_bf16 v[144:159], a[36:39], a[52:55], v[144:159]
    s_waitcnt vmcnt(12) lgkmcnt(0)
    s_barrier
    ds_read_b64_tr_b16 a[64:65], v37 offset:0
    ds_read_b64_tr_b16 a[66:67], v37 offset:512
    ds_read_b128 a[76:79], v16 offset:0
    v_mfma_f32_32x32x16_bf16 v[160:175], a[40:43], a[52:55], v[160:175]
    ds_read_b64_tr_b16 a[68:69], v37 offset:8192
    ds_read_b64_tr_b16 a[70:71], v37 offset:8704
    ds_read_b64_tr_b16 a[72:73], v37 offset:16384
    v_mfma_f32_32x32x16_bf16 v[176:191], a[52:55], a[44:47], v[176:191]
    ds_read_b64_tr_b16 a[74:75], v37 offset:16896
    ds_read_b128 a[80:83], v16 offset:8192
    s_mov_b32 exec_hi, 0
    buffer_load_dwordx4 v10, s[40:43], s35 offen lds
    s_mov_b64 exec, -1
    v_mfma_f32_32x32x16_bf16 v[192:207], a[36:39], a[56:59], v[192:207]
    v_add_u32 v4, 102400, v39
    ds_write_b16 v4, v45 offset:0
    s_add_u32 m0, s4, 0
    s_add_u32 s35, s10, 1032192
    v_mfma_f32_32x32x16_bf16 v[208:223], a[40:43], a[56:59], v[208:223]
    ds_read_b128 a[84:87], v16 offset:16384
    v_mfma_f32_32x32x16_bf16 v[224:239], a[56:59], a[44:47], v[224:239]
    s_mov_b64 exec, s[22:23]
    buffer_load_dwordx4 v9, s[44:47], s35 offen lds
    s_mov_b64 exec, -1
    s_add_u32 m0, s4, 8192
    s_add_u32 s35, s10, 1033088
    v_mfma_f32_32x32x16_bf16 v[240:255], a[60:63], a[44:47], v[240:255]
    s_waitcnt lgkmcnt(2)
    v_mfma_f32_32x32x16_bf16 v[96:111], a[64:67], a[76:79], v[96:111]
    ds_read_b128 a[88:91], v28 offset:0
    v_mfma_f32_32x32x16_bf16 v[112:127], a[68:71], a[76:79], v[112:127]
    ds_read_b64_tr_b16 a[92:93], v37 offset:2048
    ds_read_b64_tr_b16 a[94:95], v37 offset:2560
    ds_read_b128 a[104:107], v17 offset:0
    buffer_load_dwordx4 v9, s[44:47], s35 offen lds
    v_mfma_f32_32x32x16_bf16 v[128:143], a[76:79], a[72:75], v[128:143]
    ds_read_b64_tr_b16 a[96:97], v37 offset:10240
    ds_read_b64_tr_b16 a[98:99], v37 offset:10752
    s_add_u32 m0, s4, 16384
    s_add_u32 s35, s10, 1033984
    v_mfma_f32_32x32x16_bf16 v[144:159], a[64:67], a[80:83], v[144:159]
    ds_read_b64_tr_b16 a[100:101], v37 offset:18432
    ds_read_b64_tr_b16 a[102:103], v37 offset:18944
    v_mfma_f32_32x32x16_bf16 v[160:175], a[68:71], a[80:83], v[160:175]
    ds_read_b128 a[108:111], v17 offset:8192
    buffer_load_dwordx4 v9, s[44:47], s35 offen lds
    s_add_u32 m0, s4, 24576
    s_add_u32 s35, s12, 768
    v_mfma_f32_32x32x16_bf16 v[176:191], a[80:83], a[72:75], v[176:191]
    s_waitcnt lgkmcnt(8)
    v_mfma_f32_32x32x16_bf16 v[192:207], a[64:67], a[84:87], v[192:207]
    v_mfma_f32_32x32x16_bf16 v[208:223], a[68:71], a[84:87], v[208:223]
    ds_read_b128 a[112:115], v17 offset:16384
    buffer_load_dwordx4 v8, s[40:43], s35 offen lds
    s_add_u32 m0, s4, 28672
    s_add_u32 s35, s13, 768
    v_mfma_f32_32x32x16_bf16 v[224:239], a[84:87], a[72:75], v[224:239]
    v_mfma_f32_32x32x16_bf16 v[240:255], a[88:91], a[72:75], v[240:255]
    s_waitcnt lgkmcnt(1)
    v_mfma_f32_32x32x16_bf16 v[96:111], a[92:95], a[104:107], v[96:111]
    ds_read_b128 a[116:119], v29 offset:0
    buffer_load_dwordx4 v8, s[40:43], s35 offen lds
    v_mfma_f32_32x32x16_bf16 v[112:127], a[96:99], a[104:107], v[112:127]
    ds_read_b64_tr_b16 a[120:121], v37 offset:4096
    ds_read_b64_tr_b16 a[122:123], v37 offset:4608
    ds_read_b128 a[4:7], v18 offset:0
    s_add_u32 m0, s4, 32768
    s_add_u32 s35, s14, 768
    v_mfma_f32_32x32x16_bf16 v[128:143], a[104:107], a[100:103], v[128:143]
    ds_read_b64_tr_b16 a[124:125], v37 offset:12288
    ds_read_b64_tr_b16 a[126:127], v37 offset:12800
    v_mfma_f32_32x32x16_bf16 v[144:159], a[92:95], a[108:111], v[144:159]
    ds_read_b64_tr_b16 a[0:1], v37 offset:20480
    ds_read_b64_tr_b16 a[2:3], v37 offset:20992
    buffer_load_dwordx4 v8, s[40:43], s35 offen lds
    v_mfma_f32_32x32x16_bf16 v[160:175], a[96:99], a[108:111], v[160:175]
    ds_read_b128 a[8:11], v18 offset:8192
    s_add_u32 m0, s4, 36864
    s_add_u32 s35, s15, 768
    v_mfma_f32_32x32x16_bf16 v[176:191], a[108:111], a[100:103], v[176:191]
    s_waitcnt lgkmcnt(8)
    v_mfma_f32_32x32x16_bf16 v[192:207], a[92:95], a[112:115], v[192:207]
    buffer_load_dwordx4 v8, s[40:43], s35 offen lds
    s_add_u32 m0, s4, 4096
    s_add_u32 s35, s10, 1118208
    v_mfma_f32_32x32x16_bf16 v[208:223], a[96:99], a[112:115], v[208:223]
    ds_read_b128 a[12:15], v18 offset:16384
    v_mfma_f32_32x32x16_bf16 v[224:239], a[112:115], a[100:103], v[224:239]
    v_mfma_f32_32x32x16_bf16 v[240:255], a[116:119], a[100:103], v[240:255]
    s_mov_b64 exec, s[22:23]
    buffer_load_dwordx4 v9, s[44:47], s35 offen lds
    s_mov_b64 exec, -1
    s_add_u32 m0, s4, 12288
    s_add_u32 s35, s10, 1119104
    s_waitcnt lgkmcnt(1)
    v_mfma_f32_32x32x16_bf16 v[96:111], a[120:123], a[4:7], v[96:111]
    ds_read_b128 a[16:19], v30 offset:0
    v_mfma_f32_32x32x16_bf16 v[112:127], a[124:127], a[4:7], v[112:127]
    ds_read_b64_tr_b16 a[20:21], v37 offset:6144
    ds_read_b64_tr_b16 a[22:23], v37 offset:6656
    ds_read_b128 a[32:35], v19 offset:0
    v_mfma_f32_32x32x16_bf16 v[128:143], a[4:7], a[0:3], v[128:143]
    ds_read_b64_tr_b16 a[24:25], v37 offset:14336
    ds_read_b64_tr_b16 a[26:27], v37 offset:14848
    buffer_load_dwordx4 v9, s[44:47], s35 offen lds
    v_mfma_f32_32x32x16_bf16 v[144:159], a[120:123], a[8:11], v[144:159]
    ds_read_b64_tr_b16 a[28:29], v37 offset:22528
    ds_read_b64_tr_b16 a[30:31], v37 offset:23040
    s_add_u32 m0, s4, 20480
    s_add_u32 s35, s10, 1120000
    v_mfma_f32_32x32x16_bf16 v[160:175], a[124:127], a[8:11], v[160:175]
    ds_read_b128 a[36:39], v19 offset:8192
    v_mfma_f32_32x32x16_bf16 v[176:191], a[8:11], a[0:3], v[176:191]
    buffer_load_dwordx4 v9, s[44:47], s35 offen lds
    s_add_u32 m0, s4, 40960
    s_add_u32 s35, s38, 768
    s_waitcnt lgkmcnt(8)
    v_mfma_f32_32x32x16_bf16 v[192:207], a[120:123], a[12:15], v[192:207]
    v_mfma_f32_32x32x16_bf16 v[208:223], a[124:127], a[12:15], v[208:223]
    ds_read_b128 a[40:43], v19 offset:16384
    v_mfma_f32_32x32x16_bf16 v[224:239], a[12:15], a[0:3], v[224:239]
    buffer_load_dwordx4 v8, s[40:43], s35 offen lds
    s_add_u32 m0, s4, 45056
    s_add_u32 s35, s39, 768
    v_mfma_f32_32x32x16_bf16 v[240:255], a[16:19], a[0:3], v[240:255]
    s_waitcnt lgkmcnt(1)
    v_mfma_f32_32x32x16_bf16 v[96:111], a[20:23], a[32:35], v[96:111]
    ds_read_b128 a[44:47], v31 offset:0
    v_mfma_f32_32x32x16_bf16 v[112:127], a[24:27], a[32:35], v[112:127]
    buffer_load_dwordx4 v8, s[40:43], s35 offen lds
    s_add_u32 m0, s5, 49152
    s_mov_b32 s35, 768
    v_mfma_f32_32x32x16_bf16 v[128:143], a[32:35], a[28:31], v[128:143]
    v_mfma_f32_32x32x16_bf16 v[144:159], a[20:23], a[36:39], v[144:159]
    s_waitcnt vmcnt(12) lgkmcnt(0)
    s_barrier
    ds_read_b64_tr_b16 a[48:49], v38 offset:0
    ds_read_b64_tr_b16 a[50:51], v38 offset:512
    ds_read_b128 a[56:59], v20 offset:0
    v_mfma_f32_32x32x16_bf16 v[160:175], a[24:27], a[36:39], v[160:175]
    ds_read_b64_tr_b16 a[52:53], v38 offset:8192
    ds_read_b64_tr_b16 a[54:55], v38 offset:8704
    ds_read_b128 a[60:63], v20 offset:8192
    v_mfma_f32_32x32x16_bf16 v[176:191], a[36:39], a[28:31], v[176:191]
    ds_read_b128 a[64:67], v20 offset:16384
    s_mov_b32 exec_hi, 0
    buffer_load_dwordx4 v10, s[40:43], s35 offen lds
    s_mov_b64 exec, -1
    v_mfma_f32_32x32x16_bf16 v[192:207], a[20:23], a[40:43], v[192:207]
    ds_write_b16 v39, v46 offset:0
    s_add_u32 s95, s94, 0
    s_and_b32 s95, s95, 3
    s_sub_i32 s95, s97, s95
    s_add_i32 s35, s95, 7
    s_cmp_lt_i32 s95, 0
    s_cselect_b32 s95, s35, s95
    s_mul_i32 s95, s95, 57344
    s_add_u32 s95, s95, s32
    s_add_u32 m0, s34, 0
    s_add_u32 s35, s95, 0
    buffer_load_dwordx4 v40, s[48:51], s35 offen lds
    s_add_u32 m0, s34, 1024
    s_add_u32 s35, s95, 7168
    buffer_load_dwordx4 v40, s[48:51], s35 offen lds
    v_mfma_f32_32x32x16_bf16 v[208:223], a[24:27], a[40:43], v[208:223]
    ds_read_b64_tr_b16 a[68:69], v38 offset:2048
    ds_read_b64_tr_b16 a[70:71], v38 offset:2560
    ds_read_b128 a[76:79], v21 offset:0
    v_mfma_f32_32x32x16_bf16 v[224:239], a[40:43], a[28:31], v[224:239]
    ds_read_b64_tr_b16 a[72:73], v38 offset:10240
    ds_read_b64_tr_b16 a[74:75], v38 offset:10752
    s_add_u32 m0, s34, 2048
    s_add_u32 s35, s95, 14336
    buffer_load_dwordx4 v40, s[48:51], s35 offen lds
    s_add_u32 m0, s34, 3072
    s_add_u32 s35, s95, 21504
    buffer_load_dwordx4 v40, s[48:51], s35 offen lds
    v_mfma_f32_32x32x16_bf16 v[240:255], a[44:47], a[28:31], v[240:255]
    s_add_u32 m0, s34, 4096
    s_add_u32 s35, s95, 28672
    buffer_load_dwordx4 v40, s[48:51], s35 offen lds
    s_add_u32 m0, s34, 5120
    s_add_u32 s35, s95, 35840
    buffer_load_dwordx4 v40, s[48:51], s35 offen lds
    s_waitcnt lgkmcnt(7)
    v_mfma_f32_32x32x16_bf16 v[96:111], a[48:51], a[56:59], v[96:111]
    ds_read_b128 a[80:83], v21 offset:8192
    s_add_u32 m0, s34, 6144
    s_add_u32 s35, s95, 43008
    buffer_load_dwordx4 v40, s[48:51], s35 offen lds
    s_add_u32 m0, s34, 7168
    s_add_u32 s35, s95, 50176
    buffer_load_dwordx4 v40, s[48:51], s35 offen lds
    v_mfma_f32_32x32x16_bf16 v[112:127], a[52:55], a[56:59], v[112:127]
    ds_read_b128 a[84:87], v21 offset:16384
    s_add_u32 s95, s94, 1
    s_and_b32 s95, s95, 3
    s_sub_i32 s95, s97, s95
    s_add_i32 s35, s95, 7
    s_cmp_lt_i32 s95, 0
    s_cselect_b32 s95, s35, s95
    s_mul_i32 s95, s95, 57344
    s_add_u32 s95, s95, s32
    s_add_u32 m0, s34, 8192
    s_add_u32 s35, s95, 0
    buffer_load_dwordx4 v40, s[48:51], s35 offen lds
    s_add_u32 m0, s34, 9216
    s_add_u32 s35, s95, 7168
    buffer_load_dwordx4 v40, s[48:51], s35 offen lds
    v_mfma_f32_32x32x16_bf16 v[144:159], a[48:51], a[60:63], v[144:159]
    s_add_u32 m0, s34, 10240
    s_add_u32 s35, s95, 14336
    buffer_load_dwordx4 v40, s[48:51], s35 offen lds
    s_add_u32 m0, s34, 11264
    s_add_u32 s35, s95, 21504
    buffer_load_dwordx4 v40, s[48:51], s35 offen lds
    v_mfma_f32_32x32x16_bf16 v[160:175], a[52:55], a[60:63], v[160:175]
    ds_read_b64_tr_b16 a[88:89], v38 offset:4096
    ds_read_b64_tr_b16 a[90:91], v38 offset:4608
    ds_read_b128 a[96:99], v22 offset:0
    s_waitcnt lgkmcnt(5)
    v_mfma_f32_32x32x16_bf16 v[192:207], a[48:51], a[64:67], v[192:207]
    ds_read_b64_tr_b16 a[92:93], v38 offset:12288
    ds_read_b64_tr_b16 a[94:95], v38 offset:12800
    v_mfma_f32_32x32x16_bf16 v[208:223], a[52:55], a[64:67], v[208:223]
    ds_read_b128 a[100:103], v22 offset:8192
    v_mfma_f32_32x32x16_bf16 v[96:111], a[68:71], a[76:79], v[96:111]
    v_mfma_f32_32x32x16_bf16 v[112:127], a[72:75], a[76:79], v[112:127]
    ds_read_b128 a[104:107], v22 offset:16384
    s_waitcnt lgkmcnt(7)
    v_mfma_f32_32x32x16_bf16 v[144:159], a[68:71], a[80:83], v[144:159]
    v_mfma_f32_32x32x16_bf16 v[160:175], a[72:75], a[80:83], v[160:175]
    ds_read_b64_tr_b16 a[108:109], v38 offset:6144
    ds_read_b64_tr_b16 a[110:111], v38 offset:6656
    ds_read_b128 a[116:119], v23 offset:0
    v_mfma_f32_32x32x16_bf16 v[192:207], a[68:71], a[84:87], v[192:207]
    ds_read_b64_tr_b16 a[112:113], v38 offset:14336
    ds_read_b64_tr_b16 a[114:115], v38 offset:14848
    v_mfma_f32_32x32x16_bf16 v[208:223], a[72:75], a[84:87], v[208:223]
    ds_read_b128 a[120:123], v23 offset:8192
    s_waitcnt lgkmcnt(7)
    v_mfma_f32_32x32x16_bf16 v[96:111], a[88:91], a[96:99], v[96:111]
    v_mfma_f32_32x32x16_bf16 v[112:127], a[92:95], a[96:99], v[112:127]
    ds_read_b128 a[124:127], v23 offset:16384
    v_mfma_f32_32x32x16_bf16 v[144:159], a[88:91], a[100:103], v[144:159]
    v_mfma_f32_32x32x16_bf16 v[160:175], a[92:95], a[100:103], v[160:175]
    s_waitcnt lgkmcnt(2)
    v_mfma_f32_32x32x16_bf16 v[192:207], a[88:91], a[104:107], v[192:207]
    v_mfma_f32_32x32x16_bf16 v[208:223], a[92:95], a[104:107], v[208:223]
    s_waitcnt vmcnt(12) lgkmcnt(0)
    s_barrier
    ds_read_b64_tr_b16 a[0:1], v36 offset:0
    ds_read_b64_tr_b16 a[2:3], v36 offset:512
    ds_read_b128 a[8:11], v12 offset:0
    v_mfma_f32_32x32x16_bf16 v[96:111], a[108:111], a[116:119], v[96:111]
    ds_read_b64_tr_b16 a[4:5], v36 offset:8192
    ds_read_b64_tr_b16 a[6:7], v36 offset:8704
    ds_read_b128 a[12:15], v12 offset:8192
    v_mfma_f32_32x32x16_bf16 v[112:127], a[112:115], a[116:119], v[112:127]
    ds_read_b128 a[16:19], v12 offset:16384
    v_mfma_f32_32x32x16_bf16 v[144:159], a[108:111], a[120:123], v[144:159]
    v_mfma_f32_32x32x16_bf16 v[160:175], a[112:115], a[120:123], v[160:175]
    ds_read_b64_tr_b16 a[20:21], v36 offset:2048
    ds_read_b64_tr_b16 a[22:23], v36 offset:2560
    ds_read_b128 a[28:31], v13 offset:0
    v_mfma_f32_32x32x16_bf16 v[192:207], a[108:111], a[124:127], v[192:207]
    ds_read_b64_tr_b16 a[24:25], v36 offset:10240
    ds_read_b64_tr_b16 a[26:27], v36 offset:10752
    v_mfma_f32_32x32x16_bf16 v[208:223], a[112:115], a[124:127], v[208:223]
    ds_read_b128 a[32:35], v13 offset:8192
    s_waitcnt lgkmcnt(7)
    v_mfma_f32_32x32x16_bf16 v[96:111], a[0:3], a[8:11], v[96:111]
    v_mfma_f32_32x32x16_bf16 v[112:127], a[4:7], a[8:11], v[112:127]
    ds_read_b128 a[36:39], v13 offset:16384
    v_mfma_f32_32x32x16_bf16 v[144:159], a[0:3], a[12:15], v[144:159]
    s_waitcnt vmcnt(10)
    ds_read_b64_tr_b16 a[144:145], v41 offset:0
    ds_read_b64_tr_b16 a[146:147], v41 offset:1024
    ds_read_b64_tr_b16 a[148:149], v42 offset:0
    ds_read_b64_tr_b16 a[150:151], v42 offset:1024
    v_mfma_f32_32x32x16_bf16 v[160:175], a[4:7], a[12:15], v[160:175]
    ds_read_b64_tr_b16 a[40:41], v36 offset:4096
    s_waitcnt lgkmcnt(7)
    v_mfma_f32_32x32x16_bf16 v[192:207], a[0:3], a[16:19], v[192:207]
    ds_read_b64_tr_b16 a[42:43], v36 offset:4608
    ds_read_b128 a[48:51], v14 offset:0
    ds_read_b64_tr_b16 a[44:45], v36 offset:12288
    v_mfma_f32_32x32x16_bf16 v[208:223], a[4:7], a[16:19], v[208:223]
    ds_read_b64_tr_b16 a[46:47], v36 offset:12800
    ds_read_b128 a[52:55], v14 offset:8192
    s_waitcnt vmcnt(8)
    ds_read_b64_tr_b16 a[152:153], v41 offset:2048
    ds_read_b64_tr_b16 a[154:155], v41 offset:3072
    ds_read_b64_tr_b16 a[156:157], v42 offset:2048
    s_waitcnt lgkmcnt(7)
    ds_read_b64_tr_b16 a[158:159], v42 offset:3072
    v_mfma_f32_32x32x16_bf16 v[96:111], a[20:23], a[28:31], v[96:111]
    s_waitcnt vmcnt(6)
    ds_read_b64_tr_b16 a[160:161], v41 offset:4096
    ds_read_b64_tr_b16 a[162:163], v41 offset:5120
    ds_read_b64_tr_b16 a[164:165], v42 offset:4096
    ds_read_b64_tr_b16 a[166:167], v42 offset:5120
    v_mfma_f32_32x32x16_bf16 v[112:127], a[24:27], a[28:31], v[112:127]
    ds_read_b128 a[56:59], v14 offset:16384
    s_waitcnt vmcnt(4)
    ds_read_b64_tr_b16 a[168:169], v41 offset:6144
    ds_read_b64_tr_b16 a[170:171], v41 offset:7168
    s_waitcnt lgkmcnt(7)
    ds_read_b64_tr_b16 a[172:173], v42 offset:6144
    ds_read_b64_tr_b16 a[174:175], v42 offset:7168
    v_mfma_f32_32x32x16_bf16 v[144:159], a[20:23], a[32:35], v[144:159]
    s_waitcnt vmcnt(2)
    ds_read_b64_tr_b16 a[176:177], v41 offset:8192
    ds_read_b64_tr_b16 a[178:179], v41 offset:9216
    ds_read_b64_tr_b16 a[180:181], v42 offset:8192
    ds_read_b64_tr_b16 a[182:183], v42 offset:9216
    v_mfma_f32_32x32x16_bf16 v[160:175], a[24:27], a[32:35], v[160:175]
    s_waitcnt vmcnt(0)
    ds_read_b64_tr_b16 a[184:185], v41 offset:10240
    ds_read_b64_tr_b16 a[186:187], v41 offset:11264
    s_waitcnt lgkmcnt(7)
    ds_read_b64_tr_b16 a[188:189], v42 offset:10240
    ds_read_b64_tr_b16 a[190:191], v42 offset:11264
    v_mfma_f32_32x32x16_bf16 v[192:207], a[20:23], a[36:39], v[192:207]
    ds_read_b64_tr_b16 a[60:61], v36 offset:6144
    ds_read_b64_tr_b16 a[62:63], v36 offset:6656
    ds_read_b128 a[68:71], v15 offset:0
    v_mfma_f32_32x32x16_bf16 v[208:223], a[24:27], a[36:39], v[208:223]
    ds_read_b64_tr_b16 a[64:65], v36 offset:14336
    s_add_u32 m0, s34, 0
    s_add_u32 s35, s95, 28672
    buffer_load_dwordx4 v40, s[48:51], s35 offen lds
    s_add_u32 m0, s34, 1024
    s_add_u32 s35, s95, 35840
    buffer_load_dwordx4 v40, s[48:51], s35 offen lds
    v_mfma_f32_32x32x16_bf16 v[96:111], a[40:43], a[48:51], v[96:111]
    s_add_u32 m0, s34, 2048
    s_add_u32 s35, s95, 43008
    buffer_load_dwordx4 v40, s[48:51], s35 offen lds
    s_add_u32 m0, s34, 3072
    s_add_u32 s35, s95, 50176
    buffer_load_dwordx4 v40, s[48:51], s35 offen lds
    v_mfma_f32_32x32x16_bf16 v[112:127], a[44:47], a[48:51], v[112:127]
    s_add_u32 s95, s94, 2
    s_and_b32 s95, s95, 3
    s_sub_i32 s95, s97, s95
    s_add_i32 s35, s95, 7
    s_cmp_lt_i32 s95, 0
    s_cselect_b32 s95, s35, s95
    s_mul_i32 s95, s95, 57344
    s_add_u32 s95, s95, s32
    s_add_u32 m0, s34, 4096
    s_add_u32 s35, s95, 0
    buffer_load_dwordx4 v40, s[48:51], s35 offen lds
    s_add_u32 m0, s34, 5120
    s_add_u32 s35, s95, 7168
    buffer_load_dwordx4 v40, s[48:51], s35 offen lds
    v_mfma_f32_32x32x16_bf16 v[144:159], a[40:43], a[52:55], v[144:159]
    v_mfma_f32_32x32x16_bf16 v[160:175], a[44:47], a[52:55], v[160:175]
    ds_read_b64_tr_b16 a[66:67], v36 offset:14848
    v_mfma_f32_32x32x16_bf16 v[192:207], a[40:43], a[56:59], v[192:207]
    ds_read_b128 a[72:75], v15 offset:8192
    v_mfma_f32_32x32x16_bf16 v[208:223], a[44:47], a[56:59], v[208:223]
    s_waitcnt lgkmcnt(3)
    v_mfma_f32_32x32x16_bf16 v[96:111], a[60:63], a[68:71], v[96:111]
    ds_read_b128 a[76:79], v15 offset:16384
    ds_read_b64_tr_b16 a[80:81], v38 offset:16384
    ds_read_b64_tr_b16 a[82:83], v38 offset:16896
    s_waitcnt lgkmcnt(4)
    v_mfma_f32_32x32x16_bf16 v[112:127], a[64:67], a[68:71], v[112:127]
    ds_read_b128 a[84:87], v20 offset:0
    ds_read_b128 a[88:91], v20 offset:8192
    ds_read_b128 a[92:95], v20 offset:16384
    s_waitcnt lgkmcnt(6)
    v_mfma_f32_32x32x16_bf16 v[144:159], a[60:63], a[72:75], v[144:159]
    ds_read_b128 a[96:99], v32 offset:0
    ds_read_b64_tr_b16 a[100:101], v38 offset:18432
    ds_read_b64_tr_b16 a[102:103], v38 offset:18944
    v_mfma_f32_32x32x16_bf16 v[160:175], a[64:67], a[72:75], v[160:175]
    ds_read_b128 a[104:107], v21 offset:0
    ds_read_b128 a[108:111], v21 offset:8192
    ds_read_b128 a[112:115], v21 offset:16384
    s_waitcnt lgkmcnt(11)
    v_mfma_f32_32x32x16_bf16 v[192:207], a[60:63], a[76:79], v[192:207]
    ds_read_b128 a[116:119], v33 offset:0
    s_add_u32 m0, s34, 6144
    s_add_u32 s35, s95, 14336
    buffer_load_dwordx4 v40, s[48:51], s35 offen lds
    s_add_u32 m0, s34, 7168
    s_add_u32 s35, s95, 21504
    buffer_load_dwordx4 v40, s[48:51], s35 offen lds
    v_mfma_f32_32x32x16_bf16 v[208:223], a[64:67], a[76:79], v[208:223]
    ds_read_b64_tr_b16 a[120:121], v38 offset:20480
    s_add_u32 m0, s34, 8192
    s_add_u32 s35, s95, 28672
    buffer_load_dwordx4 v40, s[48:51], s35 offen lds
    s_add_u32 m0, s34, 9216
    s_add_u32 s35, s95, 35840
    buffer_load_dwordx4 v40, s[48:51], s35 offen lds
    s_waitcnt lgkmcnt(7)
    v_mfma_f32_32x32x16_bf16 v[128:143], a[84:87], a[80:83], v[128:143]
    ds_read_b64_tr_b16 a[122:123], v38 offset:20992
    ds_read_b128 a[124:127], v22 offset:0
    ds_read_b128 a[0:3], v22 offset:8192
    v_mfma_f32_32x32x16_bf16 v[176:191], a[88:91], a[80:83], v[176:191]
    ds_read_b128 a[4:7], v22 offset:16384
    s_add_u32 m0, s34, 10240
    s_add_u32 s35, s95, 43008
    buffer_load_dwordx4 v40, s[48:51], s35 offen lds
    s_add_u32 m0, s34, 11264
    s_add_u32 s35, s95, 50176
    buffer_load_dwordx4 v40, s[48:51], s35 offen lds
    v_mfma_f32_32x32x16_bf16 v[224:239], a[92:95], a[80:83], v[224:239]
    ds_read_b128 a[8:11], v34 offset:0
    buffer_store_dword v156, v47, s[56:59], s2 offen offset:256 sc1
    v_cvt_pk_bf16_f32 v144, v144, v145
    v_cvt_pk_bf16_f32 v145, v146, v147
    v_mfma_f32_32x32x16_bf16 v[240:255], a[96:99], a[80:83], v[240:255]
    ds_read_b64_tr_b16 a[12:13], v38 offset:22528
    v_cvt_pk_bf16_f32 v146, v148, v149
    v_cvt_pk_bf16_f32 v147, v150, v151
    v_cvt_pk_bf16_f32 v148, v152, v153
    v_cvt_pk_bf16_f32 v149, v154, v155
    v_cvt_pk_bf16_f32 v150, v156, v157
    s_waitcnt lgkmcnt(7)
    v_mfma_f32_32x32x16_bf16 v[128:143], a[104:107], a[100:103], v[128:143]
    ds_read_b64_tr_b16 a[14:15], v38 offset:23040
    ds_read_b128 a[16:19], v23 offset:0
    ds_read_b128 a[20:23], v23 offset:8192
    v_cvt_pk_bf16_f32 v151, v158, v159
    v_cvt_pk_bf16_f32 v160, v160, v161
    v_mfma_f32_32x32x16_bf16 v[176:191], a[108:111], a[100:103], v[176:191]
    ds_read_b128 a[24:27], v23 offset:16384
    v_cvt_pk_bf16_f32 v161, v162, v163
    v_cvt_pk_bf16_f32 v162, v164, v165
    v_cvt_pk_bf16_f32 v163, v166, v167
    v_cvt_pk_bf16_f32 v164, v168, v169
    v_cvt_pk_bf16_f32 v165, v170, v171
    v_mfma_f32_32x32x16_bf16 v[224:239], a[112:115], a[100:103], v[224:239]
    ds_read_b128 a[28:31], v35 offset:0
    v_cvt_pk_bf16_f32 v166, v172, v173
    v_cvt_pk_bf16_f32 v167, v174, v175
    v_cndmask_b32 v166, 0, v166, s[24:25]
    v_cndmask_b32 v167, 0, v167, s[24:25]
    v_cvt_pk_bf16_f32 v112, v112, v113
    v_mfma_f32_32x32x16_bf16 v[240:255], a[116:119], a[100:103], v[240:255]
    ds_read_b64_tr_b16 a[32:33], v36 offset:16384
    v_cvt_pk_bf16_f32 v113, v114, v115
    v_cvt_pk_bf16_f32 v114, v116, v117
    v_cvt_pk_bf16_f32 v115, v118, v119
    v_cvt_pk_bf16_f32 v116, v120, v121
    v_cvt_pk_bf16_f32 v117, v122, v123
    s_waitcnt lgkmcnt(7)
    v_mfma_f32_32x32x16_bf16 v[128:143], a[124:127], a[120:123], v[128:143]
    ds_read_b64_tr_b16 a[34:35], v36 offset:16896
    ds_read_b128 a[36:39], v12 offset:0
    ds_read_b128 a[40:43], v12 offset:8192
    v_cvt_pk_bf16_f32 v118, v124, v125
    v_cvt_pk_bf16_f32 v119, v126, v127
    v_mfma_f32_32x32x16_bf16 v[176:191], a[0:3], a[120:123], v[176:191]
    ds_read_b128 a[44:47], v12 offset:16384
    v_cndmask_b32 v118, 0, v118, s[24:25]
    v_cndmask_b32 v119, 0, v119, s[24:25]
    v_mfma_f32_32x32x16_bf16 v[64:79], v[160:163], v[144:147], 0
    v_mfma_f32_32x32x16_bf16 v[224:239], a[4:7], a[120:123], v[224:239]
    ds_read_b128 a[48:51], v24 offset:0
    v_mfma_f32_32x32x16_bf16 v[80:95], v[112:115], v[144:147], 0
    v_mfma_f32_32x32x16_bf16 v[240:255], a[8:11], a[120:123], v[240:255]
    ds_read_b64_tr_b16 a[52:53], v36 offset:18432
    v_mfma_f32_32x32x16_bf16 v[64:79], v[164:167], v[148:151], v[64:79]
    s_waitcnt lgkmcnt(7)
    v_mfma_f32_32x32x16_bf16 v[128:143], a[16:19], a[12:15], v[128:143]
    ds_read_b64_tr_b16 a[54:55], v36 offset:18944
    ds_read_b128 a[56:59], v13 offset:0
    ds_read_b128 a[60:63], v13 offset:8192
    v_mfma_f32_32x32x16_bf16 v[80:95], v[116:119], v[148:151], v[80:95]
    v_mfma_f32_32x32x16_bf16 v[176:191], a[20:23], a[12:15], v[176:191]
    ds_read_b128 a[64:67], v13 offset:16384
    buffer_store_dword v204, v47, s[56:59], s2 offen offset:512 sc1
    v_cvt_pk_bf16_f32 v192, v192, v193
    v_cvt_pk_bf16_f32 v193, v194, v195
    v_mfma_f32_32x32x16_bf16 v[224:239], a[24:27], a[12:15], v[224:239]
    ds_read_b128 a[68:71], v25 offset:0
    v_cvt_pk_bf16_f32 v194, v196, v197
    v_cvt_pk_bf16_f32 v195, v198, v199
    v_cvt_pk_bf16_f32 v196, v200, v201
    v_cvt_pk_bf16_f32 v197, v202, v203
    v_cvt_pk_bf16_f32 v198, v204, v205
    v_mfma_f32_32x32x16_bf16 v[240:255], a[28:31], a[12:15], v[240:255]
    ds_read_b64_tr_b16 a[72:73], v36 offset:20480
    v_cndmask_b32 v122, v92, v64, s[60:61]
    v_cndmask_b32 v123, v93, v65, s[62:63]
    v_cndmask_b32 v124, v94, v66, s[64:65]
    v_cndmask_b32 v125, v95, v67, s[66:67]
    v_cndmask_b32 v122, v122, v68, s[68:69]
    s_waitcnt lgkmcnt(7)
    v_mfma_f32_32x32x16_bf16 v[128:143], a[36:39], a[32:35], v[128:143]
    ds_read_b64_tr_b16 a[74:75], v36 offset:20992
    ds_read_b128 a[76:79], v14 offset:0
    ds_read_b128 a[80:83], v14 offset:8192
    v_cndmask_b32 v123, v123, v69, s[70:71]
    v_cndmask_b32 v124, v124, v70, s[72:73]
    v_mfma_f32_32x32x16_bf16 v[176:191], a[40:43], a[32:35], v[176:191]
    ds_read_b128 a[84:87], v14 offset:16384
    s_waitcnt vmcnt(12)
    ds_read_b64_tr_b16 a[192:193], v41 offset:0
    ds_read_b64_tr_b16 a[194:195], v41 offset:1024
    ds_read_b64_tr_b16 a[196:197], v42 offset:0
    ds_read_b64_tr_b16 a[198:199], v42 offset:1024
    v_cndmask_b32 v125, v125, v71, s[74:75]
    v_mfma_f32_32x32x16_bf16 v[224:239], a[44:47], a[32:35], v[224:239]
    s_waitcnt vmcnt(10)
    s_waitcnt lgkmcnt(7)
    ds_read_b64_tr_b16 a[200:201], v41 offset:2048
    ds_read_b64_tr_b16 a[202:203], v41 offset:3072
    ds_read_b64_tr_b16 a[204:205], v42 offset:2048
    ds_read_b64_tr_b16 a[206:207], v42 offset:3072
    v_cndmask_b32 v122, v122, v72, s[76:77]
    v_cndmask_b32 v123, v123, v73, s[78:79]
    v_mfma_f32_32x32x16_bf16 v[240:255], a[48:51], a[32:35], v[240:255]
    ds_read_b128 a[88:91], v26 offset:0
    ds_read_b64_tr_b16 a[92:93], v36 offset:22528
    s_waitcnt vmcnt(8)
    ds_read_b64_tr_b16 a[208:209], v41 offset:4096
    ds_read_b64_tr_b16 a[210:211], v41 offset:5120
    s_waitcnt lgkmcnt(7)
    ds_read_b64_tr_b16 a[212:213], v42 offset:4096
    ds_read_b64_tr_b16 a[214:215], v42 offset:5120
    v_mfma_f32_32x32x16_bf16 v[128:143], a[56:59], a[52:55], v[128:143]
    ds_read_b64_tr_b16 a[94:95], v36 offset:23040
    ds_read_b128 a[96:99], v15 offset:0
    ds_read_b128 a[100:103], v15 offset:8192
    v_cndmask_b32 v124, v124, v74, s[80:81]
    v_cndmask_b32 v125, v125, v75, s[82:83]
    v_cndmask_b32 v122, v122, v76, s[84:85]
    v_mfma_f32_32x32x16_bf16 v[176:191], a[60:63], a[52:55], v[176:191]
    ds_read_b128 a[104:107], v15 offset:16384
    s_add_u32 s95, s94, 3
    s_and_b32 s95, s95, 3
    s_sub_i32 s95, s97, s95
    s_add_i32 s35, s95, 7
    s_cmp_lt_i32 s95, 0
    s_cselect_b32 s95, s35, s95
    s_mul_i32 s95, s95, 57344
    s_add_u32 s95, s95, s32
    s_add_u32 m0, s34, 0
    s_add_u32 s35, s95, 0
    buffer_load_dwordx4 v40, s[48:51], s35 offen lds
    s_add_u32 m0, s34, 1024
    s_add_u32 s35, s95, 7168
    buffer_load_dwordx4 v40, s[48:51], s35 offen lds
    v_mfma_f32_32x32x16_bf16 v[224:239], a[64:67], a[52:55], v[224:239]
    v_cndmask_b32 v123, v123, v77, s[86:87]
    v_cndmask_b32 v124, v124, v78, s[88:89]
    v_cndmask_b32 v125, v125, v79, s[90:91]
    v_cvt_pk_bf16_f32 v62, v122, v123
    v_cvt_pk_bf16_f32 v63, v124, v125
    v_lshlrev_b32 v122, 16, v62
    v_mfma_f32_32x32x16_bf16 v[240:255], a[68:71], a[52:55], v[240:255]
    v_and_b32 v123, 0xffff0000, v62
    v_lshlrev_b32 v124, 16, v63
    v_and_b32 v125, 0xffff0000, v63
    v_mul_f32 v122, 0x3e41848f, v122
    v_mul_f32 v123, 0x3e41848f, v123
    v_mul_f32 v124, 0x3e41848f, v124
    v_mfma_f32_32x32x16_bf16 v[128:143], a[76:79], a[72:75], v[128:143]
    v_mul_f32 v125, 0x3e41848f, v125
    v_cvt_pk_bf16_f32 v62, v122, v123
    v_cvt_pk_bf16_f32 v63, v124, v125
    v_lshlrev_b32 v122, 16, v62
    v_and_b32 v123, 0xffff0000, v62
    v_lshlrev_b32 v124, 16, v63
    v_mfma_f32_32x32x16_bf16 v[176:191], a[80:83], a[72:75], v[176:191]
    v_and_b32 v125, 0xffff0000, v63
    v_max3_f32 v126, v122, v123, v124
    v_max_f32 v126, v126, v125
    v_mov_b32 v127, v126
    v_mfma_f32_32x32x16_bf16 v[224:239], a[84:87], a[72:75], v[224:239]
    s_nop 0
    v_permlane32_swap_b32 v126, v127
    v_max_f32 v126, v126, v127
    v_mul_f32 v126, v126, v50
    v_fma_f32 v122, v122, v50, -v126
    s_waitcnt lgkmcnt(0)
    v_mfma_f32_32x32x16_bf16 v[240:255], a[88:91], a[72:75], v[240:255]
    ds_read_b128 a[108:111], v27 offset:0
    s_add_u32 m0, s34, 2048
    s_add_u32 s35, s95, 14336
    buffer_load_dwordx4 v40, s[48:51], s35 offen lds
    s_add_u32 m0, s34, 3072
    s_add_u32 s35, s95, 21504
    buffer_load_dwordx4 v40, s[48:51], s35 offen lds
    v_mfma_f32_32x32x16_bf16 v[128:143], a[96:99], a[92:95], v[128:143]
    s_waitcnt vmcnt(10)
    ds_read_b64_tr_b16 a[216:217], v41 offset:6144
    ds_read_b64_tr_b16 a[218:219], v41 offset:7168
    ds_read_b64_tr_b16 a[220:221], v42 offset:6144
    ds_read_b64_tr_b16 a[222:223], v42 offset:7168
    v_fma_f32 v123, v123, v50, -v126
    v_fma_f32 v124, v124, v50, -v126
    v_mfma_f32_32x32x16_bf16 v[176:191], a[100:103], a[92:95], v[176:191]
    s_waitcnt vmcnt(8)
    ds_read_b64_tr_b16 a[224:225], v41 offset:8192
    ds_read_b64_tr_b16 a[226:227], v41 offset:9216
    ds_read_b64_tr_b16 a[228:229], v42 offset:8192
    ds_read_b64_tr_b16 a[230:231], v42 offset:9216
    v_fma_f32 v125, v125, v50, -v126
    v_mfma_f32_32x32x16_bf16 v[224:239], a[104:107], a[92:95], v[224:239]
    v_exp_f32 v122, v122
    v_exp_f32 v123, v123
    v_exp_f32 v124, v124
    s_waitcnt lgkmcnt(8)
    v_mfma_f32_32x32x16_bf16 v[240:255], a[108:111], a[92:95], v[240:255]
    s_waitcnt vmcnt(6)
    ds_read_b64_tr_b16 a[232:233], v41 offset:10240
    ds_read_b64_tr_b16 a[234:235], v41 offset:11264
    ds_read_b64_tr_b16 a[236:237], v42 offset:10240
    ds_read_b64_tr_b16 a[238:239], v42 offset:11264
    v_exp_f32 v125, v125
    v_add_f32 v126, v122, v123
    v_add_f32 v127, v124, v125
    v_add_f32 v126, v126, v127
    v_mov_b32 v127, v126
    s_nop 1
    v_permlane32_swap_b32 v126, v127
    v_add_f32 v126, v126, v127
    v_rcp_f32 v126, v126
    s_nop 0
    v_mul_f32 v122, v122, v126
    v_mul_f32 v123, v123, v126
    v_mul_f32 v124, v124, v126
    v_mul_f32 v125, v125, v126
    v_cvt_pk_bf16_f32 v62, v122, v123
    v_cvt_pk_bf16_f32 v63, v124, v125
    v_and_b32 v152, v62, v52
    v_and_b32 v153, v63, v53
    v_and_b32 v154, v62, v54
    v_and_b32 v155, v63, v55
    v_and_b32 v156, v62, v56
    v_and_b32 v157, v63, v57
    v_and_b32 v158, v62, v58
    v_and_b32 v159, v63, v59
    v_and_b32 v168, v62, v60
    v_and_b32 v169, v63, v61
    v_cvt_pk_bf16_f32 v199, v206, v207
    v_cvt_pk_bf16_f32 v208, v208, v209
    v_cvt_pk_bf16_f32 v209, v210, v211
    v_cvt_pk_bf16_f32 v210, v212, v213
    v_cvt_pk_bf16_f32 v211, v214, v215
    v_cvt_pk_bf16_f32 v212, v216, v217
    v_cvt_pk_bf16_f32 v213, v218, v219
    v_cvt_pk_bf16_f32 v214, v220, v221
    v_cvt_pk_bf16_f32 v215, v222, v223
    v_cndmask_b32 v214, 0, v214, s[24:25]
    v_cndmask_b32 v215, 0, v215, s[24:25]
    v_mfma_f32_32x32x16_bf16 v[64:79], v[208:211], v[192:195], 0
    v_mfma_f32_32x32x16_bf16 v[80:95], v[160:163], v[192:195], 0
    v_mfma_f32_32x32x16_bf16 v[64:79], v[212:215], v[196:199], v[64:79]
    v_mfma_f32_32x32x16_bf16 v[80:95], v[164:167], v[196:199], v[80:95]
    buffer_store_dword v108, v47, s[56:59], s2 offen sc1
    v_cvt_pk_bf16_f32 v96, v96, v97
    v_cvt_pk_bf16_f32 v97, v98, v99
    v_cvt_pk_bf16_f32 v98, v100, v101
    v_cvt_pk_bf16_f32 v99, v102, v103
    v_cvt_pk_bf16_f32 v100, v104, v105
    v_cvt_pk_bf16_f32 v101, v106, v107
    v_cvt_pk_bf16_f32 v102, v108, v109
    v_cvt_pk_bf16_f32 v103, v110, v111
    s_barrier
    ds_read_b128 a[128:131], v48 offset:0
    ds_read_b128 a[132:135], v48 offset:1024
    v_cndmask_b32 v122, v92, v64, s[60:61]
    v_cndmask_b32 v123, v93, v65, s[62:63]
    v_cndmask_b32 v124, v94, v66, s[64:65]
    v_cndmask_b32 v125, v95, v67, s[66:67]
    v_cndmask_b32 v122, v122, v68, s[68:69]
    v_cndmask_b32 v123, v123, v69, s[70:71]
    v_cndmask_b32 v124, v124, v70, s[72:73]
    v_cndmask_b32 v125, v125, v71, s[74:75]
    v_cndmask_b32 v122, v122, v72, s[76:77]
    v_cndmask_b32 v123, v123, v73, s[78:79]
    v_cndmask_b32 v124, v124, v74, s[80:81]
    v_cndmask_b32 v125, v125, v75, s[82:83]
    v_cndmask_b32 v122, v122, v76, s[84:85]
    v_cndmask_b32 v123, v123, v77, s[86:87]
    v_cndmask_b32 v124, v124, v78, s[88:89]
    v_cndmask_b32 v125, v125, v79, s[90:91]
    v_cvt_pk_bf16_f32 v62, v122, v123
    v_cvt_pk_bf16_f32 v63, v124, v125
    v_lshlrev_b32 v122, 16, v62
    v_and_b32 v123, 0xffff0000, v62
    v_lshlrev_b32 v124, 16, v63
    v_and_b32 v125, 0xffff0000, v63
    v_mul_f32 v122, 0x3e41848f, v122
    v_mul_f32 v123, 0x3e41848f, v123
    v_mul_f32 v124, 0x3e41848f, v124
    v_mul_f32 v125, 0x3e41848f, v125
    v_cvt_pk_bf16_f32 v62, v122, v123
    v_cvt_pk_bf16_f32 v63, v124, v125
    v_lshlrev_b32 v122, 16, v62
    v_and_b32 v123, 0xffff0000, v62
    v_lshlrev_b32 v124, 16, v63
    v_and_b32 v125, 0xffff0000, v63
    v_max3_f32 v126, v122, v123, v124
    v_max_f32 v126, v126, v125
    v_mov_b32 v127, v126
    s_nop 1
    v_permlane32_swap_b32 v126, v127
    v_max_f32 v126, v126, v127
    v_mul_f32 v126, v126, v50
    v_fma_f32 v122, v122, v50, -v126
    v_fma_f32 v123, v123, v50, -v126
    v_fma_f32 v124, v124, v50, -v126
    v_fma_f32 v125, v125, v50, -v126
    v_exp_f32 v122, v122
    v_exp_f32 v123, v123
    v_exp_f32 v124, v124
    v_exp_f32 v125, v125
    v_add_f32 v126, v122, v123
    v_add_f32 v127, v124, v125
    v_add_f32 v126, v126, v127
    v_mov_b32 v127, v126
    s_nop 1
    v_permlane32_swap_b32 v126, v127
    v_add_f32 v126, v126, v127
    v_rcp_f32 v126, v126
    s_nop 0
    v_mul_f32 v122, v122, v126
    v_mul_f32 v123, v123, v126
    v_mul_f32 v124, v124, v126
    v_mul_f32 v125, v125, v126
    v_cvt_pk_bf16_f32 v62, v122, v123
    v_cvt_pk_bf16_f32 v63, v124, v125
    v_and_b32 v200, v62, v52
    v_and_b32 v201, v63, v53
    v_and_b32 v202, v62, v54
    v_and_b32 v203, v63, v55
    v_and_b32 v204, v62, v56
    v_and_b32 v205, v63, v57
    v_and_b32 v206, v62, v58
    v_and_b32 v207, v63, v59
    v_and_b32 v216, v62, v60
    v_and_b32 v217, v63, v61
    s_waitcnt lgkmcnt(0)
    v_mfma_f32_32x32x16_bf16 v[64:79], v[112:115], v[96:99], 0
    v_mfma_f32_32x32x16_bf16 v[80:95], a[128:131], v[96:99], 0
    v_mfma_f32_32x32x16_bf16 v[64:79], v[116:119], v[100:103], v[64:79]
    v_mfma_f32_32x32x16_bf16 v[80:95], a[132:135], v[100:103], v[80:95]
    s_nop 11
    v_cndmask_b32 v88, v51, v88, s[26:27]
    v_cndmask_b32 v89, v51, v89, s[26:27]
    v_cndmask_b32 v90, v51, v90, s[26:27]
    v_cndmask_b32 v91, v51, v91, s[26:27]
    v_cndmask_b32 v122, v88, v64, s[60:61]
    v_cndmask_b32 v123, v89, v65, s[62:63]
    v_cndmask_b32 v124, v90, v66, s[64:65]
    v_cndmask_b32 v125, v91, v67, s[66:67]
    v_cndmask_b32 v122, v122, v68, s[68:69]
    v_cndmask_b32 v123, v123, v69, s[70:71]
    v_cndmask_b32 v124, v124, v70, s[72:73]
    v_cndmask_b32 v125, v125, v71, s[74:75]
    v_cndmask_b32 v122, v122, v72, s[76:77]
    v_cndmask_b32 v123, v123, v73, s[78:79]
    v_cndmask_b32 v124, v124, v74, s[80:81]
    v_cndmask_b32 v125, v125, v75, s[82:83]
    v_cndmask_b32 v122, v122, v76, s[84:85]
    v_cndmask_b32 v123, v123, v77, s[86:87]
    v_cndmask_b32 v124, v124, v78, s[88:89]
    v_cndmask_b32 v125, v125, v79, s[90:91]
    v_cvt_pk_bf16_f32 v62, v122, v123
    v_cvt_pk_bf16_f32 v63, v124, v125
    v_lshlrev_b32 v122, 16, v62
    v_and_b32 v123, 0xffff0000, v62
    v_lshlrev_b32 v124, 16, v63
    v_and_b32 v125, 0xffff0000, v63
    v_mul_f32 v122, 0x3e41848f, v122
    v_mul_f32 v123, 0x3e41848f, v123
    v_mul_f32 v124, 0x3e41848f, v124
    v_mul_f32 v125, 0x3e41848f, v125
    v_cvt_pk_bf16_f32 v62, v122, v123
    v_cvt_pk_bf16_f32 v63, v124, v125
    v_lshlrev_b32 v122, 16, v62
    v_and_b32 v123, 0xffff0000, v62
    v_lshlrev_b32 v124, 16, v63
    v_and_b32 v125, 0xffff0000, v63
    v_max3_f32 v126, v122, v123, v124
    v_max_f32 v126, v126, v125
    v_mov_b32 v127, v126
    s_nop 1
    v_permlane32_swap_b32 v126, v127
    v_max_f32 v126, v126, v127
    v_mul_f32 v126, v126, v50
    v_fma_f32 v122, v122, v50, -v126
    v_fma_f32 v123, v123, v50, -v126
    v_fma_f32 v124, v124, v50, -v126
    v_fma_f32 v125, v125, v50, -v126
    v_exp_f32 v122, v122
    v_exp_f32 v123, v123
    v_exp_f32 v124, v124
    v_exp_f32 v125, v125
    v_add_f32 v126, v122, v123
    v_add_f32 v127, v124, v125
    v_add_f32 v126, v126, v127
    v_mov_b32 v127, v126
    s_nop 1
    v_permlane32_swap_b32 v126, v127
    v_add_f32 v126, v126, v127
    v_rcp_f32 v126, v126
    s_nop 0
    v_mul_f32 v122, v122, v126
    v_mul_f32 v123, v123, v126
    v_mul_f32 v124, v124, v126
    v_mul_f32 v125, v125, v126
    v_cvt_pk_bf16_f32 v62, v122, v123
    v_cvt_pk_bf16_f32 v63, v124, v125
    v_and_b32 v104, v62, v52
    v_and_b32 v105, v63, v53
    v_and_b32 v106, v62, v54
    v_and_b32 v107, v63, v55
    v_and_b32 v108, v62, v56
    v_and_b32 v109, v63, v57
    v_and_b32 v110, v62, v58
    v_and_b32 v111, v63, v59
    v_and_b32 v120, v62, v60
    v_and_b32 v121, v63, v61
    v_cvt_pk_bf16_f32 v240, v240, v241
    v_cvt_pk_bf16_f32 v241, v242, v243
    v_cvt_pk_bf16_f32 v242, v244, v245
    v_cvt_pk_bf16_f32 v243, v246, v247
    v_cvt_pk_bf16_f32 v244, v248, v249
    v_cvt_pk_bf16_f32 v245, v250, v251
    v_cvt_pk_bf16_f32 v246, v252, v253
    v_cvt_pk_bf16_f32 v247, v254, v255
    ds_write_b64 v49, v[246:247] offset:0
    v_cvt_pk_bf16_f32 v176, v176, v177
    v_cvt_pk_bf16_f32 v177, v178, v179
    v_cvt_pk_bf16_f32 v178, v180, v181
    v_cvt_pk_bf16_f32 v179, v182, v183
    v_cvt_pk_bf16_f32 v180, v184, v185
    v_cvt_pk_bf16_f32 v181, v186, v187
    v_cvt_pk_bf16_f32 v182, v188, v189
    v_cvt_pk_bf16_f32 v183, v190, v191
    v_cvt_pk_bf16_f32 v128, v128, v129
    v_cvt_pk_bf16_f32 v129, v130, v131
    v_cvt_pk_bf16_f32 v130, v132, v133
    v_cvt_pk_bf16_f32 v131, v134, v135
    v_cvt_pk_bf16_f32 v132, v136, v137
    v_cvt_pk_bf16_f32 v133, v138, v139
    v_cvt_pk_bf16_f32 v134, v140, v141
    v_cvt_pk_bf16_f32 v135, v142, v143
    v_mfma_f32_32x32x16_bf16 v[64:79], v[176:179], v[152:155], 0
    v_mfma_f32_32x32x16_bf16 v[64:79], v[180:183], v[156:159], v[64:79]
    v_mfma_f32_32x32x8_bf16 v[64:79], v[134:135], v[168:169], v[64:79]
    s_waitcnt lgkmcnt(0)
    s_barrier
    v_cvt_pk_bf16_f32 v224, v224, v225
    v_cvt_pk_bf16_f32 v225, v226, v227
    v_cvt_pk_bf16_f32 v226, v228, v229
    v_cvt_pk_bf16_f32 v227, v230, v231
    v_cvt_pk_bf16_f32 v228, v232, v233
    v_cvt_pk_bf16_f32 v229, v234, v235
    v_cvt_pk_bf16_f32 v230, v236, v237
    v_cvt_pk_bf16_f32 v231, v238, v239
    v_mfma_f32_32x32x16_bf16 v[80:95], v[224:227], v[200:203], 0
    s_nop 0
    v_mfma_f32_32x32x16_bf16 v[80:95], v[228:231], v[204:207], v[80:95]
    v_mfma_f32_32x32x8_bf16 v[80:95], v[182:183], v[216:217], v[80:95]
    v_cvt_pk_bf16_f32 v64, v64, v65
    v_cvt_pk_bf16_f32 v65, v66, v67
    v_cvt_pk_bf16_f32 v66, v68, v69
    v_cvt_pk_bf16_f32 v67, v70, v71
    v_cvt_pk_bf16_f32 v68, v72, v73
    v_cvt_pk_bf16_f32 v69, v74, v75
    v_cvt_pk_bf16_f32 v70, v76, v77
    v_cvt_pk_bf16_f32 v71, v78, v79
    v_cndmask_b32 v70, 0, v70, s[24:25]
    v_cndmask_b32 v71, 0, v71, s[24:25]
    s_add_u32 s6, s11, 294912
    buffer_store_dwordx4 v[64:67], v11, s[52:55], s6 offen sc1
    buffer_store_dwordx4 v[68:71], v11, s[52:55], s6 offen offset:1024 sc1
    v_mfma_f32_32x32x16_bf16 v[208:223], v[128:131], v[104:107], 0
    v_mfma_f32_32x32x16_bf16 v[208:223], v[132:135], v[108:111], v[208:223]
    v_mfma_f32_32x32x8_bf16 v[208:223], v[244:245], v[120:121], v[208:223]
    v_cvt_pk_bf16_f32 v80, v80, v81
    v_cvt_pk_bf16_f32 v81, v82, v83
    v_cvt_pk_bf16_f32 v82, v84, v85
    v_cvt_pk_bf16_f32 v83, v86, v87
    v_cvt_pk_bf16_f32 v84, v88, v89
    v_cvt_pk_bf16_f32 v85, v90, v91
    v_cvt_pk_bf16_f32 v86, v92, v93
    v_cvt_pk_bf16_f32 v87, v94, v95
    v_cndmask_b32 v86, 0, v86, s[24:25]
    v_cndmask_b32 v87, 0, v87, s[24:25]
    s_add_u32 s6, s11, 589824
    buffer_store_dwordx4 v[80:83], v11, s[52:55], s6 offen sc1
    buffer_store_dwordx4 v[84:87], v11, s[52:55], s6 offen offset:1024 sc1
    v_cvt_pk_bf16_f32 v208, v208, v209
    v_cvt_pk_bf16_f32 v209, v210, v211
    v_cvt_pk_bf16_f32 v210, v212, v213
    v_cvt_pk_bf16_f32 v211, v214, v215
    v_cvt_pk_bf16_f32 v212, v216, v217
    v_cvt_pk_bf16_f32 v213, v218, v219
    v_cvt_pk_bf16_f32 v214, v220, v221
    v_cvt_pk_bf16_f32 v215, v222, v223
    v_cndmask_b32 v214, 0, v214, s[24:25]
    v_cndmask_b32 v215, 0, v215, s[24:25]
    s_add_u32 s6, s11, 0
    buffer_store_dwordx4 v[208:211], v11, s[52:55], s6 offen sc1
    buffer_store_dwordx4 v[212:215], v11, s[52:55], s6 offen offset:1024 sc1
    s_waitcnt vmcnt(9)
    ds_read_b64_tr_b16 a[240:241], v41 offset:0
    ds_read_b64_tr_b16 a[242:243], v41 offset:1024
    ds_read_b64_tr_b16 a[244:245], v42 offset:0
    ds_read_b64_tr_b16 a[246:247], v42 offset:1024
    s_waitcnt vmcnt(7)
    ds_read_b64_tr_b16 a[248:249], v41 offset:2048
    ds_read_b64_tr_b16 a[250:251], v41 offset:3072
    ds_read_b64_tr_b16 a[252:253], v42 offset:2048
    ds_read_b64_tr_b16 a[254:255], v42 offset:3072
gated_mix__sliding_local_dilated__glu_gated_glu__prompt_kernel_p2:
    s_nop 1
    s_load_dwordx2 s[20:21], s[0:1], 16
    s_load_dwordx2 s[28:29], s[0:1], 48
    s_load_dwordx4 s[24:27], s[0:1], 64
    s_and_b32 s5, s96, 7
    s_lshr_b32 s8, s96, 3
    s_sub_u32 s6, s8, 0
    s_cmp_lt_u32 s6, 4
    s_cselect_b32 s11, -1, 0
    s_sub_u32 s6, s8, 4
    s_cmp_ge_u32 s8, 0
    s_cselect_b32 s8, s6, s8
    s_max_i32 s8, s8, 0
    s_mul_i32 s7, s8, 37
    s_lshr_b32 s7, s7, 8
    s_mul_i32 s6, s7, 7
    s_sub_u32 s8, s8, s6
    s_lshl_b32 s5, s5, 2
    s_add_u32 s7, s7, s5
    s_add_u32 s12, s36, 9445376
    s_addc_u32 s13, s37, 0
    s_mov_b32 s14, 16384
    s_mov_b32 s15, 0x00020000
    s_lshl_b32 s30, s7, 1
    v_add_u32 v4, s30, v3
    v_mul_u32_u24 v5, 94, v4
    v_lshrrev_b32 v5, 10, v5
    v_mul_u32_u24 v6, 11, v5
    v_sub_u32 v4, v4, v6
    s_lshl_b32 s6, s3, 3
    v_add_u32 v5, s6, v5
    v_lshlrev_b32 v5, 8, v5
    v_lshl_add_u32 v22, v2, 3, v5
    buffer_load_dwordx2 v[24:25], v22, s[12:15], 0 offen sc1
    v_lshrrev_b32 v5, 2, v2
    v_mul_u32_u24 v6, 3, v5
    v_add_u32 v6, 1, v6
    v_lshrrev_b32 v6, 1, v6
    v_sub_u32 v4, v4, v6
    v_add_u32 v6, 11, v4
    v_min_u32 v4, v4, v6
    v_cmp_lt_u32 vcc, 5, v4
    s_nop 1
    v_cndmask_b32 v28, 1, 2, vcc
    v_cmp_lt_u32 vcc, 6, v4
    s_nop 1
    v_cndmask_b32 v28, v28, 3, vcc
    v_sub_u32 v29, 4, v28
    v_mov_b32 v30, 3
    v_mov_b32 v31, 1
    v_sub_u32 v4, s97, v5
    v_add_u32 v6, 7, v4
    v_min_u32 v4, v4, v6
    v_cmp_eq_u32 vcc, 7, v5
    s_nop 1
    v_cndmask_b32 v4, v4, 15, vcc
    v_cmp_gt_u32 s[68:69], 3, v4
    v_cmp_eq_u32 s[70:71], 3, v4
    v_cmp_eq_u32 s[72:73], 4, v4
    v_cmp_eq_u32 s[74:75], 5, v4
    v_cmp_eq_u32 s[76:77], 6, v4
    s_add_u32 s60, s94, 0
    s_and_b32 s60, s60, 3
    s_sub_i32 s60, s97, s60
    s_add_i32 s6, s60, 7
    s_cmp_lt_i32 s60, 0
    s_cselect_b32 s60, s6, s60
    s_lshl_b32 s60, s60, 12
    s_add_u32 s61, s94, 1
    s_and_b32 s61, s61, 3
    s_sub_i32 s61, s97, s61
    s_add_i32 s6, s61, 7
    s_cmp_lt_i32 s61, 0
    s_cselect_b32 s61, s6, s61
    s_lshl_b32 s61, s61, 12
    s_add_u32 s62, s94, 2
    s_and_b32 s62, s62, 3
    s_sub_i32 s62, s97, s62
    s_add_i32 s6, s62, 7
    s_cmp_lt_i32 s62, 0
    s_cselect_b32 s62, s6, s62
    s_lshl_b32 s62, s62, 12
    s_add_u32 s63, s94, 3
    s_and_b32 s63, s63, 3
    s_sub_i32 s63, s97, s63
    s_add_i32 s6, s63, 7
    s_cmp_lt_i32 s63, 0
    s_cselect_b32 s63, s6, s63
    s_lshl_b32 s63, s63, 12
    s_sub_i32 s64, s97, 4
    s_add_i32 s6, s64, 7
    s_cmp_lt_i32 s64, 0
    s_cselect_b32 s64, s6, s64
    s_lshl_b32 s64, s64, 12
    s_sub_i32 s65, s97, 5
    s_add_i32 s6, s65, 7
    s_cmp_lt_i32 s65, 0
    s_cselect_b32 s65, s6, s65
    s_lshl_b32 s65, s65, 12
    s_sub_i32 s66, s97, 6
    s_add_i32 s6, s66, 7
    s_cmp_lt_i32 s66, 0
    s_cselect_b32 s66, s6, s66
    s_lshl_b32 s66, s66, 12
    s_waitcnt lgkmcnt(0)
    s_mov_b32 s16, s26
    s_mov_b32 s17, s27
    s_mov_b32 s18, 256
    s_mov_b32 s19, 0x00020000
    v_mov_b32 v7, 0
    buffer_load_dwordx2 v[26:27], v7, s[16:19], 0 offen sc1
    v_lshrrev_b32 v4, 3, v1
    v_bfe_u32 v5, v1, 4, 1
    v_lshlrev_b32 v5, 2, v5
    v_and_b32 v6, 7, v1
    v_xor_b32 v5, v5, v6
    v_mul_u32_u24 v4, 896, v4
    v_lshl_add_u32 v8, v5, 4, v4
    s_barrier
    v_lshlrev_b32 v9, 4, v1
    s_mul_i32 s9, s3, 40960
    s_mov_b32 s44, s28
    s_mov_b32 s45, s29
    s_mov_b32 s46, 1605632
    s_mov_b32 s47, 0x00020000
    s_cmp_lt_i32 s11, 0
    s_cselect_b32 s46, 0, 1605632
    s_add_u32 m0, s9, 0
    s_mul_i32 s35, s63, 14
    s_add_u32 s35, s35, s32
    s_add_u32 s35, s35, 28672
    buffer_load_dwordx4 v8, s[44:47], s35 offen lds
    s_add_u32 m0, s9, 1024
    s_mul_i32 s35, s63, 14
    s_add_u32 s35, s35, s32
    s_add_u32 s35, s35, 35840
    buffer_load_dwordx4 v8, s[44:47], s35 offen lds
    s_add_u32 m0, s9, 2048
    s_mul_i32 s35, s63, 14
    s_add_u32 s35, s35, s32
    s_add_u32 s35, s35, 43008
    buffer_load_dwordx4 v8, s[44:47], s35 offen lds
    s_add_u32 m0, s9, 3072
    s_mul_i32 s35, s63, 14
    s_add_u32 s35, s35, s32
    s_add_u32 s35, s35, 50176
    buffer_load_dwordx4 v8, s[44:47], s35 offen lds
    s_add_u32 m0, s9, 4096
    s_mul_i32 s35, s64, 14
    s_add_u32 s35, s35, s32
    buffer_load_dwordx4 v8, s[44:47], s35 offen lds
    s_add_u32 m0, s9, 5120
    s_mul_i32 s35, s64, 14
    s_add_u32 s35, s35, s32
    s_add_u32 s35, s35, 7168
    buffer_load_dwordx4 v8, s[44:47], s35 offen lds
    s_add_u32 m0, s9, 6144
    s_mul_i32 s35, s64, 14
    s_add_u32 s35, s35, s32
    s_add_u32 s35, s35, 14336
    buffer_load_dwordx4 v8, s[44:47], s35 offen lds
    s_add_u32 m0, s9, 7168
    s_mul_i32 s35, s64, 14
    s_add_u32 s35, s35, s32
    s_add_u32 s35, s35, 21504
    buffer_load_dwordx4 v8, s[44:47], s35 offen lds
    s_mov_b32 s48, s36
    s_mov_b32 s49, s37
    s_mov_b32 s50, 9437184
    s_mov_b32 s51, 0x00020000
    s_mul_i32 s4, s7, 294912
    s_mul_i32 s6, s3, 28672
    s_add_u32 s5, s4, s6
    s_add_u32 s5, s5, 32768
    s_lshl_b32 s6, s3, 13
    s_add_u32 s4, s4, s6
    v_mov_b32 v5, s33
    v_mov_b32 v4, 0x7fffff00
    v_cmp_eq_u32 vcc, 0, v1
    s_nop 1
    v_cndmask_b32 v5, v4, v5, vcc
    s_waitcnt vmcnt(8)
    s_mov_b32 s6, 262144
gated_mix__sliding_local_dilated__glu_gated_glu__prompt_kernel_np:
    v_cmp_ne_u64 vcc, 0, v[26:27]
    s_nop 1
    s_cbranch_vccnz gated_mix__sliding_local_dilated__glu_gated_glu__prompt_kernel_nok
    buffer_load_dwordx2 v[26:27], v7, s[16:19], 0 offen sc1
    s_waitcnt vmcnt(0)
    s_sub_u32 s6, s6, 1
    s_cmp_lg_u32 s6, 0
    s_cbranch_scc1 gated_mix__sliding_local_dilated__glu_gated_glu__prompt_kernel_np
gated_mix__sliding_local_dilated__glu_gated_glu__prompt_kernel_nok:
    v_or_b32 v32, 3, v26
    v_mov_b32 v33, v27
    buffer_store_dwordx2 v[32:33], v5, s[12:15], 0 offen sc1
    s_cmp_lt_i32 s11, 0
    s_cbranch_scc1 gated_mix__sliding_local_dilated__glu_gated_glu__prompt_kernel_fin
    v_readfirstlane_b32 s22, v26
    v_readfirstlane_b32 s23, v27
    s_nop 1
    v_xor_b32 v4, s22, v24
    v_sub_u32 v4, v4, v28
    v_cmp_lt_u32 vcc, v4, v29
    v_cmp_eq_u32 s[88:89], s23, v25
    s_nop 1
    s_and_b64 vcc, vcc, s[88:89]
    s_and_b64 vcc, vcc, s[68:69]
    s_cmp_eq_u64 vcc, s[68:69]
    s_cbranch_scc1 gated_mix__sliding_local_dilated__glu_gated_glu__prompt_kernel_pg_ok
    s_mov_b32 s6, 262144
gated_mix__sliding_local_dilated__glu_gated_glu__prompt_kernel_pg:
    s_sleep 1
    buffer_load_dwordx2 v[24:25], v22, s[12:15], 0 offen sc1
    s_waitcnt vmcnt(0)
    v_xor_b32 v4, s22, v24
    v_sub_u32 v4, v4, v28
    v_cmp_lt_u32 vcc, v4, v29
    v_cmp_eq_u32 s[88:89], s23, v25
    s_nop 1
    s_and_b64 vcc, vcc, s[88:89]
    s_and_b64 vcc, vcc, s[68:69]
    s_cmp_eq_u64 vcc, s[68:69]
    s_cbranch_scc1 gated_mix__sliding_local_dilated__glu_gated_glu__prompt_kernel_pg_ok
    s_sub_u32 s6, s6, 1
    s_cmp_lg_u32 s6, 0
    s_cbranch_scc1 gated_mix__sliding_local_dilated__glu_gated_glu__prompt_kernel_pg
gated_mix__sliding_local_dilated__glu_gated_glu__prompt_kernel_pg_ok:
    s_add_u32 s35, s5, s60
    buffer_load_dwordx4 a[0:3], v9, s[48:51], s35 offen sc1
    s_add_u32 s35, s5, s60
    s_add_u32 s35, s35, 147456
    buffer_load_dwordx4 a[4:7], v9, s[48:51], s35 offen sc1
    s_add_u32 s35, s5, s60
    s_add_u32 s35, s35, 1024
    buffer_load_dwordx4 a[8:11], v9, s[48:51], s35 offen sc1
    s_add_u32 s35, s5, s60
    s_add_u32 s35, s35, 148480
    buffer_load_dwordx4 a[12:15], v9, s[48:51], s35 offen sc1
    s_add_u32 s35, s5, s60
    s_add_u32 s35, s35, 2048
    buffer_load_dwordx4 a[16:19], v9, s[48:51], s35 offen sc1
    s_add_u32 s35, s5, s60
    s_add_u32 s35, s35, 149504
    buffer_load_dwordx4 a[20:23], v9, s[48:51], s35 offen sc1
    s_add_u32 s35, s5, s60
    s_add_u32 s35, s35, 3072
    buffer_load_dwordx4 a[24:27], v9, s[48:51], s35 offen sc1
    s_add_u32 s35, s5, s60
    s_add_u32 s35, s35, 150528
    buffer_load_dwordx4 a[28:31], v9, s[48:51], s35 offen sc1
    s_add_u32 s35, s5, s61
    buffer_load_dwordx4 a[32:35], v9, s[48:51], s35 offen sc1
    s_add_u32 s35, s5, s61
    s_add_u32 s35, s35, 147456
    buffer_load_dwordx4 a[36:39], v9, s[48:51], s35 offen sc1
    s_add_u32 s35, s5, s61
    s_add_u32 s35, s35, 1024
    buffer_load_dwordx4 a[40:43], v9, s[48:51], s35 offen sc1
    s_add_u32 s35, s5, s61
    s_add_u32 s35, s35, 148480
    buffer_load_dwordx4 a[44:47], v9, s[48:51], s35 offen sc1
    s_mul_i32 s30, s7, 43
    s_lshr_b32 s30, s30, 7
    s_lshl_b32 s30, s30, 5
    s_add_u32 s30, s30, 8192
    s_lshl_b32 s6, s3, 1
    v_lshrrev_b32 v4, 2, v1
    v_add_u32 v4, s6, v4
    v_cmp_gt_u32 vcc, 8, v1
    s_nop 1
    v_cndmask_b32 v4, 0, v4, vcc
    v_lshlrev_b32 v4, 9, v4
    v_and_b32 v5, 3, v1
    v_lshl_add_u32 v4, v5, 3, v4
    v_add_u32 v23, s30, v4
    s_mov_b32 s40, s20
    s_mov_b32 s41, s21
    s_mov_b32 s42, 401408
    s_mov_b32 s43, 0x00020000
    s_mov_b32 s56, s24
    s_mov_b32 s57, s25
    s_mov_b32 s58, 1835008
    s_mov_b32 s59, 0x00020000
    s_add_u32 s52, s36, 9437184
    s_addc_u32 s53, s37, 0
    s_mov_b32 s54, 8192
    s_mov_b32 s55, 0x00020000
    s_lshl_b32 s6, s8, 7
    s_mul_i32 s10, s3, 100352
    s_add_u32 s10, s10, s6
    v_bfe_u32 v4, v1, 4, 1
    v_lshlrev_b32 v4, 5, v4
    v_and_b32 v5, 3, v1
    v_lshl_add_u32 v4, v5, 3, v4
    v_bfe_u32 v5, v1, 3, 1
    v_lshl_add_u32 v4, v5, 6, v4
    v_bfe_u32 v5, v1, 2, 2
    v_lshl_add_u32 v5, v3, 2, v5
    v_lshl_add_u32 v4, v5, 7, v4
    v_add_u32 v10, s9, v4
    v_xor_b32 v11, 64, v10
    v_add_u32 v18, s9, v9
    s_lshl_b32 s6, s3, 12
    v_add_u32 v19, s6, v9
    v_add_u32 v20, 81920, v19
    s_lshr_b32 s2, s3, 1
    s_lshl_b32 s6, s7, 6
    s_add_u32 s2, s2, s6
    s_mul_i32 s2, s2, 896
    s_lshl_b32 s6, s8, 7
    s_add_u32 s2, s2, s6
    s_and_b32 s6, s3, 1
    s_lshl_b32 s6, s6, 6
    s_add_u32 s2, s2, s6
    v_mul_u32_u24 v21, 1792, v2
    v_lshl_add_u32 v21, v3, 4, v21
    s_mov_b32 s94, 0xfff
    s_mov_b32 s95, 0
    s_add_u32 s35, s5, s61
    s_add_u32 s35, s35, 2048
    buffer_load_dwordx4 a[48:51], v9, s[48:51], s35 offen sc1
    s_waitcnt vmcnt(11)
    v_mfma_f32_32x32x16_bf16 v[96:111], a[144:147], a[0:3], 0
    s_add_u32 s35, s5, s61
    s_add_u32 s35, s35, 149504
    buffer_load_dwordx4 a[52:55], v9, s[48:51], s35 offen sc1
    v_mfma_f32_32x32x16_bf16 v[112:127], a[148:151], a[0:3], 0
    s_add_u32 s35, s5, s61
    s_add_u32 s35, s35, 3072
    buffer_load_dwordx4 a[56:59], v9, s[48:51], s35 offen sc1
    v_mfma_f32_32x32x16_bf16 v[128:143], a[144:147], a[4:7], 0
    s_add_u32 s35, s5, s61
    s_add_u32 s35, s35, 150528
    buffer_load_dwordx4 a[60:63], v9, s[48:51], s35 offen sc1
    v_mfma_f32_32x32x16_bf16 v[144:159], a[148:151], a[4:7], 0
    s_add_u32 s35, s5, s62
    buffer_load_dwordx4 a[64:67], v9, s[48:51], s35 offen sc1
    s_waitcnt vmcnt(13)
    v_mfma_f32_32x32x16_bf16 v[96:111], a[152:155], a[8:11], v[96:111]
    s_add_u32 s35, s5, s62
    s_add_u32 s35, s35, 147456
    buffer_load_dwordx4 a[68:71], v9, s[48:51], s35 offen sc1
    v_mfma_f32_32x32x16_bf16 v[112:127], a[156:159], a[8:11], v[112:127]
    s_add_u32 s35, s5, s62
    s_add_u32 s35, s35, 1024
    buffer_load_dwordx4 a[72:75], v9, s[48:51], s35 offen sc1
    v_mfma_f32_32x32x16_bf16 v[128:143], a[152:155], a[12:15], v[128:143]
    s_add_u32 s35, s5, s62
    s_add_u32 s35, s35, 148480
    buffer_load_dwordx4 a[76:79], v9, s[48:51], s35 offen sc1
    v_mfma_f32_32x32x16_bf16 v[144:159], a[156:159], a[12:15], v[144:159]
    s_add_u32 s35, s5, s62
    s_add_u32 s35, s35, 2048
    buffer_load_dwordx4 a[80:83], v9, s[48:51], s35 offen sc1
    s_waitcnt vmcnt(15)
    v_mfma_f32_32x32x16_bf16 v[96:111], a[160:163], a[16:19], v[96:111]
    s_add_u32 s35, s5, s62
    s_add_u32 s35, s35, 149504
    buffer_load_dwordx4 a[84:87], v9, s[48:51], s35 offen sc1
    v_mfma_f32_32x32x16_bf16 v[112:127], a[164:167], a[16:19], v[112:127]
    s_add_u32 s35, s5, s62
    s_add_u32 s35, s35, 3072
    buffer_load_dwordx4 a[88:91], v9, s[48:51], s35 offen sc1
    v_mfma_f32_32x32x16_bf16 v[128:143], a[160:163], a[20:23], v[128:143]
    s_add_u32 s35, s5, s62
    s_add_u32 s35, s35, 150528
    buffer_load_dwordx4 a[92:95], v9, s[48:51], s35 offen sc1
    v_mfma_f32_32x32x16_bf16 v[144:159], a[164:167], a[20:23], v[144:159]
    buffer_load_dwordx2 v[24:25], v22, s[12:15], 0 offen sc1
    s_waitcnt vmcnt(17)
    v_mfma_f32_32x32x16_bf16 v[96:111], a[168:171], a[24:27], v[96:111]
    v_mfma_f32_32x32x16_bf16 v[112:127], a[172:175], a[24:27], v[112:127]
    v_mfma_f32_32x32x16_bf16 v[128:143], a[168:171], a[28:31], v[128:143]
    v_mfma_f32_32x32x16_bf16 v[144:159], a[172:175], a[28:31], v[144:159]
    s_waitcnt vmcnt(15)
    v_mfma_f32_32x32x16_bf16 v[96:111], a[176:179], a[32:35], v[96:111]
    v_mfma_f32_32x32x16_bf16 v[112:127], a[180:183], a[32:35], v[112:127]
    v_mfma_f32_32x32x16_bf16 v[128:143], a[176:179], a[36:39], v[128:143]
    v_mfma_f32_32x32x16_bf16 v[144:159], a[180:183], a[36:39], v[144:159]
    s_waitcnt vmcnt(0)
    v_xor_b32 v4, s22, v24
    v_sub_u32 v4, v4, v28
    v_cmp_lt_u32 vcc, v4, v29
    v_cmp_eq_u32 s[88:89], s23, v25
    s_nop 1
    s_and_b64 vcc, vcc, s[88:89]
    s_and_b64 vcc, vcc, s[70:71]
    s_cmp_eq_u64 vcc, s[70:71]
    s_cbranch_scc1 gated_mix__sliding_local_dilated__glu_gated_glu__prompt_kernel_ps1_ok
    s_mov_b32 s6, 262144
gated_mix__sliding_local_dilated__glu_gated_glu__prompt_kernel_ps1:
    s_sleep 1
    buffer_load_dwordx2 v[24:25], v22, s[12:15], 0 offen sc1
    s_waitcnt vmcnt(0)
    v_xor_b32 v4, s22, v24
    v_sub_u32 v4, v4, v28
    v_cmp_lt_u32 vcc, v4, v29
    v_cmp_eq_u32 s[88:89], s23, v25
    s_nop 1
    s_and_b64 vcc, vcc, s[88:89]
    s_and_b64 vcc, vcc, s[70:71]
    s_cmp_eq_u64 vcc, s[70:71]
    s_cbranch_scc1 gated_mix__sliding_local_dilated__glu_gated_glu__prompt_kernel_ps1_ok
    s_sub_u32 s6, s6, 1
    s_cmp_lg_u32 s6, 0
    s_cbranch_scc1 gated_mix__sliding_local_dilated__glu_gated_glu__prompt_kernel_ps1
gated_mix__sliding_local_dilated__glu_gated_glu__prompt_kernel_ps1_ok:
    s_add_u32 s35, s5, s63
    buffer_load_dwordx4 a[0:3], v9, s[48:51], s35 offen sc1
    v_mfma_f32_32x32x16_bf16 v[96:111], a[184:187], a[40:43], v[96:111]
    s_add_u32 s35, s5, s63
    s_add_u32 s35, s35, 147456
    buffer_load_dwordx4 a[4:7], v9, s[48:51], s35 offen sc1
    v_mfma_f32_32x32x16_bf16 v[112:127], a[188:191], a[40:43], v[112:127]
    s_add_u32 s35, s5, s63
    s_add_u32 s35, s35, 1024
    buffer_load_dwordx4 a[8:11], v9, s[48:51], s35 offen sc1
    v_mfma_f32_32x32x16_bf16 v[128:143], a[184:187], a[44:47], v[128:143]
    s_add_u32 s35, s5, s63
    s_add_u32 s35, s35, 148480
    buffer_load_dwordx4 a[12:15], v9, s[48:51], s35 offen sc1
    v_mfma_f32_32x32x16_bf16 v[144:159], a[188:191], a[44:47], v[144:159]
    s_add_u32 s35, s5, s63
    s_add_u32 s35, s35, 2048
    buffer_load_dwordx4 a[16:19], v9, s[48:51], s35 offen sc1
    v_mfma_f32_32x32x16_bf16 v[96:111], a[192:195], a[48:51], v[96:111]
    s_add_u32 s35, s5, s63
    s_add_u32 s35, s35, 149504
    buffer_load_dwordx4 a[20:23], v9, s[48:51], s35 offen sc1
    v_mfma_f32_32x32x16_bf16 v[112:127], a[196:199], a[48:51], v[112:127]
    s_add_u32 s35, s5, s63
    s_add_u32 s35, s35, 3072
    buffer_load_dwordx4 a[24:27], v9, s[48:51], s35 offen sc1
    v_mfma_f32_32x32x16_bf16 v[128:143], a[192:195], a[52:55], v[128:143]
    s_add_u32 s35, s5, s63
    s_add_u32 s35, s35, 150528
    buffer_load_dwordx4 a[28:31], v9, s[48:51], s35 offen sc1
    v_mfma_f32_32x32x16_bf16 v[144:159], a[196:199], a[52:55], v[144:159]
    buffer_load_dwordx2 v[24:25], v22, s[12:15], 0 offen sc1
    v_mfma_f32_32x32x16_bf16 v[96:111], a[200:203], a[56:59], v[96:111]
    v_mfma_f32_32x32x16_bf16 v[112:127], a[204:207], a[56:59], v[112:127]
    v_mfma_f32_32x32x16_bf16 v[128:143], a[200:203], a[60:63], v[128:143]
    v_mfma_f32_32x32x16_bf16 v[144:159], a[204:207], a[60:63], v[144:159]
    s_add_u32 m0, s9, 8192
    s_mul_i32 s35, s64, 14
    s_add_u32 s35, s35, s32
    s_add_u32 s35, s35, 28672
    buffer_load_dwordx4 v8, s[44:47], s35 offen lds
    v_mfma_f32_32x32x16_bf16 v[96:111], a[208:211], a[64:67], v[96:111]
    s_add_u32 m0, s9, 9216
    s_mul_i32 s35, s64, 14
    s_add_u32 s35, s35, s32
    s_add_u32 s35, s35, 35840
    buffer_load_dwordx4 v8, s[44:47], s35 offen lds
    v_mfma_f32_32x32x16_bf16 v[112:127], a[212:215], a[64:67], v[112:127]
    v_mfma_f32_32x32x16_bf16 v[128:143], a[208:211], a[68:71], v[128:143]
    v_mfma_f32_32x32x16_bf16 v[144:159], a[212:215], a[68:71], v[144:159]
    s_waitcnt vmcnt(2)
    v_xor_b32 v4, s22, v24
    v_sub_u32 v4, v4, v28
    v_cmp_lt_u32 vcc, v4, v29
    v_cmp_eq_u32 s[88:89], s23, v25
    s_nop 1
    s_and_b64 vcc, vcc, s[88:89]
    s_and_b64 vcc, vcc, s[72:73]
    s_cmp_eq_u64 vcc, s[72:73]
    s_cbranch_scc1 gated_mix__sliding_local_dilated__glu_gated_glu__prompt_kernel_ps2_ok
    s_mov_b32 s6, 262144
gated_mix__sliding_local_dilated__glu_gated_glu__prompt_kernel_ps2:
    s_sleep 1
    buffer_load_dwordx2 v[24:25], v22, s[12:15], 0 offen sc1
    s_waitcnt vmcnt(0)
    v_xor_b32 v4, s22, v24
    v_sub_u32 v4, v4, v28
    v_cmp_lt_u32 vcc, v4, v29
    v_cmp_eq_u32 s[88:89], s23, v25
    s_nop 1
    s_and_b64 vcc, vcc, s[88:89]
    s_and_b64 vcc, vcc, s[72:73]
    s_cmp_eq_u64 vcc, s[72:73]
    s_cbranch_scc1 gated_mix__sliding_local_dilated__glu_gated_glu__prompt_kernel_ps2_ok
    s_sub_u32 s6, s6, 1
    s_cmp_lg_u32 s6, 0
    s_cbranch_scc1 gated_mix__sliding_local_dilated__glu_gated_glu__prompt_kernel_ps2
gated_mix__sliding_local_dilated__glu_gated_glu__prompt_kernel_ps2_ok:
    s_add_u32 s35, s5, s64
    buffer_load_dwordx4 a[32:35], v9, s[48:51], s35 offen sc1
    v_mfma_f32_32x32x16_bf16 v[96:111], a[216:219], a[72:75], v[96:111]
    s_add_u32 s35, s5, s64
    s_add_u32 s35, s35, 147456
    buffer_load_dwordx4 a[36:39], v9, s[48:51], s35 offen sc1
    v_mfma_f32_32x32x16_bf16 v[112:127], a[220:223], a[72:75], v[112:127]
    s_add_u32 s35, s5, s64
    s_add_u32 s35, s35, 1024
    buffer_load_dwordx4 a[40:43], v9, s[48:51], s35 offen sc1
    v_mfma_f32_32x32x16_bf16 v[128:143], a[216:219], a[76:79], v[128:143]
    s_add_u32 s35, s5, s64
    s_add_u32 s35, s35, 148480
    buffer_load_dwordx4 a[44:47], v9, s[48:51], s35 offen sc1
    v_mfma_f32_32x32x16_bf16 v[144:159], a[220:223], a[76:79], v[144:159]
    s_add_u32 s35, s5, s64
    s_add_u32 s35, s35, 2048
    buffer_load_dwordx4 a[48:51], v9, s[48:51], s35 offen sc1
    v_mfma_f32_32x32x16_bf16 v[96:111], a[224:227], a[80:83], v[96:111]
    s_add_u32 s35, s5, s64
    s_add_u32 s35, s35, 149504
    buffer_load_dwordx4 a[52:55], v9, s[48:51], s35 offen sc1
    v_mfma_f32_32x32x16_bf16 v[112:127], a[228:231], a[80:83], v[112:127]
    s_add_u32 m0, s9, 10240
    s_mul_i32 s35, s64, 14
    s_add_u32 s35, s35, s32
    s_add_u32 s35, s35, 43008
    buffer_load_dwordx4 v8, s[44:47], s35 offen lds
    v_mfma_f32_32x32x16_bf16 v[128:143], a[224:227], a[84:87], v[128:143]
    s_add_u32 m0, s9, 11264
    s_mul_i32 s35, s64, 14
    s_add_u32 s35, s35, s32
    s_add_u32 s35, s35, 50176
    buffer_load_dwordx4 v8, s[44:47], s35 offen lds
    v_mfma_f32_32x32x16_bf16 v[144:159], a[228:231], a[84:87], v[144:159]
    buffer_load_dwordx2 v[24:25], v22, s[12:15], 0 offen sc1
    s_add_u32 s35, s5, s64
    s_add_u32 s35, s35, 3072
    buffer_load_dwordx4 a[56:59], v9, s[48:51], s35 offen sc1
    v_mfma_f32_32x32x16_bf16 v[96:111], a[232:235], a[88:91], v[96:111]
    s_add_u32 s35, s5, s64
    s_add_u32 s35, s35, 150528
    buffer_load_dwordx4 a[60:63], v9, s[48:51], s35 offen sc1
    v_mfma_f32_32x32x16_bf16 v[112:127], a[236:239], a[88:91], v[112:127]
    s_add_u32 m0, s9, 12288
    s_mul_i32 s35, s65, 14
    s_add_u32 s35, s35, s32
    buffer_load_dwordx4 v8, s[44:47], s35 offen lds
    v_mfma_f32_32x32x16_bf16 v[128:143], a[232:235], a[92:95], v[128:143]
    s_add_u32 m0, s9, 13312
    s_mul_i32 s35, s65, 14
    s_add_u32 s35, s35, s32
    s_add_u32 s35, s35, 7168
    buffer_load_dwordx4 v8, s[44:47], s35 offen lds
    v_mfma_f32_32x32x16_bf16 v[144:159], a[236:239], a[92:95], v[144:159]
    s_add_u32 m0, s9, 14336
    s_mul_i32 s35, s65, 14
    s_add_u32 s35, s35, s32
    s_add_u32 s35, s35, 14336
    buffer_load_dwordx4 v8, s[44:47], s35 offen lds
    v_mfma_f32_32x32x16_bf16 v[96:111], a[240:243], a[0:3], v[96:111]
    s_add_u32 m0, s9, 15360
    s_mul_i32 s35, s65, 14
    s_add_u32 s35, s35, s32
    s_add_u32 s35, s35, 21504
    buffer_load_dwordx4 v8, s[44:47], s35 offen lds
    v_mfma_f32_32x32x16_bf16 v[112:127], a[244:247], a[0:3], v[112:127]
    s_add_u32 m0, s9, 16384
    s_mul_i32 s35, s65, 14
    s_add_u32 s35, s35, s32
    s_add_u32 s35, s35, 28672
    buffer_load_dwordx4 v8, s[44:47], s35 offen lds
    v_mfma_f32_32x32x16_bf16 v[128:143], a[240:243], a[4:7], v[128:143]
    ds_read_b64_tr_b16 v[176:177], v10 offset:0
    ds_read_b64_tr_b16 v[178:179], v10 offset:1024
    s_add_u32 m0, s9, 17408
    s_mul_i32 s35, s65, 14
    s_add_u32 s35, s35, s32
    s_add_u32 s35, s35, 35840
    buffer_load_dwordx4 v8, s[44:47], s35 offen lds
    v_mfma_f32_32x32x16_bf16 v[144:159], a[244:247], a[4:7], v[144:159]
    s_waitcnt vmcnt(8)
    v_xor_b32 v4, s22, v24
    v_sub_u32 v4, v4, v28
    v_cmp_lt_u32 vcc, v4, v29
    v_cmp_eq_u32 s[88:89], s23, v25
    s_nop 1
    s_and_b64 vcc, vcc, s[88:89]
    s_and_b64 vcc, vcc, s[74:75]
    s_cmp_eq_u64 vcc, s[74:75]
    s_cbranch_scc1 gated_mix__sliding_local_dilated__glu_gated_glu__prompt_kernel_ps3_ok
    s_mov_b32 s6, 262144
gated_mix__sliding_local_dilated__glu_gated_glu__prompt_kernel_ps3:
    s_sleep 1
    buffer_load_dwordx2 v[24:25], v22, s[12:15], 0 offen sc1
    s_waitcnt vmcnt(0)
    v_xor_b32 v4, s22, v24
    v_sub_u32 v4, v4, v28
    v_cmp_lt_u32 vcc, v4, v29
    v_cmp_eq_u32 s[88:89], s23, v25
    s_nop 1
    s_and_b64 vcc, vcc, s[88:89]
    s_and_b64 vcc, vcc, s[74:75]
    s_cmp_eq_u64 vcc, s[74:75]
    s_cbranch_scc1 gated_mix__sliding_local_dilated__glu_gated_glu__prompt_kernel_ps3_ok
    s_sub_u32 s6, s6, 1
    s_cmp_lg_u32 s6, 0
    s_cbranch_scc1 gated_mix__sliding_local_dilated__glu_gated_glu__prompt_kernel_ps3
gated_mix__sliding_local_dilated__glu_gated_glu__prompt_kernel_ps3_ok:
    ds_read_b64_tr_b16 v[180:181], v11 offset:0
    ds_read_b64_tr_b16 v[182:183], v11 offset:1024
    s_add_u32 s35, s5, s65
    buffer_load_dwordx4 a[64:67], v9, s[48:51], s35 offen sc1
    v_mfma_f32_32x32x16_bf16 v[96:111], a[248:251], a[8:11], v[96:111]
    s_add_u32 s35, s5, s65
    s_add_u32 s35, s35, 147456
    buffer_load_dwordx4 a[68:71], v9, s[48:51], s35 offen sc1
    v_mfma_f32_32x32x16_bf16 v[112:127], a[252:255], a[8:11], v[112:127]
    s_add_u32 s35, s5, s65
    s_add_u32 s35, s35, 1024
    buffer_load_dwordx4 a[72:75], v9, s[48:51], s35 offen sc1
    v_mfma_f32_32x32x16_bf16 v[128:143], a[248:251], a[12:15], v[128:143]
    ds_read_b64_tr_b16 v[184:185], v10 offset:2048
    ds_read_b64_tr_b16 v[186:187], v10 offset:3072
    s_add_u32 s35, s5, s65
    s_add_u32 s35, s35, 148480
    buffer_load_dwordx4 a[76:79], v9, s[48:51], s35 offen sc1
    v_mfma_f32_32x32x16_bf16 v[144:159], a[252:255], a[12:15], v[144:159]
    ds_read_b64_tr_b16 v[188:189], v11 offset:2048
    ds_read_b64_tr_b16 v[190:191], v11 offset:3072
    s_add_u32 s35, s5, s65
    s_add_u32 s35, s35, 2048
    buffer_load_dwordx4 a[80:83], v9, s[48:51], s35 offen sc1
    s_waitcnt lgkmcnt(4)
    v_mfma_f32_32x32x16_bf16 v[96:111], v[176:179], a[16:19], v[96:111]
    s_add_u32 s35, s5, s65
    s_add_u32 s35, s35, 149504
    buffer_load_dwordx4 a[84:87], v9, s[48:51], s35 offen sc1
    v_mfma_f32_32x32x16_bf16 v[112:127], v[180:183], a[16:19], v[112:127]
    s_add_u32 m0, s9, 18432
    s_mul_i32 s35, s65, 14
    s_add_u32 s35, s35, s32
    s_add_u32 s35, s35, 43008
    buffer_load_dwordx4 v8, s[44:47], s35 offen lds
    v_mfma_f32_32x32x16_bf16 v[128:143], v[176:179], a[20:23], v[128:143]
    ds_read_b64_tr_b16 v[192:193], v10 offset:4096
    ds_read_b64_tr_b16 v[194:195], v10 offset:5120
    s_add_u32 m0, s9, 19456
    s_mul_i32 s35, s65, 14
    s_add_u32 s35, s35, s32
    s_add_u32 s35, s35, 50176
    buffer_load_dwordx4 v8, s[44:47], s35 offen lds
    v_mfma_f32_32x32x16_bf16 v[144:159], v[180:183], a[20:23], v[144:159]
    buffer_load_dwordx2 v[24:25], v22, s[12:15], 0 offen sc1
    ds_read_b64_tr_b16 v[196:197], v11 offset:4096
    ds_read_b64_tr_b16 v[198:199], v11 offset:5120
    s_add_u32 s35, s5, s65
    s_add_u32 s35, s35, 3072
    buffer_load_dwordx4 a[88:91], v9, s[48:51], s35 offen sc1
    s_waitcnt lgkmcnt(4)
    v_mfma_f32_32x32x16_bf16 v[96:111], v[184:187], a[24:27], v[96:111]
    s_add_u32 s35, s5, s65
    s_add_u32 s35, s35, 150528
    buffer_load_dwordx4 a[92:95], v9, s[48:51], s35 offen sc1
    v_mfma_f32_32x32x16_bf16 v[112:127], v[188:191], a[24:27], v[112:127]
    s_add_u32 m0, s9, 20480
    s_mul_i32 s35, s66, 14
    s_add_u32 s35, s35, s32
    buffer_load_dwordx4 v8, s[44:47], s35 offen lds
    v_mfma_f32_32x32x16_bf16 v[128:143], v[184:187], a[28:31], v[128:143]
    ds_read_b64_tr_b16 v[200:201], v10 offset:6144
    ds_read_b64_tr_b16 v[202:203], v10 offset:7168
    s_add_u32 m0, s9, 21504
    s_mul_i32 s35, s66, 14
    s_add_u32 s35, s35, s32
    s_add_u32 s35, s35, 7168
    buffer_load_dwordx4 v8, s[44:47], s35 offen lds
    v_mfma_f32_32x32x16_bf16 v[144:159], v[188:191], a[28:31], v[144:159]
    ds_read_b64_tr_b16 v[204:205], v11 offset:6144
    ds_read_b64_tr_b16 v[206:207], v11 offset:7168
    s_add_u32 m0, s9, 22528
    s_mul_i32 s35, s66, 14
    s_add_u32 s35, s35, s32
    s_add_u32 s35, s35, 14336
    buffer_load_dwordx4 v8, s[44:47], s35 offen lds
    s_waitcnt lgkmcnt(4)
    v_mfma_f32_32x32x16_bf16 v[96:111], v[192:195], a[32:35], v[96:111]
    s_add_u32 m0, s9, 23552
    s_mul_i32 s35, s66, 14
    s_add_u32 s35, s35, s32
    s_add_u32 s35, s35, 21504
    buffer_load_dwordx4 v8, s[44:47], s35 offen lds
    v_mfma_f32_32x32x16_bf16 v[112:127], v[196:199], a[32:35], v[112:127]
    s_add_u32 m0, s9, 0
    s_mul_i32 s35, s66, 14
    s_add_u32 s35, s35, s32
    s_add_u32 s35, s35, 28672
    buffer_load_dwordx4 v8, s[44:47], s35 offen lds
    v_mfma_f32_32x32x16_bf16 v[128:143], v[192:195], a[36:39], v[128:143]
    ds_read_b64_tr_b16 v[160:161], v10 offset:8192
    ds_read_b64_tr_b16 v[162:163], v10 offset:9216
    s_add_u32 m0, s9, 1024
    s_mul_i32 s35, s66, 14
    s_add_u32 s35, s35, s32
    s_add_u32 s35, s35, 35840
    buffer_load_dwordx4 v8, s[44:47], s35 offen lds
    v_mfma_f32_32x32x16_bf16 v[144:159], v[196:199], a[36:39], v[144:159]
    s_waitcnt vmcnt(8)
    v_xor_b32 v4, s22, v24
    v_sub_u32 v4, v4, v28
    v_cmp_lt_u32 vcc, v4, v29
    v_cmp_eq_u32 s[88:89], s23, v25
    s_nop 1
    s_and_b64 vcc, vcc, s[88:89]
    s_and_b64 vcc, vcc, s[76:77]
    s_cmp_eq_u64 vcc, s[76:77]
    s_cbranch_scc1 gated_mix__sliding_local_dilated__glu_gated_glu__prompt_kernel_ps4_ok
    s_mov_b32 s6, 262144
gated_mix__sliding_local_dilated__glu_gated_glu__prompt_kernel_ps4:
    s_sleep 1
    buffer_load_dwordx2 v[24:25], v22, s[12:15], 0 offen sc1
    s_waitcnt vmcnt(0)
    v_xor_b32 v4, s22, v24
    v_sub_u32 v4, v4, v28
    v_cmp_lt_u32 vcc, v4, v29
    v_cmp_eq_u32 s[88:89], s23, v25
    s_nop 1
    s_and_b64 vcc, vcc, s[88:89]
    s_and_b64 vcc, vcc, s[76:77]
    s_cmp_eq_u64 vcc, s[76:77]
    s_cbranch_scc1 gated_mix__sliding_local_dilated__glu_gated_glu__prompt_kernel_ps4_ok
    s_sub_u32 s6, s6, 1
    s_cmp_lg_u32 s6, 0
    s_cbranch_scc1 gated_mix__sliding_local_dilated__glu_gated_glu__prompt_kernel_ps4
gated_mix__sliding_local_dilated__glu_gated_glu__prompt_kernel_ps4_ok:
    ds_read_b64_tr_b16 v[164:165], v11 offset:8192
    ds_read_b64_tr_b16 v[166:167], v11 offset:9216
    s_add_u32 s35, s5, s66
    buffer_load_dwordx4 a[0:3], v9, s[48:51], s35 offen sc1
    s_waitcnt lgkmcnt(4)
    v_mfma_f32_32x32x16_bf16 v[96:111], v[200:203], a[40:43], v[96:111]
    s_add_u32 s35, s5, s66
    s_add_u32 s35, s35, 147456
    buffer_load_dwordx4 a[4:7], v9, s[48:51], s35 offen sc1
    v_mfma_f32_32x32x16_bf16 v[112:127], v[204:207], a[40:43], v[112:127]
    s_add_u32 s35, s5, s66
    s_add_u32 s35, s35, 1024
    buffer_load_dwordx4 a[8:11], v9, s[48:51], s35 offen sc1
    v_mfma_f32_32x32x16_bf16 v[128:143], v[200:203], a[44:47], v[128:143]
    ds_read_b64_tr_b16 v[168:169], v10 offset:10240
    ds_read_b64_tr_b16 v[170:171], v10 offset:11264
    s_add_u32 s35, s5, s66
    s_add_u32 s35, s35, 148480
    buffer_load_dwordx4 a[12:15], v9, s[48:51], s35 offen sc1
    v_mfma_f32_32x32x16_bf16 v[144:159], v[204:207], a[44:47], v[144:159]
    ds_read_b64_tr_b16 v[172:173], v11 offset:10240
    ds_read_b64_tr_b16 v[174:175], v11 offset:11264
    s_add_u32 s35, s5, s66
    s_add_u32 s35, s35, 2048
    buffer_load_dwordx4 a[16:19], v9, s[48:51], s35 offen sc1
    s_waitcnt lgkmcnt(4)
    v_mfma_f32_32x32x16_bf16 v[96:111], v[160:163], a[48:51], v[96:111]
    s_add_u32 s35, s5, s66
    s_add_u32 s35, s35, 149504
    buffer_load_dwordx4 a[20:23], v9, s[48:51], s35 offen sc1
    v_mfma_f32_32x32x16_bf16 v[112:127], v[164:167], a[48:51], v[112:127]
    s_add_u32 m0, s9, 2048
    s_mul_i32 s35, s66, 14
    s_add_u32 s35, s35, s32
    s_add_u32 s35, s35, 43008
    buffer_load_dwordx4 v8, s[44:47], s35 offen lds
    v_mfma_f32_32x32x16_bf16 v[128:143], v[160:163], a[52:55], v[128:143]
    ds_read_b64_tr_b16 v[176:177], v10 offset:12288
    ds_read_b64_tr_b16 v[178:179], v10 offset:13312
    s_add_u32 m0, s9, 3072
    s_mul_i32 s35, s66, 14
    s_add_u32 s35, s35, s32
    s_add_u32 s35, s35, 50176
    buffer_load_dwordx4 v8, s[44:47], s35 offen lds
    v_mfma_f32_32x32x16_bf16 v[144:159], v[164:167], a[52:55], v[144:159]
    buffer_load_dwordx2 v[24:25], v23, s[12:15], 0 offen sc1
    ds_read_b64_tr_b16 v[180:181], v11 offset:12288
    ds_read_b64_tr_b16 v[182:183], v11 offset:13312
    s_add_u32 s35, s5, s66
    s_add_u32 s35, s35, 3072
    buffer_load_dwordx4 a[24:27], v9, s[48:51], s35 offen sc1
    s_waitcnt lgkmcnt(4)
    v_mfma_f32_32x32x16_bf16 v[96:111], v[168:171], a[56:59], v[96:111]
    s_add_u32 s35, s5, s66
    s_add_u32 s35, s35, 150528
    buffer_load_dwordx4 a[28:31], v9, s[48:51], s35 offen sc1
    v_mfma_f32_32x32x16_bf16 v[112:127], v[172:175], a[56:59], v[112:127]
    s_add_u32 m0, s9, 25600
    s_add_u32 s35, s10, 0
    buffer_load_dwordx4 v8, s[40:43], s35 offen lds
    v_mfma_f32_32x32x16_bf16 v[128:143], v[168:171], a[60:63], v[128:143]
    ds_read_b64_tr_b16 v[184:185], v10 offset:14336
    ds_read_b64_tr_b16 v[186:187], v10 offset:15360
    s_add_u32 m0, s9, 26624
    s_add_u32 s35, s10, 7168
    buffer_load_dwordx4 v8, s[40:43], s35 offen lds
    v_mfma_f32_32x32x16_bf16 v[144:159], v[172:175], a[60:63], v[144:159]
    ds_read_b64_tr_b16 v[188:189], v11 offset:14336
    ds_read_b64_tr_b16 v[190:191], v11 offset:15360
    s_add_u32 m0, s9, 27648
    s_add_u32 s35, s10, 14336
    buffer_load_dwordx4 v8, s[40:43], s35 offen lds
    s_waitcnt lgkmcnt(4)
    v_mfma_f32_32x32x16_bf16 v[96:111], v[176:179], a[64:67], v[96:111]
    s_add_u32 m0, s9, 28672
    s_add_u32 s35, s10, 21504
    buffer_load_dwordx4 v8, s[40:43], s35 offen lds
    v_mfma_f32_32x32x16_bf16 v[112:127], v[180:183], a[64:67], v[112:127]
    s_add_u32 m0, s9, 29696
    s_add_u32 s35, s10, 28672
    buffer_load_dwordx4 v8, s[40:43], s35 offen lds
    v_mfma_f32_32x32x16_bf16 v[128:143], v[176:179], a[68:71], v[128:143]
    ds_read_b64_tr_b16 v[192:193], v10 offset:16384
    ds_read_b64_tr_b16 v[194:195], v10 offset:17408
    s_add_u32 m0, s9, 30720
    s_add_u32 s35, s10, 35840
    buffer_load_dwordx4 v8, s[40:43], s35 offen lds
    v_mfma_f32_32x32x16_bf16 v[144:159], v[180:183], a[68:71], v[144:159]
    s_waitcnt vmcnt(8)
    v_xor_b32 v4, s22, v24
    v_sub_u32 v4, v4, v30
    v_cmp_lt_u32 vcc, v4, v31
    v_cmp_eq_u32 s[88:89], s23, v25
    s_nop 1
    s_and_b64 vcc, vcc, s[88:89]
    s_and_b64 vcc, vcc, s[94:95]
    s_cmp_eq_u64 vcc, s[94:95]
    s_cbranch_scc1 gated_mix__sliding_local_dilated__glu_gated_glu__prompt_kernel_pa_ok
    s_mov_b32 s6, 262144
gated_mix__sliding_local_dilated__glu_gated_glu__prompt_kernel_pa:
    s_sleep 1
    buffer_load_dwordx2 v[24:25], v23, s[12:15], 0 offen sc1
    s_waitcnt vmcnt(0)
    v_xor_b32 v4, s22, v24
    v_sub_u32 v4, v4, v30
    v_cmp_lt_u32 vcc, v4, v31
    v_cmp_eq_u32 s[88:89], s23, v25
    s_nop 1
    s_and_b64 vcc, vcc, s[88:89]
    s_and_b64 vcc, vcc, s[94:95]
    s_cmp_eq_u64 vcc, s[94:95]
    s_cbranch_scc1 gated_mix__sliding_local_dilated__glu_gated_glu__prompt_kernel_pa_ok
    s_sub_u32 s6, s6, 1
    s_cmp_lg_u32 s6, 0
    s_cbranch_scc1 gated_mix__sliding_local_dilated__glu_gated_glu__prompt_kernel_pa
gated_mix__sliding_local_dilated__glu_gated_glu__prompt_kernel_pa_ok:
    v_lshlrev_b32 v4, 2, v2
    s_lshl_b32 s6, s7, 8
    buffer_load_dword v12, v4, s[52:55], s6 offen sc1
    buffer_load_dword v14, v4, s[52:55], s6 offen offset:128 sc1
    ds_read_b64_tr_b16 v[196:197], v11 offset:16384
    ds_read_b64_tr_b16 v[198:199], v11 offset:17408
    s_add_u32 s35, s4, 0
    buffer_load_dwordx4 a[32:35], v9, s[48:51], s35 offen sc1
    s_waitcnt lgkmcnt(4)
    v_mfma_f32_32x32x16_bf16 v[96:111], v[184:187], a[72:75], v[96:111]
    s_add_u32 s35, s4, 147456
    buffer_load_dwordx4 a[36:39], v9, s[48:51], s35 offen sc1
    v_mfma_f32_32x32x16_bf16 v[112:127], v[188:191], a[72:75], v[112:127]
    s_add_u32 s35, s4, 1024
    buffer_load_dwordx4 a[40:43], v9, s[48:51], s35 offen sc1
    v_mfma_f32_32x32x16_bf16 v[128:143], v[184:187], a[76:79], v[128:143]
    ds_read_b64_tr_b16 v[200:201], v10 offset:18432
    ds_read_b64_tr_b16 v[202:203], v10 offset:19456
    s_add_u32 s35, s4, 148480
    buffer_load_dwordx4 a[44:47], v9, s[48:51], s35 offen sc1
    v_mfma_f32_32x32x16_bf16 v[144:159], v[188:191], a[76:79], v[144:159]
    ds_read_b64_tr_b16 v[204:205], v11 offset:18432
    ds_read_b64_tr_b16 v[206:207], v11 offset:19456
    s_add_u32 s35, s4, 2048
    buffer_load_dwordx4 a[48:51], v9, s[48:51], s35 offen sc1
    s_waitcnt lgkmcnt(4)
    v_mfma_f32_32x32x16_bf16 v[96:111], v[192:195], a[80:83], v[96:111]
    s_add_u32 s35, s4, 149504
    buffer_load_dwordx4 a[52:55], v9, s[48:51], s35 offen sc1
    v_mfma_f32_32x32x16_bf16 v[112:127], v[196:199], a[80:83], v[112:127]
    s_add_u32 m0, s9, 31744
    s_add_u32 s35, s10, 43008
    buffer_load_dwordx4 v8, s[40:43], s35 offen lds
    v_mfma_f32_32x32x16_bf16 v[128:143], v[192:195], a[84:87], v[128:143]
    ds_read_b64_tr_b16 v[160:161], v10 offset:20480
    ds_read_b64_tr_b16 v[162:163], v10 offset:21504
    s_add_u32 m0, s9, 32768
    s_add_u32 s35, s10, 50176
    buffer_load_dwordx4 v8, s[40:43], s35 offen lds
    v_mfma_f32_32x32x16_bf16 v[144:159], v[196:199], a[84:87], v[144:159]
    ds_read_b64_tr_b16 v[164:165], v11 offset:20480
    ds_read_b64_tr_b16 v[166:167], v11 offset:21504
    s_add_u32 s35, s4, 3072
    buffer_load_dwordx4 a[56:59], v9, s[48:51], s35 offen sc1
    s_waitcnt lgkmcnt(4)
    v_mfma_f32_32x32x16_bf16 v[96:111], v[200:203], a[88:91], v[96:111]
    s_add_u32 s35, s4, 150528
    buffer_load_dwordx4 a[60:63], v9, s[48:51], s35 offen sc1
    v_mfma_f32_32x32x16_bf16 v[112:127], v[204:207], a[88:91], v[112:127]
    s_add_u32 m0, s9, 33792
    s_add_u32 s35, s10, 57344
    buffer_load_dwordx4 v8, s[40:43], s35 offen lds
    v_mfma_f32_32x32x16_bf16 v[128:143], v[200:203], a[92:95], v[128:143]
    ds_read_b64_tr_b16 v[168:169], v10 offset:22528
    ds_read_b64_tr_b16 v[170:171], v10 offset:23552
    s_add_u32 s35, s4, 4096
    buffer_load_dwordx4 a[64:67], v9, s[48:51], s35 offen sc1
    v_mfma_f32_32x32x16_bf16 v[144:159], v[204:207], a[92:95], v[144:159]
    ds_read_b64_tr_b16 v[172:173], v11 offset:22528
    ds_read_b64_tr_b16 v[174:175], v11 offset:23552
    s_add_u32 s35, s4, 151552
    buffer_load_dwordx4 a[68:71], v9, s[48:51], s35 offen sc1
    s_waitcnt lgkmcnt(4)
    v_mfma_f32_32x32x16_bf16 v[96:111], v[160:163], a[0:3], v[96:111]
    s_add_u32 m0, s9, 34816
    s_add_u32 s35, s10, 64512
    buffer_load_dwordx4 v8, s[40:43], s35 offen lds
    v_mfma_f32_32x32x16_bf16 v[112:127], v[164:167], a[0:3], v[112:127]
    s_add_u32 m0, s9, 35840
    s_add_u32 s35, s10, 71680
    buffer_load_dwordx4 v8, s[40:43], s35 offen lds
    v_mfma_f32_32x32x16_bf16 v[128:143], v[160:163], a[4:7], v[128:143]
    ds_read_b64_tr_b16 v[176:177], v10 offset:0
    ds_read_b64_tr_b16 v[178:179], v10 offset:1024
    s_add_u32 s35, s4, 5120
    buffer_load_dwordx4 a[72:75], v9, s[48:51], s35 offen sc1
    v_mfma_f32_32x32x16_bf16 v[144:159], v[164:167], a[4:7], v[144:159]
    ds_read_b64_tr_b16 v[180:181], v11 offset:0
    ds_read_b64_tr_b16 v[182:183], v11 offset:1024
    s_add_u32 s35, s4, 152576
    buffer_load_dwordx4 a[76:79], v9, s[48:51], s35 offen sc1
    s_waitcnt lgkmcnt(4)
    v_mfma_f32_32x32x16_bf16 v[96:111], v[168:171], a[8:11], v[96:111]
    s_add_u32 m0, s9, 36864
    s_add_u32 s35, s10, 78848
    buffer_load_dwordx4 v8, s[40:43], s35 offen lds
    v_mfma_f32_32x32x16_bf16 v[112:127], v[172:175], a[8:11], v[112:127]
    s_add_u32 m0, s9, 37888
    s_add_u32 s35, s10, 86016
    buffer_load_dwordx4 v8, s[40:43], s35 offen lds
    v_mfma_f32_32x32x16_bf16 v[128:143], v[168:171], a[12:15], v[128:143]
    ds_read_b64_tr_b16 v[184:185], v10 offset:2048
    ds_read_b64_tr_b16 v[186:187], v10 offset:3072
    s_add_u32 s35, s4, 6144
    buffer_load_dwordx4 a[80:83], v9, s[48:51], s35 offen sc1
    v_mfma_f32_32x32x16_bf16 v[144:159], v[172:175], a[12:15], v[144:159]
    ds_read_b64_tr_b16 v[188:189], v11 offset:2048
    ds_read_b64_tr_b16 v[190:191], v11 offset:3072
    s_add_u32 s35, s4, 153600
    buffer_load_dwordx4 a[84:87], v9, s[48:51], s35 offen sc1
    s_waitcnt lgkmcnt(4)
    v_mfma_f32_32x32x16_bf16 v[96:111], v[176:179], a[16:19], v[96:111]
    s_add_u32 m0, s9, 38912
    s_add_u32 s35, s10, 93184
    buffer_load_dwordx4 v8, s[40:43], s35 offen lds
    s_waitcnt vmcnt(22)
    v_mfma_f32_32x32x16_bf16 v[112:127], v[180:183], a[16:19], v[112:127]
    s_add_u32 m0, s9, 39936
    s_add_u32 s35, s10, 100352
    buffer_load_dwordx4 v8, s[40:43], s35 offen lds
    v_cvt_pk_bf16_f32 v12, v12, v12
    v_mfma_f32_32x32x16_bf16 v[128:143], v[176:179], a[20:23], v[128:143]
    ds_read_b64_tr_b16 v[192:193], v10 offset:25600
    ds_read_b64_tr_b16 v[194:195], v10 offset:26624
    s_add_u32 s35, s4, 7168
    buffer_load_dwordx4 a[88:91], v9, s[48:51], s35 offen sc1
    v_mfma_f32_32x32x16_bf16 v[144:159], v[180:183], a[20:23], v[144:159]
    ds_read_b64_tr_b16 v[196:197], v11 offset:25600
    ds_read_b64_tr_b16 v[198:199], v11 offset:26624
    s_add_u32 s35, s4, 154624
    buffer_load_dwordx4 a[92:95], v9, s[48:51], s35 offen sc1
    s_waitcnt lgkmcnt(4)
    v_mfma_f32_32x32x16_bf16 v[96:111], v[184:187], a[24:27], v[96:111]
    v_cvt_pk_bf16_f32 v14, v14, v14
    v_lshlrev_b32 v12, 16, v12
    v_lshlrev_b32 v14, 16, v14
    v_mul_f32 v12, 0xbfb8aa3b, v12
    v_mul_f32 v14, 0xbfb8aa3b, v14
    v_mfma_f32_32x32x16_bf16 v[112:127], v[188:191], a[24:27], v[112:127]
    v_exp_f32 v12, v12
    v_exp_f32 v14, v14
    v_add_f32 v12, 1.0, v12
    v_add_f32 v14, 1.0, v14
    v_mfma_f32_32x32x16_bf16 v[128:143], v[184:187], a[28:31], v[128:143]
    ds_read_b64_tr_b16 v[200:201], v10 offset:27648
    ds_read_b64_tr_b16 v[202:203], v10 offset:28672
    v_rcp_f32 v12, v12
    v_rcp_f32 v14, v14
    v_mfma_f32_32x32x16_bf16 v[144:159], v[188:191], a[28:31], v[144:159]
    ds_read_b64_tr_b16 v[204:205], v11 offset:27648
    ds_read_b64_tr_b16 v[206:207], v11 offset:28672
    v_cvt_pk_bf16_f32 v12, v12, v12
    v_cvt_pk_bf16_f32 v14, v14, v14
    v_lshlrev_b32 v12, 16, v12
    v_lshlrev_b32 v14, 16, v14
    s_waitcnt lgkmcnt(4)
    s_waitcnt vmcnt(23)
    v_mfma_f32_32x32x16_bf16 v[32:47], v[192:195], a[32:35], 0
    v_sub_f32 v16, 1.0, v12
    v_sub_f32 v17, 1.0, v14
    v_cvt_pk_bf16_f32 v16, v16, v16
    v_cvt_pk_bf16_f32 v17, v17, v17
    v_lshlrev_b32 v16, 16, v16
    v_mfma_f32_32x32x16_bf16 v[48:63], v[196:199], a[32:35], 0
    v_lshlrev_b32 v17, 16, v17
    v_mfma_f32_32x32x16_bf16 v[64:79], v[192:195], a[36:39], 0
    ds_read_b64_tr_b16 v[160:161], v10 offset:29184
    ds_read_b64_tr_b16 v[162:163], v10 offset:30208
    v_mul_f32 v96, v96, v16
    v_mul_f32 v97, v97, v16
    v_mul_f32 v98, v98, v16
    v_mul_f32 v99, v99, v16
    v_mfma_f32_32x32x16_bf16 v[80:95], v[196:199], a[36:39], 0
    ds_read_b64_tr_b16 v[164:165], v11 offset:29184
    ds_read_b64_tr_b16 v[166:167], v11 offset:30208
    v_mul_f32 v100, v100, v16
    v_mul_f32 v101, v101, v16
    v_mul_f32 v102, v102, v16
    v_mul_f32 v103, v103, v16
    s_waitcnt lgkmcnt(4)
    s_waitcnt vmcnt(21)
    v_mfma_f32_32x32x16_bf16 v[32:47], v[200:203], a[40:43], v[32:47]
    v_mul_f32 v104, v104, v16
    v_mul_f32 v105, v105, v16
    v_mul_f32 v106, v106, v16
    v_mul_f32 v107, v107, v16
    v_mul_f32 v108, v108, v16
    v_mfma_f32_32x32x16_bf16 v[48:63], v[204:207], a[40:43], v[48:63]
    v_mul_f32 v109, v109, v16
    v_mul_f32 v110, v110, v16
    v_mul_f32 v111, v111, v16
    v_mul_f32 v112, v112, v16
    v_mul_f32 v113, v113, v16
    v_mul_f32 v114, v114, v16
    v_mfma_f32_32x32x16_bf16 v[64:79], v[200:203], a[44:47], v[64:79]
    s_waitcnt vmcnt(17)
    ds_read_b64_tr_b16 v[168:169], v10 offset:31232
    ds_read_b64_tr_b16 v[170:171], v10 offset:32256
    v_mul_f32 v115, v115, v16
    v_mul_f32 v116, v116, v16
    v_mul_f32 v117, v117, v16
    v_mul_f32 v118, v118, v16
    v_mfma_f32_32x32x16_bf16 v[80:95], v[204:207], a[44:47], v[80:95]
    ds_read_b64_tr_b16 v[172:173], v11 offset:31232
    ds_read_b64_tr_b16 v[174:175], v11 offset:32256
    v_mul_f32 v119, v119, v16
    v_mul_f32 v120, v120, v16
    v_mul_f32 v121, v121, v16
    v_mul_f32 v122, v122, v16
    s_waitcnt lgkmcnt(4)
    v_mfma_f32_32x32x16_bf16 v[32:47], v[160:163], a[48:51], v[32:47]
    v_mul_f32 v123, v123, v16
    v_mul_f32 v124, v124, v16
    v_mul_f32 v125, v125, v16
    v_mul_f32 v126, v126, v16
    v_mul_f32 v127, v127, v16
    v_mfma_f32_32x32x16_bf16 v[48:63], v[164:167], a[48:51], v[48:63]
    v_mul_f32 v128, v128, v17
    v_mul_f32 v129, v129, v17
    v_mul_f32 v130, v130, v17
    v_mul_f32 v131, v131, v17
    v_mul_f32 v132, v132, v17
    v_mul_f32 v133, v133, v17
    v_mfma_f32_32x32x16_bf16 v[64:79], v[160:163], a[52:55], v[64:79]
    s_waitcnt vmcnt(14)
    ds_read_b64_tr_b16 v[176:177], v10 offset:32768
    ds_read_b64_tr_b16 v[178:179], v10 offset:33792
    v_mul_f32 v134, v134, v17
    v_mul_f32 v135, v135, v17
    v_mul_f32 v136, v136, v17
    v_mul_f32 v137, v137, v17
    v_mfma_f32_32x32x16_bf16 v[80:95], v[164:167], a[52:55], v[80:95]
    ds_read_b64_tr_b16 v[180:181], v11 offset:32768
    ds_read_b64_tr_b16 v[182:183], v11 offset:33792
    v_mul_f32 v138, v138, v17
    v_mul_f32 v139, v139, v17
    v_mul_f32 v140, v140, v17
    v_mul_f32 v141, v141, v17
    s_waitcnt lgkmcnt(4)
    v_mfma_f32_32x32x16_bf16 v[32:47], v[168:171], a[56:59], v[32:47]
    v_mul_f32 v142, v142, v17
    v_mul_f32 v143, v143, v17
    v_mul_f32 v144, v144, v17
    v_mul_f32 v145, v145, v17
    v_mul_f32 v146, v146, v17
    v_mfma_f32_32x32x16_bf16 v[48:63], v[172:175], a[56:59], v[48:63]
    v_mul_f32 v147, v147, v17
    v_mul_f32 v148, v148, v17
    v_mul_f32 v149, v149, v17
    v_mul_f32 v150, v150, v17
    v_mul_f32 v151, v151, v17
    v_mul_f32 v152, v152, v17
    v_mfma_f32_32x32x16_bf16 v[64:79], v[168:171], a[60:63], v[64:79]
    s_waitcnt vmcnt(10)
    ds_read_b64_tr_b16 v[184:185], v10 offset:34816
    ds_read_b64_tr_b16 v[186:187], v10 offset:35840
    v_mul_f32 v153, v153, v17
    v_mul_f32 v154, v154, v17
    v_mul_f32 v155, v155, v17
    v_mul_f32 v156, v156, v17
    v_mfma_f32_32x32x16_bf16 v[80:95], v[172:175], a[60:63], v[80:95]
    ds_read_b64_tr_b16 v[188:189], v11 offset:34816
    ds_read_b64_tr_b16 v[190:191], v11 offset:35840
    v_mul_f32 v157, v157, v17
    v_mul_f32 v158, v158, v17
    v_mul_f32 v159, v159, v17
    s_waitcnt lgkmcnt(4)
    v_mfma_f32_32x32x16_bf16 v[32:47], v[176:179], a[64:67], v[32:47]
    v_mfma_f32_32x32x16_bf16 v[48:63], v[180:183], a[64:67], v[48:63]
    v_mfma_f32_32x32x16_bf16 v[64:79], v[176:179], a[68:71], v[64:79]
    s_waitcnt vmcnt(6)
    ds_read_b64_tr_b16 v[192:193], v10 offset:36352
    ds_read_b64_tr_b16 v[194:195], v10 offset:37376
    v_mfma_f32_32x32x16_bf16 v[80:95], v[180:183], a[68:71], v[80:95]
    ds_read_b64_tr_b16 v[196:197], v11 offset:36352
    ds_read_b64_tr_b16 v[198:199], v11 offset:37376
    s_waitcnt lgkmcnt(4)
    v_mfma_f32_32x32x16_bf16 v[32:47], v[184:187], a[72:75], v[32:47]
    v_mfma_f32_32x32x16_bf16 v[48:63], v[188:191], a[72:75], v[48:63]
    v_mfma_f32_32x32x16_bf16 v[64:79], v[184:187], a[76:79], v[64:79]
    s_waitcnt vmcnt(2)
    ds_read_b64_tr_b16 v[200:201], v10 offset:38400
    ds_read_b64_tr_b16 v[202:203], v10 offset:39424
    v_mfma_f32_32x32x16_bf16 v[80:95], v[188:191], a[76:79], v[80:95]
    ds_read_b64_tr_b16 v[204:205], v11 offset:38400
    ds_read_b64_tr_b16 v[206:207], v11 offset:39424
    s_waitcnt lgkmcnt(4)
    v_mfma_f32_32x32x16_bf16 v[32:47], v[192:195], a[80:83], v[32:47]
    v_mfma_f32_32x32x16_bf16 v[48:63], v[196:199], a[80:83], v[48:63]
    v_mfma_f32_32x32x16_bf16 v[64:79], v[192:195], a[84:87], v[64:79]
    v_mfma_f32_32x32x16_bf16 v[80:95], v[196:199], a[84:87], v[80:95]
    s_waitcnt lgkmcnt(0)
    s_waitcnt vmcnt(0)
    v_mfma_f32_32x32x16_bf16 v[32:47], v[200:203], a[88:91], v[32:47]
    v_mfma_f32_32x32x16_bf16 v[48:63], v[204:207], a[88:91], v[48:63]
    v_mfma_f32_32x32x16_bf16 v[64:79], v[200:203], a[92:95], v[64:79]
    v_mfma_f32_32x32x16_bf16 v[80:95], v[204:207], a[92:95], v[80:95]
    s_cmp_lg_u32 s3, 0
    s_cbranch_scc1 gated_mix__sliding_local_dilated__glu_gated_glu__prompt_kernel_red1
    s_nop 7
    v_pk_fma_f32 v[112:113], v[48:49], v[12:13], v[112:113] op_sel_hi:[1,0,1]
    v_pk_fma_f32 v[114:115], v[50:51], v[12:13], v[114:115] op_sel_hi:[1,0,1]
    v_pk_fma_f32 v[116:117], v[52:53], v[12:13], v[116:117] op_sel_hi:[1,0,1]
    v_pk_fma_f32 v[118:119], v[54:55], v[12:13], v[118:119] op_sel_hi:[1,0,1]
    v_pk_fma_f32 v[120:121], v[56:57], v[12:13], v[120:121] op_sel_hi:[1,0,1]
    v_pk_fma_f32 v[122:123], v[58:59], v[12:13], v[122:123] op_sel_hi:[1,0,1]
    v_pk_fma_f32 v[124:125], v[60:61], v[12:13], v[124:125] op_sel_hi:[1,0,1]
    v_pk_fma_f32 v[126:127], v[62:63], v[12:13], v[126:127] op_sel_hi:[1,0,1]
    ds_write_b128 v18, v[112:115] offset:4096
    ds_write_b128 v18, v[116:119] offset:5120
    ds_write_b128 v18, v[120:123] offset:6144
    ds_write_b128 v18, v[124:127] offset:7168
    v_pk_fma_f32 v[128:129], v[64:65], v[14:15], v[128:129] op_sel_hi:[1,0,1]
    v_pk_fma_f32 v[130:131], v[66:67], v[14:15], v[130:131] op_sel_hi:[1,0,1]
    v_pk_fma_f32 v[132:133], v[68:69], v[14:15], v[132:133] op_sel_hi:[1,0,1]
    v_pk_fma_f32 v[134:135], v[70:71], v[14:15], v[134:135] op_sel_hi:[1,0,1]
    v_pk_fma_f32 v[136:137], v[72:73], v[14:15], v[136:137] op_sel_hi:[1,0,1]
    v_pk_fma_f32 v[138:139], v[74:75], v[14:15], v[138:139] op_sel_hi:[1,0,1]
    v_pk_fma_f32 v[140:141], v[76:77], v[14:15], v[140:141] op_sel_hi:[1,0,1]
    v_pk_fma_f32 v[142:143], v[78:79], v[14:15], v[142:143] op_sel_hi:[1,0,1]
    ds_write_b128 v18, v[128:131] offset:8192
    ds_write_b128 v18, v[132:135] offset:9216
    ds_write_b128 v18, v[136:139] offset:10240
    ds_write_b128 v18, v[140:143] offset:11264
    v_pk_fma_f32 v[144:145], v[80:81], v[14:15], v[144:145] op_sel_hi:[1,0,1]
    v_pk_fma_f32 v[146:147], v[82:83], v[14:15], v[146:147] op_sel_hi:[1,0,1]
    v_pk_fma_f32 v[148:149], v[84:85], v[14:15], v[148:149] op_sel_hi:[1,0,1]
    v_pk_fma_f32 v[150:151], v[86:87], v[14:15], v[150:151] op_sel_hi:[1,0,1]
    v_pk_fma_f32 v[152:153], v[88:89], v[14:15], v[152:153] op_sel_hi:[1,0,1]
    v_pk_fma_f32 v[154:155], v[90:91], v[14:15], v[154:155] op_sel_hi:[1,0,1]
    v_pk_fma_f32 v[156:157], v[92:93], v[14:15], v[156:157] op_sel_hi:[1,0,1]
    v_pk_fma_f32 v[158:159], v[94:95], v[14:15], v[158:159] op_sel_hi:[1,0,1]
    ds_write_b128 v18, v[144:147] offset:12288
    ds_write_b128 v18, v[148:151] offset:13312
    ds_write_b128 v18, v[152:155] offset:14336
    ds_write_b128 v18, v[156:159] offset:15360
    v_pk_fma_f32 v[96:97], v[32:33], v[12:13], v[96:97] op_sel_hi:[1,0,1]
    v_pk_fma_f32 v[98:99], v[34:35], v[12:13], v[98:99] op_sel_hi:[1,0,1]
    v_pk_fma_f32 v[100:101], v[36:37], v[12:13], v[100:101] op_sel_hi:[1,0,1]
    v_pk_fma_f32 v[102:103], v[38:39], v[12:13], v[102:103] op_sel_hi:[1,0,1]
    v_pk_fma_f32 v[104:105], v[40:41], v[12:13], v[104:105] op_sel_hi:[1,0,1]
    v_pk_fma_f32 v[106:107], v[42:43], v[12:13], v[106:107] op_sel_hi:[1,0,1]
    v_pk_fma_f32 v[108:109], v[44:45], v[12:13], v[108:109] op_sel_hi:[1,0,1]
    v_pk_fma_f32 v[110:111], v[46:47], v[12:13], v[110:111] op_sel_hi:[1,0,1]
    s_waitcnt lgkmcnt(0)
    s_barrier
    ds_read_b128 v[32:35], v19 offset:40960
    ds_read_b128 v[36:39], v19 offset:41984
    ds_read_b128 v[40:43], v19 offset:43008
    ds_read_b128 v[44:47], v19 offset:44032
    ds_read_b128 v[48:51], v20 offset:0
    ds_read_b128 v[52:55], v20 offset:1024
    ds_read_b128 v[56:59], v20 offset:2048
    ds_read_b128 v[60:63], v20 offset:3072
    ds_read_b128 v[64:67], v20 offset:40960
    ds_read_b128 v[68:71], v20 offset:41984
    ds_read_b128 v[72:75], v20 offset:43008
    ds_read_b128 v[76:79], v20 offset:44032
    s_waitcnt lgkmcnt(8)
    v_pk_add_f32 v[96:97], v[96:97], v[32:33]
    v_pk_add_f32 v[98:99], v[98:99], v[34:35]
    v_pk_add_f32 v[100:101], v[100:101], v[36:37]
    v_pk_add_f32 v[102:103], v[102:103], v[38:39]
    v_pk_add_f32 v[104:105], v[104:105], v[40:41]
    v_pk_add_f32 v[106:107], v[106:107], v[42:43]
    v_pk_add_f32 v[108:109], v[108:109], v[44:45]
    v_pk_add_f32 v[110:111], v[110:111], v[46:47]
    s_waitcnt lgkmcnt(4)
    v_pk_add_f32 v[96:97], v[96:97], v[48:49]
    v_pk_add_f32 v[98:99], v[98:99], v[50:51]
    v_pk_add_f32 v[100:101], v[100:101], v[52:53]
    v_pk_add_f32 v[102:103], v[102:103], v[54:55]
    v_pk_add_f32 v[104:105], v[104:105], v[56:57]
    v_pk_add_f32 v[106:107], v[106:107], v[58:59]
    v_pk_add_f32 v[108:109], v[108:109], v[60:61]
    v_pk_add_f32 v[110:111], v[110:111], v[62:63]
    s_waitcnt lgkmcnt(0)
    v_pk_add_f32 v[96:97], v[96:97], v[64:65]
    v_pk_add_f32 v[98:99], v[98:99], v[66:67]
    v_pk_add_f32 v[100:101], v[100:101], v[68:69]
    v_pk_add_f32 v[102:103], v[102:103], v[70:71]
    v_pk_add_f32 v[104:105], v[104:105], v[72:73]
    v_pk_add_f32 v[106:107], v[106:107], v[74:75]
    v_pk_add_f32 v[108:109], v[108:109], v[76:77]
    v_pk_add_f32 v[110:111], v[110:111], v[78:79]
    v_cvt_pk_bf16_f32 v96, v96, v97
    v_cvt_pk_bf16_f32 v97, v98, v99
    v_cvt_pk_bf16_f32 v98, v100, v101
    v_cvt_pk_bf16_f32 v99, v102, v103
    v_cvt_pk_bf16_f32 v100, v104, v105
    v_cvt_pk_bf16_f32 v101, v106, v107
    v_cvt_pk_bf16_f32 v102, v108, v109
    v_cvt_pk_bf16_f32 v103, v110, v111
    v_permlane32_swap_b32 v96, v98
    v_permlane32_swap_b32 v97, v99
    v_permlane32_swap_b32 v100, v102
    v_permlane32_swap_b32 v101, v103
    buffer_store_dwordx4 v[96:99], v21, s[56:59], s2 offen
    buffer_store_dwordx4 v[100:103], v21, s[56:59], s2 offen offset:32
    s_branch gated_mix__sliding_local_dilated__glu_gated_glu__prompt_kernel_fin
gated_mix__sliding_local_dilated__glu_gated_glu__prompt_kernel_red1:
    s_nop 11
    s_cmp_lg_u32 s3, 1
    s_cbranch_scc1 gated_mix__sliding_local_dilated__glu_gated_glu__prompt_kernel_red2
    v_pk_fma_f32 v[96:97], v[32:33], v[12:13], v[96:97] op_sel_hi:[1,0,1]
    v_pk_fma_f32 v[98:99], v[34:35], v[12:13], v[98:99] op_sel_hi:[1,0,1]
    v_pk_fma_f32 v[100:101], v[36:37], v[12:13], v[100:101] op_sel_hi:[1,0,1]
    v_pk_fma_f32 v[102:103], v[38:39], v[12:13], v[102:103] op_sel_hi:[1,0,1]
    v_pk_fma_f32 v[104:105], v[40:41], v[12:13], v[104:105] op_sel_hi:[1,0,1]
    v_pk_fma_f32 v[106:107], v[42:43], v[12:13], v[106:107] op_sel_hi:[1,0,1]
    v_pk_fma_f32 v[108:109], v[44:45], v[12:13], v[108:109] op_sel_hi:[1,0,1]
    v_pk_fma_f32 v[110:111], v[46:47], v[12:13], v[110:111] op_sel_hi:[1,0,1]
    ds_write_b128 v18, v[96:99] offset:0
    ds_write_b128 v18, v[100:103] offset:1024
    ds_write_b128 v18, v[104:107] offset:2048
    ds_write_b128 v18, v[108:111] offset:3072
    v_pk_fma_f32 v[128:129], v[64:65], v[14:15], v[128:129] op_sel_hi:[1,0,1]
    v_pk_fma_f32 v[130:131], v[66:67], v[14:15], v[130:131] op_sel_hi:[1,0,1]
    v_pk_fma_f32 v[132:133], v[68:69], v[14:15], v[132:133] op_sel_hi:[1,0,1]
    v_pk_fma_f32 v[134:135], v[70:71], v[14:15], v[134:135] op_sel_hi:[1,0,1]
    v_pk_fma_f32 v[136:137], v[72:73], v[14:15], v[136:137] op_sel_hi:[1,0,1]
    v_pk_fma_f32 v[138:139], v[74:75], v[14:15], v[138:139] op_sel_hi:[1,0,1]
    v_pk_fma_f32 v[140:141], v[76:77], v[14:15], v[140:141] op_sel_hi:[1,0,1]
    v_pk_fma_f32 v[142:143], v[78:79], v[14:15], v[142:143] op_sel_hi:[1,0,1]
    ds_write_b128 v18, v[128:131] offset:8192
    ds_write_b128 v18, v[132:135] offset:9216
    ds_write_b128 v18, v[136:139] offset:10240
    ds_write_b128 v18, v[140:143] offset:11264
    v_pk_fma_f32 v[144:145], v[80:81], v[14:15], v[144:145] op_sel_hi:[1,0,1]
    v_pk_fma_f32 v[146:147], v[82:83], v[14:15], v[146:147] op_sel_hi:[1,0,1]
    v_pk_fma_f32 v[148:149], v[84:85], v[14:15], v[148:149] op_sel_hi:[1,0,1]
    v_pk_fma_f32 v[150:151], v[86:87], v[14:15], v[150:151] op_sel_hi:[1,0,1]
    v_pk_fma_f32 v[152:153], v[88:89], v[14:15], v[152:153] op_sel_hi:[1,0,1]
    v_pk_fma_f32 v[154:155], v[90:91], v[14:15], v[154:155] op_sel_hi:[1,0,1]
    v_pk_fma_f32 v[156:157], v[92:93], v[14:15], v[156:157] op_sel_hi:[1,0,1]
    v_pk_fma_f32 v[158:159], v[94:95], v[14:15], v[158:159] op_sel_hi:[1,0,1]
    ds_write_b128 v18, v[144:147] offset:12288
    ds_write_b128 v18, v[148:151] offset:13312
    ds_write_b128 v18, v[152:155] offset:14336
    ds_write_b128 v18, v[156:159] offset:15360
    v_pk_fma_f32 v[112:113], v[48:49], v[12:13], v[112:113] op_sel_hi:[1,0,1]
    v_pk_fma_f32 v[114:115], v[50:51], v[12:13], v[114:115] op_sel_hi:[1,0,1]
    v_pk_fma_f32 v[116:117], v[52:53], v[12:13], v[116:117] op_sel_hi:[1,0,1]
    v_pk_fma_f32 v[118:119], v[54:55], v[12:13], v[118:119] op_sel_hi:[1,0,1]
    v_pk_fma_f32 v[120:121], v[56:57], v[12:13], v[120:121] op_sel_hi:[1,0,1]
    v_pk_fma_f32 v[122:123], v[58:59], v[12:13], v[122:123] op_sel_hi:[1,0,1]
    v_pk_fma_f32 v[124:125], v[60:61], v[12:13], v[124:125] op_sel_hi:[1,0,1]
    v_pk_fma_f32 v[126:127], v[62:63], v[12:13], v[126:127] op_sel_hi:[1,0,1]
    s_waitcnt lgkmcnt(0)
    s_barrier
    ds_read_b128 v[32:35], v19 offset:0
    ds_read_b128 v[36:39], v19 offset:1024
    ds_read_b128 v[40:43], v19 offset:2048
    ds_read_b128 v[44:47], v19 offset:3072
    ds_read_b128 v[48:51], v20 offset:0
    ds_read_b128 v[52:55], v20 offset:1024
    ds_read_b128 v[56:59], v20 offset:2048
    ds_read_b128 v[60:63], v20 offset:3072
    ds_read_b128 v[64:67], v20 offset:40960
    ds_read_b128 v[68:71], v20 offset:41984
    ds_read_b128 v[72:75], v20 offset:43008
    ds_read_b128 v[76:79], v20 offset:44032
    s_waitcnt lgkmcnt(8)
    v_pk_add_f32 v[112:113], v[112:113], v[32:33]
    v_pk_add_f32 v[114:115], v[114:115], v[34:35]
    v_pk_add_f32 v[116:117], v[116:117], v[36:37]
    v_pk_add_f32 v[118:119], v[118:119], v[38:39]
    v_pk_add_f32 v[120:121], v[120:121], v[40:41]
    v_pk_add_f32 v[122:123], v[122:123], v[42:43]
    v_pk_add_f32 v[124:125], v[124:125], v[44:45]
    v_pk_add_f32 v[126:127], v[126:127], v[46:47]
    s_waitcnt lgkmcnt(4)
    v_pk_add_f32 v[112:113], v[112:113], v[48:49]
    v_pk_add_f32 v[114:115], v[114:115], v[50:51]
    v_pk_add_f32 v[116:117], v[116:117], v[52:53]
    v_pk_add_f32 v[118:119], v[118:119], v[54:55]
    v_pk_add_f32 v[120:121], v[120:121], v[56:57]
    v_pk_add_f32 v[122:123], v[122:123], v[58:59]
    v_pk_add_f32 v[124:125], v[124:125], v[60:61]
    v_pk_add_f32 v[126:127], v[126:127], v[62:63]
    s_waitcnt lgkmcnt(0)
    v_pk_add_f32 v[112:113], v[112:113], v[64:65]
    v_pk_add_f32 v[114:115], v[114:115], v[66:67]
    v_pk_add_f32 v[116:117], v[116:117], v[68:69]
    v_pk_add_f32 v[118:119], v[118:119], v[70:71]
    v_pk_add_f32 v[120:121], v[120:121], v[72:73]
    v_pk_add_f32 v[122:123], v[122:123], v[74:75]
    v_pk_add_f32 v[124:125], v[124:125], v[76:77]
    v_pk_add_f32 v[126:127], v[126:127], v[78:79]
    v_cvt_pk_bf16_f32 v112, v112, v113
    v_cvt_pk_bf16_f32 v113, v114, v115
    v_cvt_pk_bf16_f32 v114, v116, v117
    v_cvt_pk_bf16_f32 v115, v118, v119
    v_cvt_pk_bf16_f32 v116, v120, v121
    v_cvt_pk_bf16_f32 v117, v122, v123
    v_cvt_pk_bf16_f32 v118, v124, v125
    v_cvt_pk_bf16_f32 v119, v126, v127
    v_permlane32_swap_b32 v112, v114
    v_permlane32_swap_b32 v113, v115
    v_permlane32_swap_b32 v116, v118
    v_permlane32_swap_b32 v117, v119
    buffer_store_dwordx4 v[112:115], v21, s[56:59], s2 offen
    buffer_store_dwordx4 v[116:119], v21, s[56:59], s2 offen offset:32
    s_branch gated_mix__sliding_local_dilated__glu_gated_glu__prompt_kernel_fin
gated_mix__sliding_local_dilated__glu_gated_glu__prompt_kernel_red2:
    s_nop 11
    s_cmp_lg_u32 s3, 2
    s_cbranch_scc1 gated_mix__sliding_local_dilated__glu_gated_glu__prompt_kernel_red3
    v_pk_fma_f32 v[96:97], v[32:33], v[12:13], v[96:97] op_sel_hi:[1,0,1]
    v_pk_fma_f32 v[98:99], v[34:35], v[12:13], v[98:99] op_sel_hi:[1,0,1]
    v_pk_fma_f32 v[100:101], v[36:37], v[12:13], v[100:101] op_sel_hi:[1,0,1]
    v_pk_fma_f32 v[102:103], v[38:39], v[12:13], v[102:103] op_sel_hi:[1,0,1]
    v_pk_fma_f32 v[104:105], v[40:41], v[12:13], v[104:105] op_sel_hi:[1,0,1]
    v_pk_fma_f32 v[106:107], v[42:43], v[12:13], v[106:107] op_sel_hi:[1,0,1]
    v_pk_fma_f32 v[108:109], v[44:45], v[12:13], v[108:109] op_sel_hi:[1,0,1]
    v_pk_fma_f32 v[110:111], v[46:47], v[12:13], v[110:111] op_sel_hi:[1,0,1]
    ds_write_b128 v18, v[96:99] offset:0
    ds_write_b128 v18, v[100:103] offset:1024
    ds_write_b128 v18, v[104:107] offset:2048
    ds_write_b128 v18, v[108:111] offset:3072
    v_pk_fma_f32 v[112:113], v[48:49], v[12:13], v[112:113] op_sel_hi:[1,0,1]
    v_pk_fma_f32 v[114:115], v[50:51], v[12:13], v[114:115] op_sel_hi:[1,0,1]
    v_pk_fma_f32 v[116:117], v[52:53], v[12:13], v[116:117] op_sel_hi:[1,0,1]
    v_pk_fma_f32 v[118:119], v[54:55], v[12:13], v[118:119] op_sel_hi:[1,0,1]
    v_pk_fma_f32 v[120:121], v[56:57], v[12:13], v[120:121] op_sel_hi:[1,0,1]
    v_pk_fma_f32 v[122:123], v[58:59], v[12:13], v[122:123] op_sel_hi:[1,0,1]
    v_pk_fma_f32 v[124:125], v[60:61], v[12:13], v[124:125] op_sel_hi:[1,0,1]
    v_pk_fma_f32 v[126:127], v[62:63], v[12:13], v[126:127] op_sel_hi:[1,0,1]
    ds_write_b128 v18, v[112:115] offset:4096
    ds_write_b128 v18, v[116:119] offset:5120
    ds_write_b128 v18, v[120:123] offset:6144
    ds_write_b128 v18, v[124:127] offset:7168
    v_pk_fma_f32 v[144:145], v[80:81], v[14:15], v[144:145] op_sel_hi:[1,0,1]
    v_pk_fma_f32 v[146:147], v[82:83], v[14:15], v[146:147] op_sel_hi:[1,0,1]
    v_pk_fma_f32 v[148:149], v[84:85], v[14:15], v[148:149] op_sel_hi:[1,0,1]
    v_pk_fma_f32 v[150:151], v[86:87], v[14:15], v[150:151] op_sel_hi:[1,0,1]
    v_pk_fma_f32 v[152:153], v[88:89], v[14:15], v[152:153] op_sel_hi:[1,0,1]
    v_pk_fma_f32 v[154:155], v[90:91], v[14:15], v[154:155] op_sel_hi:[1,0,1]
    v_pk_fma_f32 v[156:157], v[92:93], v[14:15], v[156:157] op_sel_hi:[1,0,1]
    v_pk_fma_f32 v[158:159], v[94:95], v[14:15], v[158:159] op_sel_hi:[1,0,1]
    ds_write_b128 v18, v[144:147] offset:12288
    ds_write_b128 v18, v[148:151] offset:13312
    ds_write_b128 v18, v[152:155] offset:14336
    ds_write_b128 v18, v[156:159] offset:15360
    v_pk_fma_f32 v[128:129], v[64:65], v[14:15], v[128:129] op_sel_hi:[1,0,1]
    v_pk_fma_f32 v[130:131], v[66:67], v[14:15], v[130:131] op_sel_hi:[1,0,1]
    v_pk_fma_f32 v[132:133], v[68:69], v[14:15], v[132:133] op_sel_hi:[1,0,1]
    v_pk_fma_f32 v[134:135], v[70:71], v[14:15], v[134:135] op_sel_hi:[1,0,1]
    v_pk_fma_f32 v[136:137], v[72:73], v[14:15], v[136:137] op_sel_hi:[1,0,1]
    v_pk_fma_f32 v[138:139], v[74:75], v[14:15], v[138:139] op_sel_hi:[1,0,1]
    v_pk_fma_f32 v[140:141], v[76:77], v[14:15], v[140:141] op_sel_hi:[1,0,1]
    v_pk_fma_f32 v[142:143], v[78:79], v[14:15], v[142:143] op_sel_hi:[1,0,1]
    s_waitcnt lgkmcnt(0)
    s_barrier
    ds_read_b128 v[32:35], v19 offset:0
    ds_read_b128 v[36:39], v19 offset:1024
    ds_read_b128 v[40:43], v19 offset:2048
    ds_read_b128 v[44:47], v19 offset:3072
    ds_read_b128 v[48:51], v19 offset:40960
    ds_read_b128 v[52:55], v19 offset:41984
    ds_read_b128 v[56:59], v19 offset:43008
    ds_read_b128 v[60:63], v19 offset:44032
    ds_read_b128 v[64:67], v20 offset:40960
    ds_read_b128 v[68:71], v20 offset:41984
    ds_read_b128 v[72:75], v20 offset:43008
    ds_read_b128 v[76:79], v20 offset:44032
    s_waitcnt lgkmcnt(8)
    v_pk_add_f32 v[128:129], v[128:129], v[32:33]
    v_pk_add_f32 v[130:131], v[130:131], v[34:35]
    v_pk_add_f32 v[132:133], v[132:133], v[36:37]
    v_pk_add_f32 v[134:135], v[134:135], v[38:39]
    v_pk_add_f32 v[136:137], v[136:137], v[40:41]
    v_pk_add_f32 v[138:139], v[138:139], v[42:43]
    v_pk_add_f32 v[140:141], v[140:141], v[44:45]
    v_pk_add_f32 v[142:143], v[142:143], v[46:47]
    s_waitcnt lgkmcnt(4)
    v_pk_add_f32 v[128:129], v[128:129], v[48:49]
    v_pk_add_f32 v[130:131], v[130:131], v[50:51]
    v_pk_add_f32 v[132:133], v[132:133], v[52:53]
    v_pk_add_f32 v[134:135], v[134:135], v[54:55]
    v_pk_add_f32 v[136:137], v[136:137], v[56:57]
    v_pk_add_f32 v[138:139], v[138:139], v[58:59]
    v_pk_add_f32 v[140:141], v[140:141], v[60:61]
    v_pk_add_f32 v[142:143], v[142:143], v[62:63]
    s_waitcnt lgkmcnt(0)
    v_pk_add_f32 v[128:129], v[128:129], v[64:65]
    v_pk_add_f32 v[130:131], v[130:131], v[66:67]
    v_pk_add_f32 v[132:133], v[132:133], v[68:69]
    v_pk_add_f32 v[134:135], v[134:135], v[70:71]
    v_pk_add_f32 v[136:137], v[136:137], v[72:73]
    v_pk_add_f32 v[138:139], v[138:139], v[74:75]
    v_pk_add_f32 v[140:141], v[140:141], v[76:77]
    v_pk_add_f32 v[142:143], v[142:143], v[78:79]
    v_cvt_pk_bf16_f32 v128, v128, v129
    v_cvt_pk_bf16_f32 v129, v130, v131
    v_cvt_pk_bf16_f32 v130, v132, v133
    v_cvt_pk_bf16_f32 v131, v134, v135
    v_cvt_pk_bf16_f32 v132, v136, v137
    v_cvt_pk_bf16_f32 v133, v138, v139
    v_cvt_pk_bf16_f32 v134, v140, v141
    v_cvt_pk_bf16_f32 v135, v142, v143
    v_permlane32_swap_b32 v128, v130
    v_permlane32_swap_b32 v129, v131
    v_permlane32_swap_b32 v132, v134
    v_permlane32_swap_b32 v133, v135
    buffer_store_dwordx4 v[128:131], v21, s[56:59], s2 offen
    buffer_store_dwordx4 v[132:135], v21, s[56:59], s2 offen offset:32
    s_branch gated_mix__sliding_local_dilated__glu_gated_glu__prompt_kernel_fin
gated_mix__sliding_local_dilated__glu_gated_glu__prompt_kernel_red3:
    s_nop 11
    v_pk_fma_f32 v[96:97], v[32:33], v[12:13], v[96:97] op_sel_hi:[1,0,1]
    v_pk_fma_f32 v[98:99], v[34:35], v[12:13], v[98:99] op_sel_hi:[1,0,1]
    v_pk_fma_f32 v[100:101], v[36:37], v[12:13], v[100:101] op_sel_hi:[1,0,1]
    v_pk_fma_f32 v[102:103], v[38:39], v[12:13], v[102:103] op_sel_hi:[1,0,1]
    v_pk_fma_f32 v[104:105], v[40:41], v[12:13], v[104:105] op_sel_hi:[1,0,1]
    v_pk_fma_f32 v[106:107], v[42:43], v[12:13], v[106:107] op_sel_hi:[1,0,1]
    v_pk_fma_f32 v[108:109], v[44:45], v[12:13], v[108:109] op_sel_hi:[1,0,1]
    v_pk_fma_f32 v[110:111], v[46:47], v[12:13], v[110:111] op_sel_hi:[1,0,1]
    ds_write_b128 v18, v[96:99] offset:0
    ds_write_b128 v18, v[100:103] offset:1024
    ds_write_b128 v18, v[104:107] offset:2048
    ds_write_b128 v18, v[108:111] offset:3072
    v_pk_fma_f32 v[112:113], v[48:49], v[12:13], v[112:113] op_sel_hi:[1,0,1]
    v_pk_fma_f32 v[114:115], v[50:51], v[12:13], v[114:115] op_sel_hi:[1,0,1]
    v_pk_fma_f32 v[116:117], v[52:53], v[12:13], v[116:117] op_sel_hi:[1,0,1]
    v_pk_fma_f32 v[118:119], v[54:55], v[12:13], v[118:119] op_sel_hi:[1,0,1]
    v_pk_fma_f32 v[120:121], v[56:57], v[12:13], v[120:121] op_sel_hi:[1,0,1]
    v_pk_fma_f32 v[122:123], v[58:59], v[12:13], v[122:123] op_sel_hi:[1,0,1]
    v_pk_fma_f32 v[124:125], v[60:61], v[12:13], v[124:125] op_sel_hi:[1,0,1]
    v_pk_fma_f32 v[126:127], v[62:63], v[12:13], v[126:127] op_sel_hi:[1,0,1]
    ds_write_b128 v18, v[112:115] offset:4096
    ds_write_b128 v18, v[116:119] offset:5120
    ds_write_b128 v18, v[120:123] offset:6144
    ds_write_b128 v18, v[124:127] offset:7168
    v_pk_fma_f32 v[128:129], v[64:65], v[14:15], v[128:129] op_sel_hi:[1,0,1]
    v_pk_fma_f32 v[130:131], v[66:67], v[14:15], v[130:131] op_sel_hi:[1,0,1]
    v_pk_fma_f32 v[132:133], v[68:69], v[14:15], v[132:133] op_sel_hi:[1,0,1]
    v_pk_fma_f32 v[134:135], v[70:71], v[14:15], v[134:135] op_sel_hi:[1,0,1]
    v_pk_fma_f32 v[136:137], v[72:73], v[14:15], v[136:137] op_sel_hi:[1,0,1]
    v_pk_fma_f32 v[138:139], v[74:75], v[14:15], v[138:139] op_sel_hi:[1,0,1]
    v_pk_fma_f32 v[140:141], v[76:77], v[14:15], v[140:141] op_sel_hi:[1,0,1]
    v_pk_fma_f32 v[142:143], v[78:79], v[14:15], v[142:143] op_sel_hi:[1,0,1]
    ds_write_b128 v18, v[128:131] offset:8192
    ds_write_b128 v18, v[132:135] offset:9216
    ds_write_b128 v18, v[136:139] offset:10240
    ds_write_b128 v18, v[140:143] offset:11264
    v_pk_fma_f32 v[144:145], v[80:81], v[14:15], v[144:145] op_sel_hi:[1,0,1]
    v_pk_fma_f32 v[146:147], v[82:83], v[14:15], v[146:147] op_sel_hi:[1,0,1]
    v_pk_fma_f32 v[148:149], v[84:85], v[14:15], v[148:149] op_sel_hi:[1,0,1]
    v_pk_fma_f32 v[150:151], v[86:87], v[14:15], v[150:151] op_sel_hi:[1,0,1]
    v_pk_fma_f32 v[152:153], v[88:89], v[14:15], v[152:153] op_sel_hi:[1,0,1]
    v_pk_fma_f32 v[154:155], v[90:91], v[14:15], v[154:155] op_sel_hi:[1,0,1]
    v_pk_fma_f32 v[156:157], v[92:93], v[14:15], v[156:157] op_sel_hi:[1,0,1]
    v_pk_fma_f32 v[158:159], v[94:95], v[14:15], v[158:159] op_sel_hi:[1,0,1]
    s_waitcnt lgkmcnt(0)
    s_barrier
    ds_read_b128 v[32:35], v19 offset:0
    ds_read_b128 v[36:39], v19 offset:1024
    ds_read_b128 v[40:43], v19 offset:2048
    ds_read_b128 v[44:47], v19 offset:3072
    ds_read_b128 v[48:51], v19 offset:40960
    ds_read_b128 v[52:55], v19 offset:41984
    ds_read_b128 v[56:59], v19 offset:43008
    ds_read_b128 v[60:63], v19 offset:44032
    ds_read_b128 v[64:67], v20 offset:0
    ds_read_b128 v[68:71], v20 offset:1024
    ds_read_b128 v[72:75], v20 offset:2048
    ds_read_b128 v[76:79], v20 offset:3072
    s_waitcnt lgkmcnt(8)
    v_pk_add_f32 v[144:145], v[144:145], v[32:33]
    v_pk_add_f32 v[146:147], v[146:147], v[34:35]
    v_pk_add_f32 v[148:149], v[148:149], v[36:37]
    v_pk_add_f32 v[150:151], v[150:151], v[38:39]
    v_pk_add_f32 v[152:153], v[152:153], v[40:41]
    v_pk_add_f32 v[154:155], v[154:155], v[42:43]
    v_pk_add_f32 v[156:157], v[156:157], v[44:45]
    v_pk_add_f32 v[158:159], v[158:159], v[46:47]
    s_waitcnt lgkmcnt(4)
    v_pk_add_f32 v[144:145], v[144:145], v[48:49]
    v_pk_add_f32 v[146:147], v[146:147], v[50:51]
    v_pk_add_f32 v[148:149], v[148:149], v[52:53]
    v_pk_add_f32 v[150:151], v[150:151], v[54:55]
    v_pk_add_f32 v[152:153], v[152:153], v[56:57]
    v_pk_add_f32 v[154:155], v[154:155], v[58:59]
    v_pk_add_f32 v[156:157], v[156:157], v[60:61]
    v_pk_add_f32 v[158:159], v[158:159], v[62:63]
    s_waitcnt lgkmcnt(0)
    v_pk_add_f32 v[144:145], v[144:145], v[64:65]
    v_pk_add_f32 v[146:147], v[146:147], v[66:67]
    v_pk_add_f32 v[148:149], v[148:149], v[68:69]
    v_pk_add_f32 v[150:151], v[150:151], v[70:71]
    v_pk_add_f32 v[152:153], v[152:153], v[72:73]
    v_pk_add_f32 v[154:155], v[154:155], v[74:75]
    v_pk_add_f32 v[156:157], v[156:157], v[76:77]
    v_pk_add_f32 v[158:159], v[158:159], v[78:79]
    v_cvt_pk_bf16_f32 v144, v144, v145
    v_cvt_pk_bf16_f32 v145, v146, v147
    v_cvt_pk_bf16_f32 v146, v148, v149
    v_cvt_pk_bf16_f32 v147, v150, v151
    v_cvt_pk_bf16_f32 v148, v152, v153
    v_cvt_pk_bf16_f32 v149, v154, v155
    v_cvt_pk_bf16_f32 v150, v156, v157
    v_cvt_pk_bf16_f32 v151, v158, v159
    v_permlane32_swap_b32 v144, v146
    v_permlane32_swap_b32 v145, v147
    v_permlane32_swap_b32 v148, v150
    v_permlane32_swap_b32 v149, v151
    buffer_store_dwordx4 v[144:147], v21, s[56:59], s2 offen
    buffer_store_dwordx4 v[148:151], v21, s[56:59], s2 offen offset:32
gated_mix__sliding_local_dilated__glu_gated_glu__prompt_kernel_fin:
gated_mix__sliding_local_dilated__glu_gated_glu__prompt_kernel_done:
    s_endpgm
.section .rodata,"a"
.p2align 6
.amdhsa_kernel gated_mix__sliding_local_dilated__glu_gated_glu__prompt_kernel
  .amdhsa_next_free_vgpr 512
  .amdhsa_next_free_sgpr 102
  .amdhsa_accum_offset 256
  .amdhsa_group_segment_fixed_size 0
  .amdhsa_kernarg_size 88
  .amdhsa_user_sgpr_count 2
  .amdhsa_user_sgpr_kernarg_segment_ptr 1
  .amdhsa_system_sgpr_workgroup_id_x 1
.end_amdhsa_kernel
```
